```python
import torch

def _softmax(x, axis=-1):
    return torch.softmax(x, dim=axis)
def _gelu(x):
    return torch.nn.functional.gelu(x, approximate="tanh")
def _silu(x):
    return torch.nn.functional.silu(x)
def _sigmoid(x):
    return torch.sigmoid(x)
def _layernorm(x, axis=-1, eps=1e-5):
    m = x.mean(dim=axis, keepdim=True)
    v = x.var(dim=axis, keepdim=True, unbiased=False)
    return (x - m) / torch.sqrt(v + eps)
def _scatter_add(tgt, idx, src, axis=0):
    return tgt.clone().index_add_(axis, idx, src)
def _segment_sum(src, seg, n):
    out = torch.zeros((n,) + src.shape[1:], dtype=src.dtype)
    return out.index_add_(0, seg, src)
def _pad(x, pw):
    flat = tuple(v for pair in reversed(pw) for v in pair)
    return torch.nn.functional.pad(x, flat)

kernel_name = 'parallel_sum__mha_block__mixer_s_mlp__prompt'

def setup_inputs():

    _w = (lambda a: (lambda t: t.to(torch.bfloat16) if t.is_floating_point() else t)(torch.as_tensor(a)))
    def _A_setup():
        B, S, D, H = 1, 2048, 640, 32
        return {
            "x": _w((lambda *s: torch.randn(*s, dtype=torch.bfloat16) * 0.05)(B, S, D)),
            "wqkv": _w((lambda *s: torch.randn(*s, dtype=torch.bfloat16) * 0.05)(D, 3 * D)),
            "wo": _w((lambda *s: torch.randn(*s, dtype=torch.bfloat16) * 0.05)(D, D)),
        }
    _A_in = _A_setup()

    def _B_setup():
        B, S, D, F = 1, 2048, 640, 1536
        return {
            "x":  _w((lambda *s: torch.randn(*s, dtype=torch.bfloat16) * 0.05)(B, S, D)),
            "w1": _w((lambda *s: torch.randn(*s, dtype=torch.bfloat16) * 0.8)(D, D) * (D ** -0.5)),
            "w2": _w((lambda *s: torch.randn(*s, dtype=torch.bfloat16) * 0.8)(D, D) * (D ** -0.5)),
            "w3": _w((lambda *s: torch.randn(*s, dtype=torch.bfloat16) * 0.8)(D, F) * (D ** -0.5)),
            "w4": _w((lambda *s: torch.randn(*s, dtype=torch.bfloat16) * 0.8)(F, D) * (F ** -0.5)),
        }
    _B_in = _B_setup()

    return {
        "A_x": _A_in["x"],
        "A_wqkv": _A_in["wqkv"],
        "A_wo": _A_in["wo"],
        "B_x": _B_in["x"],
        "B_w1": _B_in["w1"],
        "B_w2": _B_in["w2"],
        "B_w3": _B_in["w3"],
        "B_w4": _B_in["w4"],
    }

def reference(A_x, A_wqkv, A_wo, B_x, B_w1, B_w2, B_w3, B_w4):
    def _A_ref(x, wqkv, wo):
        B, S, D = x.shape
        H = 32
        Dh = D // H
        qkv = (lambda x, *d: x.permute(*d))((x @ wqkv).reshape(B, S, 3, H, Dh), 2, 0, 3, 1, 4)
        q, k, v = qkv[0], qkv[1], qkv[2]
        scores = torch.einsum("bhqd,bhkd->bhqk", q, k) * (Dh ** -0.5)
        p = _softmax(scores, axis=-1)
        o = torch.einsum("bhqk,bhkd->bhqd", p, v)
        return (lambda x, *d: x.permute(*d))(o, 0, 2, 1, 3).reshape(B, S, D) @ wo

    def _B_ref(x, w1, w2, w3, w4):
        B, S, D = x.shape
        h = _gelu(_layernorm(x, axis=-1) @ w1)
        c = D // 4
        g0 = _pad(h[:, :, 0*c:1*c], ((0, 0), (1, 0), (0, 0)))[:, :S, :]
        g1 = _pad(h[:, :, 1*c:2*c], ((0, 0), (0, 1), (0, 0)))[:, 1:, :]
        g2 = _pad(h[:, :, 2*c:3*c], ((0, 0), (2, 0), (0, 0)))[:, :S, :]
        g3 = _pad(h[:, :, 3*c:   ], ((0, 0), (0, 2), (0, 0)))[:, 2:, :]
        hs = torch.concatenate([g0, g1, g2, g3], axis=-1) @ w2
        x1 = x + hs
        h2 = _gelu(_layernorm(x1, axis=-1) @ w3) @ w4
        return x1 + h2

    x = A_x
    xn = _layernorm(x, axis=-1)
    return x + _A_ref(xn, A_wqkv, A_wo) + _B_ref(xn, B_w1, B_w2, B_w3, B_w4)
```

```asm
; @launch kernel=k1_kernel grid=(256,1,1) block=(512,1,1) lds=136192
; @launch kernel=k2_kernel grid=(512,1,1) block=(512,1,1) lds=81920
.amdgcn_target "amdgcn-amd-amdhsa--gfx950"
.text
.globl k1_kernel
.p2align 8
.type k1_kernel,@function
k1_kernel:
    s_cmp_ge_u32 s2, 256
    s_cbranch_scc1 k1_kernel_exit
    s_load_dwordx16 s[64:79], s[0:1], 0
    s_load_dwordx4 s[80:83], s[0:1], 64
    s_load_dwordx2 s[32:33], s[0:1], 80
    s_cmp_ge_u32 s2, 8
    s_cbranch_scc1 k1_kernel_nocp
    s_getpc_b64 s[34:35]
k1_kernel_pc:
    s_sub_u32 s34, s34, k1_kernel_pc - k1_kernel
    s_subb_u32 s35, s35, 0
    s_mov_b32 s36, 0xa660
    v_lshlrev_b32 v214, 7, v0
    v_min_u32 v214, s36, v214
    global_load_dword v215, v214, s[34:35]
k1_kernel_nocp:
    v_readfirstlane_b32 s26, v0
    v_and_b32 v0, 63, v0
    s_nop 2
    s_lshr_b32 s26, s26, 6
    s_lshr_b32 s28, s26, 1
    s_and_b32 s28, s28, 1
    s_and_b32 s29, s26, 1
    s_cmp_lt_u32 s26, 4
    s_cbranch_scc1 k1_kernel_compute
    s_sub_u32 s26, s26, 4
    s_mul_i32 s30, s26, 32
    v_lshrrev_b32 v5, 3, v0
    v_add_u32 v5, s30, v5
    v_lshrrev_b32 v6, 1, v5
    v_xor_b32 v6, v6, v0
    v_and_b32 v6, 7, v6
    v_mul_u32_u24 v7, 1280, v5
    v_lshl_add_u32 v8, v6, 4, v7
    s_mul_i32 s30, s26, 32
    v_lshrrev_b32 v5, 3, v0
    v_add_u32 v5, s30, v5
    v_add_u32 v5, 8, v5
    v_lshrrev_b32 v6, 1, v5
    v_xor_b32 v6, v6, v0
    v_and_b32 v6, 7, v6
    v_mul_u32_u24 v7, 1280, v5
    v_lshl_add_u32 v9, v6, 4, v7
    v_subrev_u32 v9, 1024, v9
    s_mul_i32 s30, s26, 32
    v_lshrrev_b32 v5, 3, v0
    v_add_u32 v5, s30, v5
    v_add_u32 v5, 16, v5
    v_lshrrev_b32 v6, 1, v5
    v_xor_b32 v6, v6, v0
    v_and_b32 v6, 7, v6
    v_mul_u32_u24 v7, 1280, v5
    v_lshl_add_u32 v10, v6, 4, v7
    v_subrev_u32 v10, 2048, v10
    s_mul_i32 s30, s26, 32
    v_lshrrev_b32 v5, 3, v0
    v_add_u32 v5, s30, v5
    v_add_u32 v5, 24, v5
    v_lshrrev_b32 v6, 1, v5
    v_xor_b32 v6, v6, v0
    v_and_b32 v6, 7, v6
    v_mul_u32_u24 v7, 1280, v5
    v_lshl_add_u32 v11, v6, 4, v7
    v_subrev_u32 v11, 3072, v11
    s_mul_i32 s30, s26, 320
    v_add_u32 v5, s30, v0
    v_mul_u32_u24 v32, 0xcccd, v5
    v_lshrrev_b32 v32, 20, v32
    v_mul_u32_u24 v7, 20, v32
    v_lshrrev_b32 v17, 2, v32
    v_sub_u32 v7, v5, v7
    v_and_b32 v17, 2, v17
    v_xor_b32 v7, v7, v17
    v_lshlrev_b32 v12, 4, v7
    v_add_u32 v5, 64, v5
    v_mul_u32_u24 v33, 0xcccd, v5
    v_lshrrev_b32 v33, 20, v33
    v_mul_u32_u24 v7, 20, v33
    v_lshrrev_b32 v17, 2, v33
    v_sub_u32 v7, v5, v7
    v_and_b32 v17, 2, v17
    v_xor_b32 v7, v7, v17
    v_lshlrev_b32 v13, 4, v7
    v_subrev_u32 v13, 1024, v13
    v_add_u32 v5, 64, v5
    v_mul_u32_u24 v34, 0xcccd, v5
    v_lshrrev_b32 v34, 20, v34
    v_mul_u32_u24 v7, 20, v34
    v_lshrrev_b32 v17, 2, v34
    v_sub_u32 v7, v5, v7
    v_and_b32 v17, 2, v17
    v_xor_b32 v7, v7, v17
    v_lshlrev_b32 v14, 4, v7
    v_subrev_u32 v14, 2048, v14
    v_add_u32 v5, 64, v5
    v_mul_u32_u24 v35, 0xcccd, v5
    v_lshrrev_b32 v35, 20, v35
    v_mul_u32_u24 v7, 20, v35
    v_lshrrev_b32 v17, 2, v35
    v_sub_u32 v7, v5, v7
    v_and_b32 v17, 2, v17
    v_xor_b32 v7, v7, v17
    v_lshlrev_b32 v15, 4, v7
    v_subrev_u32 v15, 3072, v15
    v_add_u32 v5, 64, v5
    v_mul_u32_u24 v36, 0xcccd, v5
    v_lshrrev_b32 v36, 20, v36
    v_mul_u32_u24 v7, 20, v36
    v_lshrrev_b32 v17, 2, v36
    v_sub_u32 v7, v5, v7
    v_and_b32 v17, 2, v17
    v_xor_b32 v7, v7, v17
    v_lshlrev_b32 v16, 4, v7
    s_mul_i32 s24, s26, 4096
    s_mul_i32 s20, s26, 5120
    s_add_u32 s20, s20, 49152
    s_and_b32 s3, s2, 7
    s_lshr_b32 s16, s2, 3
    s_and_b32 s17, s3, 1
    s_lshl_b32 s17, s17, 3
    s_and_b32 s47, s16, 7
    s_add_u32 s40, s17, s47
    s_lshr_b32 s17, s3, 1
    s_lshr_b32 s48, s16, 3
    s_sub_u32 s41, 3, s48
    s_lshl_b32 s41, s41, 2
    s_add_u32 s41, s41, s17
    s_lshl_b32 s42, s40, 7
    s_cmp_lt_u32 s41, 12
    s_mov_b32 s43, 1280
    s_cselect_b32 s43, 3840, s43
    s_cselect_b32 s30, 0, 12
    s_sub_u32 s30, s41, s30
    s_mul_i32 s44, s30, 320
    s_lshl_b32 s23, s43, 6
    s_mul_i32 s45, s48, 80
    s_mul_i32 s30, s47, 40
    s_add_u32 s45, s45, s30
    s_lshr_b32 s45, s45, 5
    s_cmp_ge_u32 s45, 10
    s_cselect_b32 s30, 10, 0
    s_sub_u32 s45, s45, s30
    s_mul_i32 s53, s42, 1280
    s_lshl_b32 s21, s45, 7
    s_add_u32 s21, s21, s53
    s_mul_i32 s22, s45, s23
    s_add_u32 s22, s22, s44
    s_mov_b32 s46, s45
    v_mad_u32_u24 v12, v32, s43, v12
    v_mad_u32_u24 v13, v33, s43, v13
    v_mad_u32_u24 v14, v34, s43, v14
    v_mad_u32_u24 v15, v35, s43, v15
    v_mad_u32_u24 v16, v36, s43, v16
    s_waitcnt lgkmcnt(0)
    s_mov_b32 s4, s64
    s_mov_b32 s5, s65
    s_mov_b32 s6, 0x280000
    s_mov_b32 s7, 0x00020000
    s_cmp_lt_u32 s41, 12
    s_cselect_b32 s8, s66, s72
    s_cselect_b32 s9, s67, s73
    s_mov_b32 s10, 0xc8000
    s_cselect_b32 s10, 0x258000, s10
    s_mov_b32 s11, 0x00020000
    s_add_u32 m0, s24, 0
    s_nop 0
    buffer_load_dwordx4 v8, s[4:7], s21 offen offset:0  lds
    buffer_load_dwordx4 v9, s[4:7], s21 offen offset:1024  lds
    buffer_load_dwordx4 v10, s[4:7], s21 offen offset:2048  lds
    buffer_load_dwordx4 v11, s[4:7], s21 offen offset:3072  lds
    s_add_u32 s21, s21, 128
    s_add_u32 s45, s45, 1
    s_cmp_lg_u32 s45, 10
    s_cbranch_scc1 k1_kernel_u1_done
    s_mov_b32 s21, s53
    s_mov_b32 s45, 0
k1_kernel_u1_done:
    s_add_u32 m0, s20, 0
    s_nop 0
    buffer_load_dwordx4 v12, s[8:11], s22 offen offset:0 lds
    buffer_load_dwordx4 v13, s[8:11], s22 offen offset:1024 lds
    buffer_load_dwordx4 v14, s[8:11], s22 offen offset:2048 lds
    buffer_load_dwordx4 v15, s[8:11], s22 offen offset:3072 lds
    s_add_u32 m0, s20, 4096
    s_nop 0
    buffer_load_dwordx4 v16, s[8:11], s22 offen offset:0 lds
    s_add_u32 s22, s22, s23
    s_add_u32 s46, s46, 1
    s_cmp_lg_u32 s46, 10
    s_cbranch_scc1 k1_kernel_u2_done
    s_mov_b32 s22, s44
    s_mov_b32 s46, 0
k1_kernel_u2_done:
    s_sub_u32 s34, s2, 64
    s_lshl_b32 s34, s34, 2
    s_add_u32 s34, s34, s26
    s_cmp_lt_u32 s34, 736
    s_cselect_b32 s47, 1, 0
    s_cselect_b32 s34, s34, 0
    s_mov_b32 s54, 0
    s_mov_b32 s55, 0
    s_cmp_lt_u32 s34, 160
    s_cbranch_scc1 k1_kernel_rtl_w2
    s_cmp_lt_u32 s34, 544
    s_cbranch_scc1 k1_kernel_rtl_w4
    s_sub_u32 s34, s34, 544
    s_mul_i32 s36, s34, 2731
    s_lshr_b32 s36, s36, 16
    s_mul_i32 s35, s36, 24
    s_sub_u32 s35, s34, s35
    s_mul_i32 s38, s36, 368640
    s_mul_i32 s39, s35, 5120
    s_add_u32 s38, s38, s39
    s_add_u32 s38, s38, 3391488
    s_mov_b32 s12, s68
    s_mov_b32 s13, s69
    s_mov_b32 s14, 0xc8000
    s_mov_b32 s15, 0x00020000
    s_mov_b32 s37, 0
    s_mov_b32 s54, 1
    s_lshl_b32 s55, s35, 2
    s_mul_i32 s49, s36, 160
    s_branch k1_kernel_rtl_go
k1_kernel_rtl_w4:
    s_sub_u32 s34, s34, 160
    s_mul_i32 s36, s34, 1366
    s_lshr_b32 s36, s36, 16
    s_mul_i32 s35, s36, 48
    s_sub_u32 s35, s34, s35
    s_mul_i32 s38, s36, 368640
    s_mul_i32 s39, s35, 5120
    s_add_u32 s38, s38, s39
    s_add_u32 s38, s38, 3145728
    s_mov_b32 s12, s78
    s_mov_b32 s13, s79
    s_mov_b32 s14, 0x1e0000
    s_mov_b32 s15, 0x00020000
    s_lshl_b32 s37, s35, 5
    s_mul_i32 s49, s36, 160
    s_branch k1_kernel_rtl_go
k1_kernel_rtl_w2:
    s_mul_i32 s36, s34, 3277
    s_lshr_b32 s36, s36, 16
    s_mul_i32 s35, s36, 20
    s_sub_u32 s35, s34, s35
    s_mul_i32 s38, s34, 5120
    s_mov_b32 s12, s74
    s_mov_b32 s13, s75
    s_mov_b32 s14, 0xc8000
    s_mov_b32 s15, 0x00020000
    s_lshl_b32 s37, s35, 5
    s_mul_i32 s49, s36, 160
k1_kernel_rtl_go:
    s_mul_i32 s37, s37, 1280
    s_add_u32 s49, s49, s37
    s_cmp_eq_u32 s47, 0
    s_cselect_b32 s51, 0, 32
    s_mul_i32 s50, s26, 6144
    s_add_u32 s50, s50, 111616
    v_mov_b32 v20, v0
    v_mov_b32 v30, 0x7ff00000
    v_mul_u32_u24 v21, 0x15556, v20
    v_lshrrev_b32 v21, 20, v21
    v_mul_u32_u24 v22, 12, v21
    v_lshrrev_b32 v23, 2, v21
    v_sub_u32 v22, v20, v22
    v_and_b32 v23, 2, v23
    v_xor_b32 v22, v22, v23
    v_min_u32 v22, 9, v22
    s_cmp_eq_u32 s54, 0
    s_cbranch_scc1 k1_kernel_rtp0
    v_lshrrev_b32 v23, 3, v21
    v_add_u32 v23, s55, v23
    v_mul_u32_u24 v31, 43, v23
    v_lshrrev_b32 v31, 7, v31
    v_mul_u32_u24 v37, 3, v31
    v_sub_u32 v23, v23, v37
    v_and_b32 v21, 7, v21
    v_lshl_add_u32 v37, v23, 3, v21
    v_mul_u32_u24 v21, 20, v31
    v_add_u32 v21, v21, v37
    v_cmp_gt_u32 vcc, 20, v37
    s_branch k1_kernel_rtq0
k1_kernel_rtp0:
    v_cmp_gt_u32 vcc, s51, v21
k1_kernel_rtq0:
    v_mul_u32_u24 v21, 1280, v21
    v_lshl_add_u32 v24, v22, 4, v21
    v_cndmask_b32 v24, v30, v24, vcc
    v_add_u32 v20, 64, v20
    v_mul_u32_u24 v21, 0x15556, v20
    v_lshrrev_b32 v21, 20, v21
    v_mul_u32_u24 v22, 12, v21
    v_lshrrev_b32 v23, 2, v21
    v_sub_u32 v22, v20, v22
    v_and_b32 v23, 2, v23
    v_xor_b32 v22, v22, v23
    v_min_u32 v22, 9, v22
    s_cmp_eq_u32 s54, 0
    s_cbranch_scc1 k1_kernel_rtp1
    v_lshrrev_b32 v23, 3, v21
    v_add_u32 v23, s55, v23
    v_mul_u32_u24 v31, 43, v23
    v_lshrrev_b32 v31, 7, v31
    v_mul_u32_u24 v37, 3, v31
    v_sub_u32 v23, v23, v37
    v_and_b32 v21, 7, v21
    v_lshl_add_u32 v37, v23, 3, v21
    v_mul_u32_u24 v21, 20, v31
    v_add_u32 v21, v21, v37
    v_cmp_gt_u32 vcc, 20, v37
    s_branch k1_kernel_rtq1
k1_kernel_rtp1:
    v_cmp_gt_u32 vcc, s51, v21
k1_kernel_rtq1:
    v_mul_u32_u24 v21, 1280, v21
    v_lshl_add_u32 v25, v22, 4, v21
    v_cndmask_b32 v25, v30, v25, vcc
    v_add_u32 v20, 64, v20
    v_mul_u32_u24 v21, 0x15556, v20
    v_lshrrev_b32 v21, 20, v21
    v_mul_u32_u24 v22, 12, v21
    v_lshrrev_b32 v23, 2, v21
    v_sub_u32 v22, v20, v22
    v_and_b32 v23, 2, v23
    v_xor_b32 v22, v22, v23
    v_min_u32 v22, 9, v22
    s_cmp_eq_u32 s54, 0
    s_cbranch_scc1 k1_kernel_rtp2
    v_lshrrev_b32 v23, 3, v21
    v_add_u32 v23, s55, v23
    v_mul_u32_u24 v31, 43, v23
    v_lshrrev_b32 v31, 7, v31
    v_mul_u32_u24 v37, 3, v31
    v_sub_u32 v23, v23, v37
    v_and_b32 v21, 7, v21
    v_lshl_add_u32 v37, v23, 3, v21
    v_mul_u32_u24 v21, 20, v31
    v_add_u32 v21, v21, v37
    v_cmp_gt_u32 vcc, 20, v37
    s_branch k1_kernel_rtq2
k1_kernel_rtp2:
    v_cmp_gt_u32 vcc, s51, v21
k1_kernel_rtq2:
    v_mul_u32_u24 v21, 1280, v21
    v_lshl_add_u32 v26, v22, 4, v21
    v_cndmask_b32 v26, v30, v26, vcc
    v_add_u32 v20, 64, v20
    v_mul_u32_u24 v21, 0x15556, v20
    v_lshrrev_b32 v21, 20, v21
    v_mul_u32_u24 v22, 12, v21
    v_lshrrev_b32 v23, 2, v21
    v_sub_u32 v22, v20, v22
    v_and_b32 v23, 2, v23
    v_xor_b32 v22, v22, v23
    v_min_u32 v22, 9, v22
    s_cmp_eq_u32 s54, 0
    s_cbranch_scc1 k1_kernel_rtp3
    v_lshrrev_b32 v23, 3, v21
    v_add_u32 v23, s55, v23
    v_mul_u32_u24 v31, 43, v23
    v_lshrrev_b32 v31, 7, v31
    v_mul_u32_u24 v37, 3, v31
    v_sub_u32 v23, v23, v37
    v_and_b32 v21, 7, v21
    v_lshl_add_u32 v37, v23, 3, v21
    v_mul_u32_u24 v21, 20, v31
    v_add_u32 v21, v21, v37
    v_cmp_gt_u32 vcc, 20, v37
    s_branch k1_kernel_rtq3
k1_kernel_rtp3:
    v_cmp_gt_u32 vcc, s51, v21
k1_kernel_rtq3:
    v_mul_u32_u24 v21, 1280, v21
    v_lshl_add_u32 v27, v22, 4, v21
    v_cndmask_b32 v27, v30, v27, vcc
    v_add_u32 v20, 64, v20
    v_mul_u32_u24 v21, 0x15556, v20
    v_lshrrev_b32 v21, 20, v21
    v_mul_u32_u24 v22, 12, v21
    v_lshrrev_b32 v23, 2, v21
    v_sub_u32 v22, v20, v22
    v_and_b32 v23, 2, v23
    v_xor_b32 v22, v22, v23
    v_min_u32 v22, 9, v22
    s_cmp_eq_u32 s54, 0
    s_cbranch_scc1 k1_kernel_rtp4
    v_lshrrev_b32 v23, 3, v21
    v_add_u32 v23, s55, v23
    v_mul_u32_u24 v31, 43, v23
    v_lshrrev_b32 v31, 7, v31
    v_mul_u32_u24 v37, 3, v31
    v_sub_u32 v23, v23, v37
    v_and_b32 v21, 7, v21
    v_lshl_add_u32 v37, v23, 3, v21
    v_mul_u32_u24 v21, 20, v31
    v_add_u32 v21, v21, v37
    v_cmp_gt_u32 vcc, 20, v37
    s_branch k1_kernel_rtq4
k1_kernel_rtp4:
    v_cmp_gt_u32 vcc, s51, v21
k1_kernel_rtq4:
    v_mul_u32_u24 v21, 1280, v21
    v_lshl_add_u32 v28, v22, 4, v21
    v_cndmask_b32 v28, v30, v28, vcc
    v_add_u32 v20, 64, v20
    v_mul_u32_u24 v21, 0x15556, v20
    v_lshrrev_b32 v21, 20, v21
    v_mul_u32_u24 v22, 12, v21
    v_lshrrev_b32 v23, 2, v21
    v_sub_u32 v22, v20, v22
    v_and_b32 v23, 2, v23
    v_xor_b32 v22, v22, v23
    v_min_u32 v22, 9, v22
    s_cmp_eq_u32 s54, 0
    s_cbranch_scc1 k1_kernel_rtp5
    v_lshrrev_b32 v23, 3, v21
    v_add_u32 v23, s55, v23
    v_mul_u32_u24 v31, 43, v23
    v_lshrrev_b32 v31, 7, v31
    v_mul_u32_u24 v37, 3, v31
    v_sub_u32 v23, v23, v37
    v_and_b32 v21, 7, v21
    v_lshl_add_u32 v37, v23, 3, v21
    v_mul_u32_u24 v21, 20, v31
    v_add_u32 v21, v21, v37
    v_cmp_gt_u32 vcc, 20, v37
    s_branch k1_kernel_rtq5
k1_kernel_rtp5:
    v_cmp_gt_u32 vcc, s51, v21
k1_kernel_rtq5:
    v_mul_u32_u24 v21, 1280, v21
    v_lshl_add_u32 v29, v22, 4, v21
    v_cndmask_b32 v29, v30, v29, vcc
    s_waitcnt vmcnt(0)
    s_barrier
    s_add_u32 m0, s24, 16384
    s_nop 0
    buffer_load_dwordx4 v8, s[4:7], s21 offen offset:0  lds
    buffer_load_dwordx4 v9, s[4:7], s21 offen offset:1024  lds
    buffer_load_dwordx4 v10, s[4:7], s21 offen offset:2048  lds
    buffer_load_dwordx4 v11, s[4:7], s21 offen offset:3072  lds
    s_add_u32 s21, s21, 128
    s_add_u32 s45, s45, 1
    s_cmp_lg_u32 s45, 10
    s_cbranch_scc1 k1_kernel_u3_done
    s_mov_b32 s21, s53
    s_mov_b32 s45, 0
k1_kernel_u3_done:
    s_add_u32 m0, s20, 20480
    s_nop 0
    buffer_load_dwordx4 v12, s[8:11], s22 offen offset:0 lds
    buffer_load_dwordx4 v13, s[8:11], s22 offen offset:1024 lds
    buffer_load_dwordx4 v14, s[8:11], s22 offen offset:2048 lds
    buffer_load_dwordx4 v15, s[8:11], s22 offen offset:3072 lds
    s_add_u32 m0, s20, 24576
    s_nop 0
    buffer_load_dwordx4 v16, s[8:11], s22 offen offset:0 lds
    s_add_u32 s22, s22, s23
    s_add_u32 s46, s46, 1
    s_cmp_lg_u32 s46, 10
    s_cbranch_scc1 k1_kernel_u4_done
    s_mov_b32 s22, s44
    s_mov_b32 s46, 0
k1_kernel_u4_done:
    s_add_u32 m0, s24, 32768
    s_nop 0
    buffer_load_dwordx4 v8, s[4:7], s21 offen offset:0  lds
    buffer_load_dwordx4 v9, s[4:7], s21 offen offset:1024  lds
    buffer_load_dwordx4 v10, s[4:7], s21 offen offset:2048  lds
    buffer_load_dwordx4 v11, s[4:7], s21 offen offset:3072  lds
    s_add_u32 s21, s21, 128
    s_add_u32 s45, s45, 1
    s_cmp_lg_u32 s45, 10
    s_cbranch_scc1 k1_kernel_u5_done
    s_mov_b32 s21, s53
    s_mov_b32 s45, 0
k1_kernel_u5_done:
    s_add_u32 m0, s20, 40960
    s_nop 0
    buffer_load_dwordx4 v12, s[8:11], s22 offen offset:0 lds
    buffer_load_dwordx4 v13, s[8:11], s22 offen offset:1024 lds
    buffer_load_dwordx4 v14, s[8:11], s22 offen offset:2048 lds
    buffer_load_dwordx4 v15, s[8:11], s22 offen offset:3072 lds
    s_add_u32 m0, s20, 45056
    s_nop 0
    buffer_load_dwordx4 v16, s[8:11], s22 offen offset:0 lds
    s_add_u32 s22, s22, s23
    s_add_u32 s46, s46, 1
    s_cmp_lg_u32 s46, 10
    s_cbranch_scc1 k1_kernel_u6_done
    s_mov_b32 s22, s44
    s_mov_b32 s46, 0
k1_kernel_u6_done:
    s_waitcnt vmcnt(9)
    s_barrier
    s_add_u32 m0, s20, 0
    s_nop 0
    buffer_load_dwordx4 v12, s[8:11], s22 offen offset:0 lds
    buffer_load_dwordx4 v13, s[8:11], s22 offen offset:1024 lds
    buffer_load_dwordx4 v14, s[8:11], s22 offen offset:2048 lds
    buffer_load_dwordx4 v15, s[8:11], s22 offen offset:3072 lds
    s_add_u32 m0, s20, 4096
    s_nop 0
    buffer_load_dwordx4 v16, s[8:11], s22 offen offset:0 lds
    s_add_u32 s22, s22, s23
    s_add_u32 s46, s46, 1
    s_cmp_lg_u32 s46, 10
    s_cbranch_scc1 k1_kernel_u7_done
    s_mov_b32 s22, s44
    s_mov_b32 s46, 0
k1_kernel_u7_done:
    s_add_u32 m0, s24, 0
    s_nop 0
    buffer_load_dwordx4 v8, s[4:7], s21 offen offset:0  lds
    buffer_load_dwordx4 v9, s[4:7], s21 offen offset:1024  lds
    buffer_load_dwordx4 v10, s[4:7], s21 offen offset:2048  lds
    buffer_load_dwordx4 v11, s[4:7], s21 offen offset:3072  lds
    s_add_u32 s21, s21, 128
    s_add_u32 s45, s45, 1
    s_cmp_lg_u32 s45, 10
    s_cbranch_scc1 k1_kernel_u8_done
    s_mov_b32 s21, s53
    s_mov_b32 s45, 0
k1_kernel_u8_done:
    s_waitcnt vmcnt(9)
    s_barrier
    s_add_u32 m0, s20, 20480
    s_nop 0
    buffer_load_dwordx4 v12, s[8:11], s22 offen offset:0 lds
    buffer_load_dwordx4 v13, s[8:11], s22 offen offset:1024 lds
    buffer_load_dwordx4 v14, s[8:11], s22 offen offset:2048 lds
    buffer_load_dwordx4 v15, s[8:11], s22 offen offset:3072 lds
    s_add_u32 m0, s20, 24576
    s_nop 0
    buffer_load_dwordx4 v16, s[8:11], s22 offen offset:0 lds
    s_add_u32 s22, s22, s23
    s_add_u32 s46, s46, 1
    s_cmp_lg_u32 s46, 10
    s_cbranch_scc1 k1_kernel_u9_done
    s_mov_b32 s22, s44
    s_mov_b32 s46, 0
k1_kernel_u9_done:
    s_add_u32 m0, s24, 16384
    s_nop 0
    buffer_load_dwordx4 v8, s[4:7], s21 offen offset:0  lds
    buffer_load_dwordx4 v9, s[4:7], s21 offen offset:1024  lds
    buffer_load_dwordx4 v10, s[4:7], s21 offen offset:2048  lds
    buffer_load_dwordx4 v11, s[4:7], s21 offen offset:3072  lds
    s_add_u32 s21, s21, 128
    s_add_u32 s45, s45, 1
    s_cmp_lg_u32 s45, 10
    s_cbranch_scc1 k1_kernel_u10_done
    s_mov_b32 s21, s53
    s_mov_b32 s45, 0
k1_kernel_u10_done:
    s_add_u32 m0, s50, 0
    s_nop 0
    buffer_load_dwordx4 v24, s[12:15], s49 offen lds
    s_waitcnt vmcnt(10)
    s_barrier
    s_add_u32 m0, s20, 40960
    s_nop 0
    buffer_load_dwordx4 v12, s[8:11], s22 offen offset:0 lds
    buffer_load_dwordx4 v13, s[8:11], s22 offen offset:1024 lds
    buffer_load_dwordx4 v14, s[8:11], s22 offen offset:2048 lds
    buffer_load_dwordx4 v15, s[8:11], s22 offen offset:3072 lds
    s_add_u32 m0, s20, 45056
    s_nop 0
    buffer_load_dwordx4 v16, s[8:11], s22 offen offset:0 lds
    s_add_u32 s22, s22, s23
    s_add_u32 s46, s46, 1
    s_cmp_lg_u32 s46, 10
    s_cbranch_scc1 k1_kernel_u11_done
    s_mov_b32 s22, s44
    s_mov_b32 s46, 0
k1_kernel_u11_done:
    s_add_u32 m0, s24, 32768
    s_nop 0
    buffer_load_dwordx4 v8, s[4:7], s21 offen offset:0  lds
    buffer_load_dwordx4 v9, s[4:7], s21 offen offset:1024  lds
    buffer_load_dwordx4 v10, s[4:7], s21 offen offset:2048  lds
    buffer_load_dwordx4 v11, s[4:7], s21 offen offset:3072  lds
    s_add_u32 s21, s21, 128
    s_add_u32 s45, s45, 1
    s_cmp_lg_u32 s45, 10
    s_cbranch_scc1 k1_kernel_u12_done
    s_mov_b32 s21, s53
    s_mov_b32 s45, 0
k1_kernel_u12_done:
    s_add_u32 m0, s50, 1024
    s_nop 0
    buffer_load_dwordx4 v25, s[12:15], s49 offen lds
    s_waitcnt vmcnt(11)
    s_barrier
    s_add_u32 m0, s20, 0
    s_nop 0
    buffer_load_dwordx4 v12, s[8:11], s22 offen offset:0 lds
    buffer_load_dwordx4 v13, s[8:11], s22 offen offset:1024 lds
    buffer_load_dwordx4 v14, s[8:11], s22 offen offset:2048 lds
    buffer_load_dwordx4 v15, s[8:11], s22 offen offset:3072 lds
    s_add_u32 m0, s20, 4096
    s_nop 0
    buffer_load_dwordx4 v16, s[8:11], s22 offen offset:0 lds
    s_add_u32 s22, s22, s23
    s_add_u32 s46, s46, 1
    s_cmp_lg_u32 s46, 10
    s_cbranch_scc1 k1_kernel_u13_done
    s_mov_b32 s22, s44
    s_mov_b32 s46, 0
k1_kernel_u13_done:
    s_add_u32 m0, s24, 0
    s_nop 0
    buffer_load_dwordx4 v8, s[4:7], s21 offen offset:0  lds
    buffer_load_dwordx4 v9, s[4:7], s21 offen offset:1024  lds
    buffer_load_dwordx4 v10, s[4:7], s21 offen offset:2048  lds
    buffer_load_dwordx4 v11, s[4:7], s21 offen offset:3072  lds
    s_add_u32 s21, s21, 128
    s_add_u32 s45, s45, 1
    s_cmp_lg_u32 s45, 10
    s_cbranch_scc1 k1_kernel_u14_done
    s_mov_b32 s21, s53
    s_mov_b32 s45, 0
k1_kernel_u14_done:
    s_add_u32 m0, s50, 2048
    s_nop 0
    buffer_load_dwordx4 v26, s[12:15], s49 offen lds
    s_waitcnt vmcnt(11)
    s_barrier
    s_add_u32 m0, s20, 20480
    s_nop 0
    buffer_load_dwordx4 v12, s[8:11], s22 offen offset:0 lds
    buffer_load_dwordx4 v13, s[8:11], s22 offen offset:1024 lds
    buffer_load_dwordx4 v14, s[8:11], s22 offen offset:2048 lds
    buffer_load_dwordx4 v15, s[8:11], s22 offen offset:3072 lds
    s_add_u32 m0, s20, 24576
    s_nop 0
    buffer_load_dwordx4 v16, s[8:11], s22 offen offset:0 lds
    s_add_u32 s22, s22, s23
    s_add_u32 s46, s46, 1
    s_cmp_lg_u32 s46, 10
    s_cbranch_scc1 k1_kernel_u15_done
    s_mov_b32 s22, s44
    s_mov_b32 s46, 0
k1_kernel_u15_done:
    s_add_u32 m0, s24, 16384
    s_nop 0
    buffer_load_dwordx4 v8, s[4:7], s21 offen offset:0  lds
    buffer_load_dwordx4 v9, s[4:7], s21 offen offset:1024  lds
    buffer_load_dwordx4 v10, s[4:7], s21 offen offset:2048  lds
    buffer_load_dwordx4 v11, s[4:7], s21 offen offset:3072  lds
    s_add_u32 s21, s21, 128
    s_add_u32 s45, s45, 1
    s_cmp_lg_u32 s45, 10
    s_cbranch_scc1 k1_kernel_u16_done
    s_mov_b32 s21, s53
    s_mov_b32 s45, 0
k1_kernel_u16_done:
    s_add_u32 m0, s50, 3072
    s_nop 0
    buffer_load_dwordx4 v27, s[12:15], s49 offen lds
    s_waitcnt vmcnt(11)
    s_barrier
    s_add_u32 m0, s20, 40960
    s_nop 0
    buffer_load_dwordx4 v12, s[8:11], s22 offen offset:0 lds
    buffer_load_dwordx4 v13, s[8:11], s22 offen offset:1024 lds
    buffer_load_dwordx4 v14, s[8:11], s22 offen offset:2048 lds
    buffer_load_dwordx4 v15, s[8:11], s22 offen offset:3072 lds
    s_add_u32 m0, s20, 45056
    s_nop 0
    buffer_load_dwordx4 v16, s[8:11], s22 offen offset:0 lds
    s_add_u32 s22, s22, s23
    s_add_u32 s46, s46, 1
    s_cmp_lg_u32 s46, 10
    s_cbranch_scc1 k1_kernel_u17_done
    s_mov_b32 s22, s44
    s_mov_b32 s46, 0
k1_kernel_u17_done:
    s_add_u32 m0, s24, 32768
    s_nop 0
    buffer_load_dwordx4 v8, s[4:7], s21 offen offset:0  lds
    buffer_load_dwordx4 v9, s[4:7], s21 offen offset:1024  lds
    buffer_load_dwordx4 v10, s[4:7], s21 offen offset:2048  lds
    buffer_load_dwordx4 v11, s[4:7], s21 offen offset:3072  lds
    s_add_u32 s21, s21, 128
    s_add_u32 s45, s45, 1
    s_cmp_lg_u32 s45, 10
    s_cbranch_scc1 k1_kernel_u18_done
    s_mov_b32 s21, s53
    s_mov_b32 s45, 0
k1_kernel_u18_done:
    s_add_u32 m0, s50, 4096
    s_nop 0
    buffer_load_dwordx4 v28, s[12:15], s49 offen lds
    s_waitcnt vmcnt(11)
    s_barrier
    s_add_u32 m0, s20, 0
    s_nop 0
    buffer_load_dwordx4 v12, s[8:11], s22 offen offset:0 lds
    buffer_load_dwordx4 v13, s[8:11], s22 offen offset:1024 lds
    buffer_load_dwordx4 v14, s[8:11], s22 offen offset:2048 lds
    buffer_load_dwordx4 v15, s[8:11], s22 offen offset:3072 lds
    s_add_u32 m0, s20, 4096
    s_nop 0
    buffer_load_dwordx4 v16, s[8:11], s22 offen offset:0 lds
    s_add_u32 s22, s22, s23
    s_add_u32 s46, s46, 1
    s_cmp_lg_u32 s46, 10
    s_cbranch_scc1 k1_kernel_u19_done
    s_mov_b32 s22, s44
    s_mov_b32 s46, 0
k1_kernel_u19_done:
    s_add_u32 m0, s24, 0
    s_nop 0
    buffer_load_dwordx4 v8, s[4:7], s21 offen offset:0  lds
    buffer_load_dwordx4 v9, s[4:7], s21 offen offset:1024  lds
    buffer_load_dwordx4 v10, s[4:7], s21 offen offset:2048  lds
    buffer_load_dwordx4 v11, s[4:7], s21 offen offset:3072  lds
    s_add_u32 s21, s21, 128
    s_add_u32 s45, s45, 1
    s_cmp_lg_u32 s45, 10
    s_cbranch_scc1 k1_kernel_u20_done
    s_mov_b32 s21, s53
    s_mov_b32 s45, 0
k1_kernel_u20_done:
    s_add_u32 m0, s50, 5120
    s_nop 0
    buffer_load_dwordx4 v29, s[12:15], s49 offen lds
    s_waitcnt vmcnt(11)
    s_barrier
    s_waitcnt vmcnt(1)
    s_barrier
    s_waitcnt vmcnt(0)
    s_barrier
    s_barrier
    s_cmp_lg_u32 s26, 0
    s_cbranch_scc1 k1_kernel_nocs
    s_cmp_ge_u32 s2, 240
    s_cbranch_scc1 k1_kernel_nocs
    s_mul_i32 s34, s2, 5462
    s_lshr_b32 s34, s34, 16
    s_mul_i32 s35, s34, 12
    s_sub_u32 s35, s2, s35
    s_mov_b32 s12, s76
    s_mov_b32 s13, s77
    s_mov_b32 s14, 0x1e0000
    s_mov_b32 s15, 0x00020000
    s_mul_i32 s36, s34, 98304
    s_lshl_b32 s37, s35, 8
    s_add_u32 s36, s36, s37
    v_lshrrev_b32 v20, 4, v0
    v_mul_u32_u24 v20, 3072, v20
    v_and_b32 v21, 15, v0
    v_lshl_add_u32 v20, v21, 4, v20
    buffer_load_dwordx4 v[32:35], v20, s[12:15], s36 offen
    s_add_u32 s36, s36, 12288
    buffer_load_dwordx4 v[36:39], v20, s[12:15], s36 offen
    s_add_u32 s36, s36, 12288
    buffer_load_dwordx4 v[40:43], v20, s[12:15], s36 offen
    s_add_u32 s36, s36, 12288
    buffer_load_dwordx4 v[44:47], v20, s[12:15], s36 offen
    s_add_u32 s36, s36, 12288
    buffer_load_dwordx4 v[48:51], v20, s[12:15], s36 offen
    s_add_u32 s36, s36, 12288
    buffer_load_dwordx4 v[52:55], v20, s[12:15], s36 offen
    s_add_u32 s36, s36, 12288
    buffer_load_dwordx4 v[56:59], v20, s[12:15], s36 offen
    s_add_u32 s36, s36, 12288
    buffer_load_dwordx4 v[60:63], v20, s[12:15], s36 offen
    s_add_u32 s36, s36, 12288
    v_mov_b32 v24, 0
    v_mov_b32 v25, 0
    v_mov_b32 v26, 0
    v_mov_b32 v27, 0
    v_mov_b32 v28, 0
    v_mov_b32 v29, 0
    v_mov_b32 v30, 0
    v_mov_b32 v31, 0
    s_mov_b32 s37, 0xffff0000
    s_waitcnt vmcnt(7)
    v_lshlrev_b32 v22, 16, v32
    v_and_b32 v23, s37, v32
    v_add_f32 v24, v24, v22
    v_add_f32 v25, v25, v23
    v_lshlrev_b32 v22, 16, v33
    v_and_b32 v23, s37, v33
    v_add_f32 v26, v26, v22
    v_add_f32 v27, v27, v23
    v_lshlrev_b32 v22, 16, v34
    v_and_b32 v23, s37, v34
    v_add_f32 v28, v28, v22
    v_add_f32 v29, v29, v23
    v_lshlrev_b32 v22, 16, v35
    v_and_b32 v23, s37, v35
    v_add_f32 v30, v30, v22
    v_add_f32 v31, v31, v23
    s_waitcnt vmcnt(6)
    v_lshlrev_b32 v22, 16, v36
    v_and_b32 v23, s37, v36
    v_add_f32 v24, v24, v22
    v_add_f32 v25, v25, v23
    v_lshlrev_b32 v22, 16, v37
    v_and_b32 v23, s37, v37
    v_add_f32 v26, v26, v22
    v_add_f32 v27, v27, v23
    v_lshlrev_b32 v22, 16, v38
    v_and_b32 v23, s37, v38
    v_add_f32 v28, v28, v22
    v_add_f32 v29, v29, v23
    v_lshlrev_b32 v22, 16, v39
    v_and_b32 v23, s37, v39
    v_add_f32 v30, v30, v22
    v_add_f32 v31, v31, v23
    s_waitcnt vmcnt(5)
    v_lshlrev_b32 v22, 16, v40
    v_and_b32 v23, s37, v40
    v_add_f32 v24, v24, v22
    v_add_f32 v25, v25, v23
    v_lshlrev_b32 v22, 16, v41
    v_and_b32 v23, s37, v41
    v_add_f32 v26, v26, v22
    v_add_f32 v27, v27, v23
    v_lshlrev_b32 v22, 16, v42
    v_and_b32 v23, s37, v42
    v_add_f32 v28, v28, v22
    v_add_f32 v29, v29, v23
    v_lshlrev_b32 v22, 16, v43
    v_and_b32 v23, s37, v43
    v_add_f32 v30, v30, v22
    v_add_f32 v31, v31, v23
    s_waitcnt vmcnt(4)
    v_lshlrev_b32 v22, 16, v44
    v_and_b32 v23, s37, v44
    v_add_f32 v24, v24, v22
    v_add_f32 v25, v25, v23
    v_lshlrev_b32 v22, 16, v45
    v_and_b32 v23, s37, v45
    v_add_f32 v26, v26, v22
    v_add_f32 v27, v27, v23
    v_lshlrev_b32 v22, 16, v46
    v_and_b32 v23, s37, v46
    v_add_f32 v28, v28, v22
    v_add_f32 v29, v29, v23
    v_lshlrev_b32 v22, 16, v47
    v_and_b32 v23, s37, v47
    v_add_f32 v30, v30, v22
    v_add_f32 v31, v31, v23
    s_waitcnt vmcnt(3)
    v_lshlrev_b32 v22, 16, v48
    v_and_b32 v23, s37, v48
    v_add_f32 v24, v24, v22
    v_add_f32 v25, v25, v23
    v_lshlrev_b32 v22, 16, v49
    v_and_b32 v23, s37, v49
    v_add_f32 v26, v26, v22
    v_add_f32 v27, v27, v23
    v_lshlrev_b32 v22, 16, v50
    v_and_b32 v23, s37, v50
    v_add_f32 v28, v28, v22
    v_add_f32 v29, v29, v23
    v_lshlrev_b32 v22, 16, v51
    v_and_b32 v23, s37, v51
    v_add_f32 v30, v30, v22
    v_add_f32 v31, v31, v23
    s_waitcnt vmcnt(2)
    v_lshlrev_b32 v22, 16, v52
    v_and_b32 v23, s37, v52
    v_add_f32 v24, v24, v22
    v_add_f32 v25, v25, v23
    v_lshlrev_b32 v22, 16, v53
    v_and_b32 v23, s37, v53
    v_add_f32 v26, v26, v22
    v_add_f32 v27, v27, v23
    v_lshlrev_b32 v22, 16, v54
    v_and_b32 v23, s37, v54
    v_add_f32 v28, v28, v22
    v_add_f32 v29, v29, v23
    v_lshlrev_b32 v22, 16, v55
    v_and_b32 v23, s37, v55
    v_add_f32 v30, v30, v22
    v_add_f32 v31, v31, v23
    s_waitcnt vmcnt(1)
    v_lshlrev_b32 v22, 16, v56
    v_and_b32 v23, s37, v56
    v_add_f32 v24, v24, v22
    v_add_f32 v25, v25, v23
    v_lshlrev_b32 v22, 16, v57
    v_and_b32 v23, s37, v57
    v_add_f32 v26, v26, v22
    v_add_f32 v27, v27, v23
    v_lshlrev_b32 v22, 16, v58
    v_and_b32 v23, s37, v58
    v_add_f32 v28, v28, v22
    v_add_f32 v29, v29, v23
    v_lshlrev_b32 v22, 16, v59
    v_and_b32 v23, s37, v59
    v_add_f32 v30, v30, v22
    v_add_f32 v31, v31, v23
    s_waitcnt vmcnt(0)
    v_lshlrev_b32 v22, 16, v60
    v_and_b32 v23, s37, v60
    v_add_f32 v24, v24, v22
    v_add_f32 v25, v25, v23
    v_lshlrev_b32 v22, 16, v61
    v_and_b32 v23, s37, v61
    v_add_f32 v26, v26, v22
    v_add_f32 v27, v27, v23
    v_lshlrev_b32 v22, 16, v62
    v_and_b32 v23, s37, v62
    v_add_f32 v28, v28, v22
    v_add_f32 v29, v29, v23
    v_lshlrev_b32 v22, 16, v63
    v_and_b32 v23, s37, v63
    v_add_f32 v30, v30, v22
    v_add_f32 v31, v31, v23
    v_mov_b32 v32, v24
    v_mov_b32 v33, v25
    v_mov_b32 v34, v26
    v_mov_b32 v35, v27
    v_mov_b32 v36, v28
    v_mov_b32 v37, v29
    v_mov_b32 v38, v30
    v_mov_b32 v39, v31
    s_nop 1
    v_permlane16_swap_b32 v32, v24
    v_permlane16_swap_b32 v33, v25
    v_permlane16_swap_b32 v34, v26
    v_permlane16_swap_b32 v35, v27
    v_permlane16_swap_b32 v36, v28
    v_permlane16_swap_b32 v37, v29
    v_permlane16_swap_b32 v38, v30
    v_permlane16_swap_b32 v39, v31
    s_nop 1
    v_add_f32 v24, v32, v24
    v_add_f32 v25, v33, v25
    v_add_f32 v26, v34, v26
    v_add_f32 v27, v35, v27
    v_add_f32 v28, v36, v28
    v_add_f32 v29, v37, v29
    v_add_f32 v30, v38, v30
    v_add_f32 v31, v39, v31
    v_mov_b32 v32, v24
    v_mov_b32 v33, v25
    v_mov_b32 v34, v26
    v_mov_b32 v35, v27
    v_mov_b32 v36, v28
    v_mov_b32 v37, v29
    v_mov_b32 v38, v30
    v_mov_b32 v39, v31
    s_nop 1
    v_permlane32_swap_b32 v32, v24
    v_permlane32_swap_b32 v33, v25
    v_permlane32_swap_b32 v34, v26
    v_permlane32_swap_b32 v35, v27
    v_permlane32_swap_b32 v36, v28
    v_permlane32_swap_b32 v37, v29
    v_permlane32_swap_b32 v38, v30
    v_permlane32_swap_b32 v39, v31
    s_nop 1
    v_add_f32 v24, v32, v24
    v_add_f32 v25, v33, v25
    v_add_f32 v26, v34, v26
    v_add_f32 v27, v35, v27
    v_add_f32 v28, v36, v28
    v_add_f32 v29, v37, v29
    v_add_f32 v30, v38, v30
    v_add_f32 v31, v39, v31
    s_add_u32 s12, s32, 0x1a80000
    s_addc_u32 s13, s33, 0
    s_mov_b32 s14, 0x1e000
    s_mov_b32 s15, 0x00020000
    s_mul_i32 s36, s34, 6144
    s_lshl_b32 s37, s35, 9
    s_add_u32 s36, s36, s37
    v_lshlrev_b32 v20, 5, v21
    s_mov_b32 exec_lo, 0xffff
    s_mov_b32 exec_hi, 0
    buffer_store_dwordx4 v[24:27], v20, s[12:15], s36 offen
    buffer_store_dwordx4 v[28:31], v20, s[12:15], s36 offen offset:16
k1_kernel_nocs:
    s_endpgm
k1_kernel_compute:
    s_waitcnt lgkmcnt(0)
    s_cmp_eq_u32 s26, 0
    s_cbranch_scc1 k1_kernel_notouch
    s_cmp_eq_u32 s26, 1
    s_cselect_b32 s4, s64, s66
    s_cselect_b32 s5, s65, s67
    s_cmp_eq_u32 s26, 3
    s_cselect_b32 s4, s72, s4
    s_cselect_b32 s5, s73, s5
    s_mov_b32 s6, 0xc8000
    s_cselect_b32 s6, s6, 0x258000
    s_mov_b32 s7, 0x00020000
    v_and_b32 v5, 1, v0
    v_lshlrev_b32 v5, 21, v5
    buffer_load_dword v215, v5, s[4:7], 0 offen
k1_kernel_notouch:
    v_and_b32 v5, 15, v0
    v_lshrrev_b32 v6, 4, v0
    v_lshrrev_b32 v7, 1, v5
    v_xor_b32 v7, v7, v6
    s_mul_i32 s30, s28, 64
    v_add_u32 v5, s30, v5
    v_lshlrev_b32 v5, 7, v5
    v_lshl_add_u32 v1, v7, 4, v5
    s_lshl_b32 s30, s29, 12
    v_xor_b32 v212, 0x1000, v1
    v_xor_b32 v1, s30, v1
    v_xor_b32 v212, s30, v212
    v_xor_b32 v2, 64, v1
    v_xor_b32 v213, 64, v212
    v_lshrrev_b32 v5, 2, v0
    v_and_b32 v5, 3, v5
    v_lshl_add_u32 v5, v6, 3, v5
    v_mul_u32_u24 v5, 320, v5
    v_and_b32 v7, 3, v0
    v_lshl_add_u32 v5, v7, 3, v5
    v_add_u32 v5, 49152, v5
    v_and_b32 v6, 1, v6
    v_lshlrev_b32 v6, 5, v6
    s_mul_i32 s30, s29, 160
    v_add_u32 v5, s30, v5
    s_lshl_b32 s30, s29, 1
    s_sub_u32 s30, 1, s30
    v_mul_lo_u32 v6, v6, s30
    v_add_u32 v3, v5, v6
    v_sub_u32 v4, v5, v6
    s_mov_b32 s27, 0
    s_mov_b32 s16, 0
    v_mov_b32 v80, 0
    v_mov_b32 v81, 0
    v_mov_b32 v82, 0
    v_mov_b32 v83, 0
    v_mov_b32 v84, 0
    v_mov_b32 v85, 0
    v_mov_b32 v86, 0
    v_mov_b32 v87, 0
    v_mov_b32 v88, 0
    v_mov_b32 v89, 0
    v_mov_b32 v90, 0
    v_mov_b32 v91, 0
    v_mov_b32 v92, 0
    v_mov_b32 v93, 0
    v_mov_b32 v94, 0
    v_mov_b32 v95, 0
    v_mov_b32 v96, 0
    v_mov_b32 v97, 0
    v_mov_b32 v98, 0
    v_mov_b32 v99, 0
    v_mov_b32 v100, 0
    v_mov_b32 v101, 0
    v_mov_b32 v102, 0
    v_mov_b32 v103, 0
    v_mov_b32 v104, 0
    v_mov_b32 v105, 0
    v_mov_b32 v106, 0
    v_mov_b32 v107, 0
    v_mov_b32 v108, 0
    v_mov_b32 v109, 0
    v_mov_b32 v110, 0
    v_mov_b32 v111, 0
    v_mov_b32 v112, 0
    v_mov_b32 v113, 0
    v_mov_b32 v114, 0
    v_mov_b32 v115, 0
    v_mov_b32 v116, 0
    v_mov_b32 v117, 0
    v_mov_b32 v118, 0
    v_mov_b32 v119, 0
    v_mov_b32 v120, 0
    v_mov_b32 v121, 0
    v_mov_b32 v122, 0
    v_mov_b32 v123, 0
    v_mov_b32 v124, 0
    v_mov_b32 v125, 0
    v_mov_b32 v126, 0
    v_mov_b32 v127, 0
    v_mov_b32 v128, 0
    v_mov_b32 v129, 0
    v_mov_b32 v130, 0
    v_mov_b32 v131, 0
    v_mov_b32 v132, 0
    v_mov_b32 v133, 0
    v_mov_b32 v134, 0
    v_mov_b32 v135, 0
    v_mov_b32 v136, 0
    v_mov_b32 v137, 0
    v_mov_b32 v138, 0
    v_mov_b32 v139, 0
    v_mov_b32 v140, 0
    v_mov_b32 v141, 0
    v_mov_b32 v142, 0
    v_mov_b32 v143, 0
    v_mov_b32 v144, 0
    v_mov_b32 v145, 0
    v_mov_b32 v146, 0
    v_mov_b32 v147, 0
    v_mov_b32 v148, 0
    v_mov_b32 v149, 0
    v_mov_b32 v150, 0
    v_mov_b32 v151, 0
    v_mov_b32 v152, 0
    v_mov_b32 v153, 0
    v_mov_b32 v154, 0
    v_mov_b32 v155, 0
    v_mov_b32 v156, 0
    v_mov_b32 v157, 0
    v_mov_b32 v158, 0
    v_mov_b32 v159, 0
    v_mov_b32 v160, 0
    v_mov_b32 v161, 0
    v_mov_b32 v162, 0
    v_mov_b32 v163, 0
    v_mov_b32 v164, 0
    v_mov_b32 v165, 0
    v_mov_b32 v166, 0
    v_mov_b32 v167, 0
    v_mov_b32 v168, 0
    v_mov_b32 v169, 0
    v_mov_b32 v170, 0
    v_mov_b32 v171, 0
    v_mov_b32 v172, 0
    v_mov_b32 v173, 0
    v_mov_b32 v174, 0
    v_mov_b32 v175, 0
    v_mov_b32 v176, 0
    v_mov_b32 v177, 0
    v_mov_b32 v178, 0
    v_mov_b32 v179, 0
    v_mov_b32 v180, 0
    v_mov_b32 v181, 0
    v_mov_b32 v182, 0
    v_mov_b32 v183, 0
    v_mov_b32 v184, 0
    v_mov_b32 v185, 0
    v_mov_b32 v186, 0
    v_mov_b32 v187, 0
    v_mov_b32 v188, 0
    v_mov_b32 v189, 0
    v_mov_b32 v190, 0
    v_mov_b32 v191, 0
    v_mov_b32 v192, 0
    v_mov_b32 v193, 0
    v_mov_b32 v194, 0
    v_mov_b32 v195, 0
    v_mov_b32 v196, 0x3f803f80
    v_mov_b32 v197, 0x3f803f80
    v_mov_b32 v198, 0x3f803f80
    v_mov_b32 v199, 0x3f803f80
    s_and_b32 s3, s2, 7
    s_lshr_b32 s16, s2, 3
    s_and_b32 s17, s3, 1
    s_lshl_b32 s17, s17, 3
    s_and_b32 s47, s16, 7
    s_add_u32 s40, s17, s47
    s_lshr_b32 s17, s3, 1
    s_lshr_b32 s48, s16, 3
    s_sub_u32 s41, 3, s48
    s_lshl_b32 s41, s41, 2
    s_add_u32 s41, s41, s17
    s_lshl_b32 s42, s40, 7
    s_cmp_lt_u32 s41, 12
    s_mov_b32 s43, 1280
    s_cselect_b32 s43, 3840, s43
    s_cselect_b32 s30, 0, 12
    s_sub_u32 s30, s41, s30
    s_mul_i32 s44, s30, 320
    s_lshl_b32 s23, s43, 6
    s_mov_b32 s27, 0
    s_mov_b32 s16, 0
    s_cmp_lg_u32 s2, 0
    s_cbranch_scc1 k1_kernel_nz
    s_cmp_lg_u32 s26, 0
    s_cbranch_scc1 k1_kernel_nz
    s_add_u32 s12, s32, 0x1a70000
    s_addc_u32 s13, s33, 0
    s_mov_b32 s14, 0x4000
    s_mov_b32 s15, 0x00020000
    v_lshlrev_b32 v5, 8, v0
    v_mov_b32 v6, 0
    buffer_store_dword v6, v5, s[12:15], 0 offen
k1_kernel_nz:
    s_sub_u32 s30, s41, 8
    s_cmp_lt_u32 s30, 4
    s_cbranch_scc1 k1_kernel_vloop
    s_barrier
    ds_read_b128 v[8:11], v1 offset:0
    ds_read_b128 v[12:15], v1 offset:2048
    ds_read_b128 v[16:19], v212 offset:0
    ds_read_b128 v[20:23], v212 offset:2048
    ds_read_b64_tr_b16 v[24:25], v3 offset:0
    ds_read_b64_tr_b16 v[26:27], v3 offset:1280
    ds_read_b64_tr_b16 v[28:29], v4 offset:32
    ds_read_b64_tr_b16 v[30:31], v4 offset:1312
    ds_read_b64_tr_b16 v[32:33], v3 offset:64
    ds_read_b64_tr_b16 v[34:35], v3 offset:1344
    ds_read_b64_tr_b16 v[36:37], v4 offset:96
    ds_read_b64_tr_b16 v[38:39], v4 offset:1376
    ds_read_b64_tr_b16 v[40:41], v3 offset:128
    ds_read_b64_tr_b16 v[42:43], v3 offset:1408
    s_mov_b32 s19, 10
k1_kernel_loop:
    s_waitcnt lgkmcnt(0)
    v_mfma_f32_16x16x32_bf16 v[80:83], v[24:27], v[8:11], v[80:83]
    ds_read_b128 v[44:47], v2 offset:0
    v_mfma_f32_16x16x32_bf16 v[100:103], v[24:27], v[12:15], v[100:103]
    ds_read_b128 v[48:51], v2 offset:2048
    v_mfma_f32_16x16x32_bf16 v[120:123], v[24:27], v[16:19], v[120:123]
    ds_read_b128 v[52:55], v213 offset:0
    v_mfma_f32_16x16x32_bf16 v[140:143], v[24:27], v[20:23], v[140:143]
    ds_read_b128 v[56:59], v213 offset:2048
    v_mfma_f32_16x16x32_bf16 v[84:87], v[28:31], v[8:11], v[84:87]
    ds_read_b64_tr_b16 v[60:61], v3 offset:10240
    v_mfma_f32_16x16x32_bf16 v[104:107], v[28:31], v[12:15], v[104:107]
    ds_read_b64_tr_b16 v[62:63], v3 offset:11520
    v_mfma_f32_16x16x32_bf16 v[124:127], v[28:31], v[16:19], v[124:127]
    ds_read_b64_tr_b16 v[64:65], v4 offset:10272
    v_mfma_f32_16x16x32_bf16 v[144:147], v[28:31], v[20:23], v[144:147]
    ds_read_b64_tr_b16 v[66:67], v4 offset:11552
    v_mfma_f32_16x16x32_bf16 v[88:91], v[32:35], v[8:11], v[88:91]
    ds_read_b64_tr_b16 v[68:69], v3 offset:10304
    v_mfma_f32_16x16x32_bf16 v[108:111], v[32:35], v[12:15], v[108:111]
    ds_read_b64_tr_b16 v[70:71], v3 offset:11584
    v_mfma_f32_16x16x32_bf16 v[128:131], v[32:35], v[16:19], v[128:131]
    ds_read_b64_tr_b16 v[72:73], v4 offset:10336
    v_mfma_f32_16x16x32_bf16 v[148:151], v[32:35], v[20:23], v[148:151]
    ds_read_b64_tr_b16 v[74:75], v4 offset:11616
    v_mfma_f32_16x16x32_bf16 v[92:95], v[36:39], v[8:11], v[92:95]
    ds_read_b64_tr_b16 v[76:77], v3 offset:10368
    v_mfma_f32_16x16x32_bf16 v[112:115], v[36:39], v[12:15], v[112:115]
    ds_read_b64_tr_b16 v[78:79], v3 offset:11648
    v_mfma_f32_16x16x32_bf16 v[132:135], v[36:39], v[16:19], v[132:135]
    v_mfma_f32_16x16x32_bf16 v[152:155], v[36:39], v[20:23], v[152:155]
    v_mfma_f32_16x16x32_bf16 v[96:99], v[40:43], v[8:11], v[96:99]
    v_mfma_f32_16x16x32_bf16 v[116:119], v[40:43], v[12:15], v[116:119]
    v_mfma_f32_16x16x32_bf16 v[136:139], v[40:43], v[16:19], v[136:139]
    v_mfma_f32_16x16x32_bf16 v[156:159], v[40:43], v[20:23], v[156:159]
    v_mfma_f32_16x16x32_bf16 v[180:183], v[196:199], v[8:11], v[180:183]
    v_mfma_f32_16x16x32_bf16 v[188:191], v[8:11], v[8:11], v[188:191]
    v_mfma_f32_16x16x32_bf16 v[184:187], v[196:199], v[12:15], v[184:187]
    v_mfma_f32_16x16x32_bf16 v[192:195], v[12:15], v[12:15], v[192:195]
    s_cmp_lg_u32 s28, 0
    s_cbranch_scc1 k1_kernel_css0
    v_mfma_f32_16x16x32_bf16 v[160:163], v[24:27], v[196:199], v[160:163]
    v_mfma_f32_16x16x32_bf16 v[164:167], v[28:31], v[196:199], v[164:167]
    v_mfma_f32_16x16x32_bf16 v[168:171], v[32:35], v[196:199], v[168:171]
    v_mfma_f32_16x16x32_bf16 v[172:175], v[36:39], v[196:199], v[172:175]
    v_mfma_f32_16x16x32_bf16 v[176:179], v[40:43], v[196:199], v[176:179]
k1_kernel_css0:
    s_waitcnt lgkmcnt(0)
    s_barrier
    v_mfma_f32_16x16x32_bf16 v[80:83], v[60:63], v[44:47], v[80:83]
    s_add_u32 s27, s27, 1
    s_cmp_eq_u32 s27, 3
    v_mfma_f32_16x16x32_bf16 v[100:103], v[60:63], v[48:51], v[100:103]
    s_mov_b32 s25, 16384
    s_cselect_b32 s25, 0xffff8000, s25
    v_mfma_f32_16x16x32_bf16 v[120:123], v[60:63], v[52:55], v[120:123]
    s_cselect_b32 s27, 0, s27
    s_add_u32 s16, s16, 1
    v_mfma_f32_16x16x32_bf16 v[140:143], v[60:63], v[56:59], v[140:143]
    s_cmp_eq_u32 s16, 3
    s_mov_b32 s17, 20480
    v_mfma_f32_16x16x32_bf16 v[84:87], v[64:67], v[44:47], v[84:87]
    s_cselect_b32 s17, 0xffff6000, s17
    s_cselect_b32 s16, 0, s16
    v_mfma_f32_16x16x32_bf16 v[104:107], v[64:67], v[48:51], v[104:107]
    v_add_u32 v1, s25, v1
    v_add_u32 v2, s25, v2
    v_mfma_f32_16x16x32_bf16 v[124:127], v[64:67], v[52:55], v[124:127]
    v_add_u32 v212, s25, v212
    v_add_u32 v213, s25, v213
    v_mfma_f32_16x16x32_bf16 v[144:147], v[64:67], v[56:59], v[144:147]
    v_add_u32 v3, s17, v3
    v_add_u32 v4, s17, v4
    v_mfma_f32_16x16x32_bf16 v[88:91], v[68:71], v[44:47], v[88:91]
    ds_read_b128 v[8:11], v1 offset:0
    ds_read_b128 v[12:15], v1 offset:2048
    v_mfma_f32_16x16x32_bf16 v[108:111], v[68:71], v[48:51], v[108:111]
    ds_read_b128 v[16:19], v212 offset:0
    ds_read_b128 v[20:23], v212 offset:2048
    v_mfma_f32_16x16x32_bf16 v[128:131], v[68:71], v[52:55], v[128:131]
    ds_read_b64_tr_b16 v[24:25], v3 offset:0
    v_mfma_f32_16x16x32_bf16 v[148:151], v[68:71], v[56:59], v[148:151]
    ds_read_b64_tr_b16 v[26:27], v3 offset:1280
    v_mfma_f32_16x16x32_bf16 v[92:95], v[72:75], v[44:47], v[92:95]
    ds_read_b64_tr_b16 v[28:29], v4 offset:32
    v_mfma_f32_16x16x32_bf16 v[112:115], v[72:75], v[48:51], v[112:115]
    ds_read_b64_tr_b16 v[30:31], v4 offset:1312
    v_mfma_f32_16x16x32_bf16 v[132:135], v[72:75], v[52:55], v[132:135]
    ds_read_b64_tr_b16 v[32:33], v3 offset:64
    v_mfma_f32_16x16x32_bf16 v[152:155], v[72:75], v[56:59], v[152:155]
    ds_read_b64_tr_b16 v[34:35], v3 offset:1344
    v_mfma_f32_16x16x32_bf16 v[96:99], v[76:79], v[44:47], v[96:99]
    ds_read_b64_tr_b16 v[36:37], v4 offset:96
    v_mfma_f32_16x16x32_bf16 v[116:119], v[76:79], v[48:51], v[116:119]
    ds_read_b64_tr_b16 v[38:39], v4 offset:1376
    v_mfma_f32_16x16x32_bf16 v[136:139], v[76:79], v[52:55], v[136:139]
    ds_read_b64_tr_b16 v[40:41], v3 offset:128
    v_mfma_f32_16x16x32_bf16 v[156:159], v[76:79], v[56:59], v[156:159]
    ds_read_b64_tr_b16 v[42:43], v3 offset:1408
    v_mfma_f32_16x16x32_bf16 v[180:183], v[196:199], v[44:47], v[180:183]
    v_mfma_f32_16x16x32_bf16 v[188:191], v[44:47], v[44:47], v[188:191]
    v_mfma_f32_16x16x32_bf16 v[184:187], v[196:199], v[48:51], v[184:187]
    v_mfma_f32_16x16x32_bf16 v[192:195], v[48:51], v[48:51], v[192:195]
    s_cmp_lg_u32 s28, 1
    s_cbranch_scc1 k1_kernel_css1
    v_mfma_f32_16x16x32_bf16 v[160:163], v[60:63], v[196:199], v[160:163]
    v_mfma_f32_16x16x32_bf16 v[164:167], v[64:67], v[196:199], v[164:167]
    v_mfma_f32_16x16x32_bf16 v[168:171], v[68:71], v[196:199], v[168:171]
    v_mfma_f32_16x16x32_bf16 v[172:175], v[72:75], v[196:199], v[172:175]
    v_mfma_f32_16x16x32_bf16 v[176:179], v[76:79], v[196:199], v[176:179]
k1_kernel_css1:
    s_sub_u32 s19, s19, 1
    s_cmp_lg_u32 s19, 0
    s_cbranch_scc1 k1_kernel_loop
    s_waitcnt lgkmcnt(0)
    s_branch k1_kernel_stats
k1_kernel_vloop:
    s_barrier
    ds_read_b128 v[8:11], v1 offset:0
    ds_read_b128 v[12:15], v1 offset:2048
    ds_read_b128 v[16:19], v212 offset:0
    ds_read_b128 v[20:23], v212 offset:2048
    ds_read_b64_tr_b16 v[24:25], v3 offset:0
    ds_read_b64_tr_b16 v[26:27], v3 offset:1280
    ds_read_b64_tr_b16 v[28:29], v4 offset:32
    ds_read_b64_tr_b16 v[30:31], v4 offset:1312
    ds_read_b64_tr_b16 v[32:33], v3 offset:64
    ds_read_b64_tr_b16 v[34:35], v3 offset:1344
    ds_read_b64_tr_b16 v[36:37], v4 offset:96
    ds_read_b64_tr_b16 v[38:39], v4 offset:1376
    ds_read_b64_tr_b16 v[40:41], v3 offset:128
    ds_read_b64_tr_b16 v[42:43], v3 offset:1408
    s_mov_b32 s19, 10
k1_kernel_loopv:
    s_waitcnt lgkmcnt(0)
    v_mfma_f32_16x16x32_bf16 v[80:83], v[8:11], v[24:27], v[80:83]
    ds_read_b128 v[44:47], v2 offset:0
    v_mfma_f32_16x16x32_bf16 v[100:103], v[12:15], v[24:27], v[100:103]
    ds_read_b128 v[48:51], v2 offset:2048
    v_mfma_f32_16x16x32_bf16 v[120:123], v[16:19], v[24:27], v[120:123]
    ds_read_b128 v[52:55], v213 offset:0
    v_mfma_f32_16x16x32_bf16 v[140:143], v[20:23], v[24:27], v[140:143]
    ds_read_b128 v[56:59], v213 offset:2048
    v_mfma_f32_16x16x32_bf16 v[84:87], v[8:11], v[28:31], v[84:87]
    ds_read_b64_tr_b16 v[60:61], v3 offset:10240
    v_mfma_f32_16x16x32_bf16 v[104:107], v[12:15], v[28:31], v[104:107]
    ds_read_b64_tr_b16 v[62:63], v3 offset:11520
    v_mfma_f32_16x16x32_bf16 v[124:127], v[16:19], v[28:31], v[124:127]
    ds_read_b64_tr_b16 v[64:65], v4 offset:10272
    v_mfma_f32_16x16x32_bf16 v[144:147], v[20:23], v[28:31], v[144:147]
    ds_read_b64_tr_b16 v[66:67], v4 offset:11552
    v_mfma_f32_16x16x32_bf16 v[88:91], v[8:11], v[32:35], v[88:91]
    ds_read_b64_tr_b16 v[68:69], v3 offset:10304
    v_mfma_f32_16x16x32_bf16 v[108:111], v[12:15], v[32:35], v[108:111]
    ds_read_b64_tr_b16 v[70:71], v3 offset:11584
    v_mfma_f32_16x16x32_bf16 v[128:131], v[16:19], v[32:35], v[128:131]
    ds_read_b64_tr_b16 v[72:73], v4 offset:10336
    v_mfma_f32_16x16x32_bf16 v[148:151], v[20:23], v[32:35], v[148:151]
    ds_read_b64_tr_b16 v[74:75], v4 offset:11616
    v_mfma_f32_16x16x32_bf16 v[92:95], v[8:11], v[36:39], v[92:95]
    ds_read_b64_tr_b16 v[76:77], v3 offset:10368
    v_mfma_f32_16x16x32_bf16 v[112:115], v[12:15], v[36:39], v[112:115]
    ds_read_b64_tr_b16 v[78:79], v3 offset:11648
    v_mfma_f32_16x16x32_bf16 v[132:135], v[16:19], v[36:39], v[132:135]
    v_mfma_f32_16x16x32_bf16 v[152:155], v[20:23], v[36:39], v[152:155]
    v_mfma_f32_16x16x32_bf16 v[96:99], v[8:11], v[40:43], v[96:99]
    v_mfma_f32_16x16x32_bf16 v[116:119], v[12:15], v[40:43], v[116:119]
    v_mfma_f32_16x16x32_bf16 v[136:139], v[16:19], v[40:43], v[136:139]
    v_mfma_f32_16x16x32_bf16 v[156:159], v[20:23], v[40:43], v[156:159]
    v_mfma_f32_16x16x32_bf16 v[180:183], v[196:199], v[8:11], v[180:183]
    v_mfma_f32_16x16x32_bf16 v[188:191], v[8:11], v[8:11], v[188:191]
    v_mfma_f32_16x16x32_bf16 v[184:187], v[196:199], v[12:15], v[184:187]
    v_mfma_f32_16x16x32_bf16 v[192:195], v[12:15], v[12:15], v[192:195]
    s_cmp_lg_u32 s28, 0
    s_cbranch_scc1 k1_kernel_csv0
    v_mfma_f32_16x16x32_bf16 v[160:163], v[196:199], v[24:27], v[160:163]
    v_mfma_f32_16x16x32_bf16 v[164:167], v[196:199], v[28:31], v[164:167]
    v_mfma_f32_16x16x32_bf16 v[168:171], v[196:199], v[32:35], v[168:171]
    v_mfma_f32_16x16x32_bf16 v[172:175], v[196:199], v[36:39], v[172:175]
    v_mfma_f32_16x16x32_bf16 v[176:179], v[196:199], v[40:43], v[176:179]
k1_kernel_csv0:
    s_waitcnt lgkmcnt(0)
    s_barrier
    v_mfma_f32_16x16x32_bf16 v[80:83], v[44:47], v[60:63], v[80:83]
    s_add_u32 s27, s27, 1
    s_cmp_eq_u32 s27, 3
    v_mfma_f32_16x16x32_bf16 v[100:103], v[48:51], v[60:63], v[100:103]
    s_mov_b32 s25, 16384
    s_cselect_b32 s25, 0xffff8000, s25
    v_mfma_f32_16x16x32_bf16 v[120:123], v[52:55], v[60:63], v[120:123]
    s_cselect_b32 s27, 0, s27
    s_add_u32 s16, s16, 1
    v_mfma_f32_16x16x32_bf16 v[140:143], v[56:59], v[60:63], v[140:143]
    s_cmp_eq_u32 s16, 3
    s_mov_b32 s17, 20480
    v_mfma_f32_16x16x32_bf16 v[84:87], v[44:47], v[64:67], v[84:87]
    s_cselect_b32 s17, 0xffff6000, s17
    s_cselect_b32 s16, 0, s16
    v_mfma_f32_16x16x32_bf16 v[104:107], v[48:51], v[64:67], v[104:107]
    v_add_u32 v1, s25, v1
    v_add_u32 v2, s25, v2
    v_mfma_f32_16x16x32_bf16 v[124:127], v[52:55], v[64:67], v[124:127]
    v_add_u32 v212, s25, v212
    v_add_u32 v213, s25, v213
    v_mfma_f32_16x16x32_bf16 v[144:147], v[56:59], v[64:67], v[144:147]
    v_add_u32 v3, s17, v3
    v_add_u32 v4, s17, v4
    v_mfma_f32_16x16x32_bf16 v[88:91], v[44:47], v[68:71], v[88:91]
    ds_read_b128 v[8:11], v1 offset:0
    ds_read_b128 v[12:15], v1 offset:2048
    v_mfma_f32_16x16x32_bf16 v[108:111], v[48:51], v[68:71], v[108:111]
    ds_read_b128 v[16:19], v212 offset:0
    ds_read_b128 v[20:23], v212 offset:2048
    v_mfma_f32_16x16x32_bf16 v[128:131], v[52:55], v[68:71], v[128:131]
    ds_read_b64_tr_b16 v[24:25], v3 offset:0
    v_mfma_f32_16x16x32_bf16 v[148:151], v[56:59], v[68:71], v[148:151]
    ds_read_b64_tr_b16 v[26:27], v3 offset:1280
    v_mfma_f32_16x16x32_bf16 v[92:95], v[44:47], v[72:75], v[92:95]
    ds_read_b64_tr_b16 v[28:29], v4 offset:32
    v_mfma_f32_16x16x32_bf16 v[112:115], v[48:51], v[72:75], v[112:115]
    ds_read_b64_tr_b16 v[30:31], v4 offset:1312
    v_mfma_f32_16x16x32_bf16 v[132:135], v[52:55], v[72:75], v[132:135]
    ds_read_b64_tr_b16 v[32:33], v3 offset:64
    v_mfma_f32_16x16x32_bf16 v[152:155], v[56:59], v[72:75], v[152:155]
    ds_read_b64_tr_b16 v[34:35], v3 offset:1344
    v_mfma_f32_16x16x32_bf16 v[96:99], v[44:47], v[76:79], v[96:99]
    ds_read_b64_tr_b16 v[36:37], v4 offset:96
    v_mfma_f32_16x16x32_bf16 v[116:119], v[48:51], v[76:79], v[116:119]
    ds_read_b64_tr_b16 v[38:39], v4 offset:1376
    v_mfma_f32_16x16x32_bf16 v[136:139], v[52:55], v[76:79], v[136:139]
    ds_read_b64_tr_b16 v[40:41], v3 offset:128
    v_mfma_f32_16x16x32_bf16 v[156:159], v[56:59], v[76:79], v[156:159]
    ds_read_b64_tr_b16 v[42:43], v3 offset:1408
    v_mfma_f32_16x16x32_bf16 v[180:183], v[196:199], v[44:47], v[180:183]
    v_mfma_f32_16x16x32_bf16 v[188:191], v[44:47], v[44:47], v[188:191]
    v_mfma_f32_16x16x32_bf16 v[184:187], v[196:199], v[48:51], v[184:187]
    v_mfma_f32_16x16x32_bf16 v[192:195], v[48:51], v[48:51], v[192:195]
    s_cmp_lg_u32 s28, 1
    s_cbranch_scc1 k1_kernel_csv1
    v_mfma_f32_16x16x32_bf16 v[160:163], v[196:199], v[60:63], v[160:163]
    v_mfma_f32_16x16x32_bf16 v[164:167], v[196:199], v[64:67], v[164:167]
    v_mfma_f32_16x16x32_bf16 v[168:171], v[196:199], v[68:71], v[168:171]
    v_mfma_f32_16x16x32_bf16 v[172:175], v[196:199], v[72:75], v[172:175]
    v_mfma_f32_16x16x32_bf16 v[176:179], v[196:199], v[76:79], v[176:179]
k1_kernel_csv1:
    s_sub_u32 s19, s19, 1
    s_cmp_lg_u32 s19, 0
    s_cbranch_scc1 k1_kernel_loopv
    s_waitcnt lgkmcnt(0)
k1_kernel_stats:
    v_lshrrev_b32 v6, 4, v0
    v_lshrrev_b32 v5, 2, v0
    v_and_b32 v5, 3, v5
    v_lshl_add_u32 v5, v6, 3, v5
    v_mul_u32_u24 v5, 192, v5
    v_and_b32 v7, 3, v0
    v_lshl_add_u32 v5, v7, 3, v5
    s_mul_i32 s30, s26, 6144
    s_add_u32 s30, s30, 111616
    v_add_u32 v5, s30, v5
    v_and_b32 v6, 1, v6
    v_lshlrev_b32 v6, 5, v6
    v_add_u32 v46, v5, v6
    v_sub_u32 v47, v5, v6
    ds_read_b64_tr_b16 v[48:49], v46 offset:0
    ds_read_b64_tr_b16 v[50:51], v46 offset:768
    ds_read_b64_tr_b16 v[52:53], v47 offset:32
    ds_read_b64_tr_b16 v[54:55], v47 offset:800
    ds_read_b64_tr_b16 v[56:57], v46 offset:64
    ds_read_b64_tr_b16 v[58:59], v46 offset:832
    ds_read_b64_tr_b16 v[60:61], v47 offset:96
    ds_read_b64_tr_b16 v[62:63], v47 offset:864
    ds_read_b64_tr_b16 v[64:65], v46 offset:128
    ds_read_b64_tr_b16 v[66:67], v46 offset:896
    s_sub_u32 s34, s2, 64
    s_lshl_b32 s34, s34, 2
    s_add_u32 s34, s34, s26
    s_cmp_lt_u32 s34, 736
    s_cselect_b32 s47, 1, 0
    s_cselect_b32 s34, s34, 0
    s_mov_b32 s54, 0
    s_mov_b32 s55, 0
    s_cmp_lt_u32 s34, 160
    s_cbranch_scc1 k1_kernel_rtc_w2
    s_cmp_lt_u32 s34, 544
    s_cbranch_scc1 k1_kernel_rtc_w4
    s_sub_u32 s34, s34, 544
    s_mul_i32 s36, s34, 2731
    s_lshr_b32 s36, s36, 16
    s_mul_i32 s35, s36, 24
    s_sub_u32 s35, s34, s35
    s_mul_i32 s38, s36, 368640
    s_mul_i32 s39, s35, 5120
    s_add_u32 s38, s38, s39
    s_add_u32 s38, s38, 3391488
    s_branch k1_kernel_rtc_go
k1_kernel_rtc_w4:
    s_sub_u32 s34, s34, 160
    s_mul_i32 s36, s34, 1366
    s_lshr_b32 s36, s36, 16
    s_mul_i32 s35, s36, 48
    s_sub_u32 s35, s34, s35
    s_mul_i32 s38, s36, 368640
    s_mul_i32 s39, s35, 5120
    s_add_u32 s38, s38, s39
    s_add_u32 s38, s38, 3145728
    s_branch k1_kernel_rtc_go
k1_kernel_rtc_w2:
    s_mul_i32 s36, s34, 3277
    s_lshr_b32 s36, s36, 16
    s_mul_i32 s35, s36, 20
    s_sub_u32 s35, s34, s35
    s_mul_i32 s38, s34, 5120
k1_kernel_rtc_go:
    s_add_u32 s12, s32, 0x2000000
    s_addc_u32 s13, s33, 0
    s_mov_b32 s14, 0x5d0000
    s_mov_b32 s15, 0x00020000
    v_lshlrev_b32 v5, 4, v0
    s_add_u32 s39, s38, 4096
    s_waitcnt lgkmcnt(0)
    s_cmp_eq_u32 s47, 0
    s_cbranch_scc1 k1_kernel_rt5
    buffer_store_dwordx4 v[48:51], v5, s[12:15], s38 offen offset:0
    buffer_store_dwordx4 v[52:55], v5, s[12:15], s38 offen offset:1024
    buffer_store_dwordx4 v[56:59], v5, s[12:15], s38 offen offset:2048
    buffer_store_dwordx4 v[60:63], v5, s[12:15], s38 offen offset:3072
    buffer_store_dwordx4 v[64:67], v5, s[12:15], s39 offen offset:0
k1_kernel_rt5:
    s_nop 1
    v_and_b32 v5, 15, v0
    v_lshrrev_b32 v6, 4, v0
    s_mul_i32 s30, s26, 5120
    s_add_u32 s30, s30, 49152
    v_lshlrev_b32 v7, 4, v0
    v_add_u32 v7, s30, v7
    ds_write_b128 v7, v[160:163] offset:0
    ds_write_b128 v7, v[164:167] offset:1024
    ds_write_b128 v7, v[168:171] offset:2048
    ds_write_b128 v7, v[172:175] offset:3072
    ds_write_b128 v7, v[176:179] offset:4096
    v_and_b32 v7, 3, v5
    v_cmp_eq_u32 vcc, 1, v7
    s_nop 1
    v_cndmask_b32 v188, v188, v189, vcc
    v_cmp_eq_u32 vcc, 2, v7
    s_nop 1
    v_cndmask_b32 v188, v188, v190, vcc
    v_cmp_eq_u32 vcc, 3, v7
    s_nop 1
    v_cndmask_b32 v188, v188, v191, vcc
    v_cmp_eq_u32 vcc, 1, v7
    s_nop 1
    v_cndmask_b32 v192, v192, v193, vcc
    v_cmp_eq_u32 vcc, 2, v7
    s_nop 1
    v_cndmask_b32 v192, v192, v194, vcc
    v_cmp_eq_u32 vcc, 3, v7
    s_nop 1
    v_cndmask_b32 v192, v192, v195, vcc
    s_mov_b32 s46, 0x3acccccd
    s_mov_b32 s47, 0x3727c5ac
    s_cmp_lt_u32 s41, 4
    s_mov_b32 s48, 1.0
    s_cselect_b32 s48, 0x3ea52b5c, s48
    v_mul_f32 v180, s46, v180
    v_mul_f32 v188, s46, v188
    v_fma_f32 v188, -v180, v180, v188
    v_max_f32 v188, 0, v188
    v_add_f32 v181, s47, v188
    v_rsq_f32 v181, v181
    s_nop 0
    v_mul_f32 v182, v181, v181
    v_mul_f32 v182, v182, v188
    v_add_f32 v182, s47, v182
    v_rsq_f32 v182, v182
    s_nop 0
    v_mul_f32 v182, v182, v181
    v_mul_f32 v183, s48, v181
    v_mul_f32 v184, s46, v184
    v_mul_f32 v192, s46, v192
    v_fma_f32 v192, -v184, v184, v192
    v_max_f32 v192, 0, v192
    v_add_f32 v185, s47, v192
    v_rsq_f32 v185, v185
    s_nop 0
    v_mul_f32 v186, v185, v185
    v_mul_f32 v186, v186, v192
    v_add_f32 v186, s47, v186
    v_rsq_f32 v186, v186
    s_nop 0
    v_mul_f32 v186, v186, v185
    v_mul_f32 v187, s48, v185
    s_cmp_ge_u32 s41, 12
    s_cselect_b64 vcc, -1, 0
    v_cndmask_b32 v183, v183, v182, vcc
    v_cndmask_b32 v187, v187, v186, vcc
    v_lshrrev_b32 v7, 2, v5
    v_cmp_eq_u32 vcc, v7, v6
    s_lshl_b32 s30, s28, 6
    s_lshl_b32 s46, s29, 5
    s_add_u32 s30, s30, s46
    v_add_u32 v7, s30, v5
    v_lshlrev_b32 v17, 2, v7
    v_add_u32 v17, 110592, v17
    s_and_saveexec_b64 s[50:51], vcc
    ds_write_b32 v17, v180 offset:0
    ds_write_b32 v17, v183 offset:512
    ds_write_b32 v17, v184 offset:64
    ds_write_b32 v17, v187 offset:576
    s_cmp_lg_u32 s41, 0
    s_cbranch_scc1 k1_kernel_nogs
    s_add_u32 s12, s32, 0x1a60000
    s_addc_u32 s13, s33, 0
    s_mov_b32 s14, 0x4000
    s_mov_b32 s15, 0x00020000
    v_add_u32 v7, s42, v7
    v_lshlrev_b32 v7, 3, v7
    buffer_store_dwordx2 v[180:181], v7, s[12:15], 0 offen offset:0
    buffer_store_dwordx2 v[184:185], v7, s[12:15], 0 offen offset:128
k1_kernel_nogs:
    s_mov_b64 exec, s[50:51]
    s_waitcnt lgkmcnt(0)
    s_barrier
    s_xor_b32 s30, s26, 2
    s_mul_i32 s30, s30, 5120
    s_add_u32 s30, s30, 49152
    v_lshlrev_b32 v7, 4, v0
    v_add_u32 v7, s30, v7
    ds_read_b128 v[48:51], v7 offset:0
    ds_read_b128 v[52:55], v7 offset:1024
    ds_read_b128 v[56:59], v7 offset:2048
    ds_read_b128 v[60:63], v7 offset:3072
    ds_read_b128 v[64:67], v7 offset:4096
    s_waitcnt lgkmcnt(0)
    v_pk_add_f32 v[160:161], v[160:161], v[48:49]
    v_pk_add_f32 v[162:163], v[162:163], v[50:51]
    v_pk_add_f32 v[164:165], v[164:165], v[52:53]
    v_pk_add_f32 v[166:167], v[166:167], v[54:55]
    v_pk_add_f32 v[168:169], v[168:169], v[56:57]
    v_pk_add_f32 v[170:171], v[170:171], v[58:59]
    v_pk_add_f32 v[172:173], v[172:173], v[60:61]
    v_pk_add_f32 v[174:175], v[174:175], v[62:63]
    v_pk_add_f32 v[176:177], v[176:177], v[64:65]
    v_pk_add_f32 v[178:179], v[178:179], v[66:67]
    s_sub_u32 s30, s41, 8
    s_cmp_lt_u32 s30, 4
    s_cbranch_scc1 k1_kernel_epv
    s_lshl_b32 s30, s28, 6
    v_add_u32 v7, s30, v5
    v_lshlrev_b32 v17, 2, v7
    v_add_u32 v17, 110592, v17
    s_lshl_b32 s46, s29, 7
    v_xor_b32 v17, s46, v17
    v_xor_b32 v7, 128, v17
    ds_read2_b32 v[8:9], v17 offset0:0 offset1:128
    ds_read2_b32 v[10:11], v17 offset0:16 offset1:144
    ds_read2_b32 v[12:13], v7 offset0:0 offset1:128
    ds_read2_b32 v[14:15], v7 offset0:16 offset1:144
    s_waitcnt lgkmcnt(0)
    s_mul_i32 s36, s26, 12288
    s_cmp_ge_u32 s41, 12
    s_cbranch_scc1 k1_kernel_eph
    s_mul_i32 s47, s29, 20
    v_add_u32 v7, 0, v6
    v_mul_u32_u24 v17, 52, v7
    v_lshrrev_b32 v17, 8, v17
    v_mul_u32_u24 v24, 5, v17
    v_sub_u32 v7, v7, v24
    v_mul_u32_u24 v17, 2560, v17
    v_add_u32 v17, s36, v17
    v_lshrrev_b32 v24, 1, v7
    v_lshlrev_b32 v24, 9, v24
    v_and_b32 v25, 1, v7
    v_lshl_add_u32 v24, v25, 3, v24
    v_cmp_eq_u32 vcc, 4, v7
    v_lshlrev_b32 v25, 4, v5
    v_lshlrev_b32 v26, 3, v5
    v_cndmask_b32 v25, v25, v26, vcc
    v_add3_u32 v200, v17, v24, v25
    v_mov_b32 v25, 256
    v_mov_b32 v26, 128
    v_cndmask_b32 v25, v25, v26, vcc
    v_add_u32 v201, v200, v25
    v_add_u32 v7, 4, v6
    v_mul_u32_u24 v17, 52, v7
    v_lshrrev_b32 v17, 8, v17
    v_mul_u32_u24 v24, 5, v17
    v_sub_u32 v7, v7, v24
    v_mul_u32_u24 v17, 2560, v17
    v_add_u32 v17, s36, v17
    v_lshrrev_b32 v24, 1, v7
    v_lshlrev_b32 v24, 9, v24
    v_and_b32 v25, 1, v7
    v_lshl_add_u32 v24, v25, 3, v24
    v_cmp_eq_u32 vcc, 4, v7
    v_lshlrev_b32 v25, 4, v5
    v_lshlrev_b32 v26, 3, v5
    v_cndmask_b32 v25, v25, v26, vcc
    v_add3_u32 v202, v17, v24, v25
    v_mov_b32 v25, 256
    v_mov_b32 v26, 128
    v_cndmask_b32 v25, v25, v26, vcc
    v_add_u32 v203, v202, v25
    v_add_u32 v7, 8, v6
    v_mul_u32_u24 v17, 52, v7
    v_lshrrev_b32 v17, 8, v17
    v_mul_u32_u24 v24, 5, v17
    v_sub_u32 v7, v7, v24
    v_mul_u32_u24 v17, 2560, v17
    v_add_u32 v17, s36, v17
    v_lshrrev_b32 v24, 1, v7
    v_lshlrev_b32 v24, 9, v24
    v_and_b32 v25, 1, v7
    v_lshl_add_u32 v24, v25, 3, v24
    v_cmp_eq_u32 vcc, 4, v7
    v_lshlrev_b32 v25, 4, v5
    v_lshlrev_b32 v26, 3, v5
    v_cndmask_b32 v25, v25, v26, vcc
    v_add3_u32 v204, v17, v24, v25
    v_mov_b32 v25, 256
    v_mov_b32 v26, 128
    v_cndmask_b32 v25, v25, v26, vcc
    v_add_u32 v205, v204, v25
    v_add_u32 v7, 12, v6
    v_mul_u32_u24 v17, 52, v7
    v_lshrrev_b32 v17, 8, v17
    v_mul_u32_u24 v24, 5, v17
    v_sub_u32 v7, v7, v24
    v_mul_u32_u24 v17, 2560, v17
    v_add_u32 v17, s36, v17
    v_lshrrev_b32 v24, 1, v7
    v_lshlrev_b32 v24, 9, v24
    v_and_b32 v25, 1, v7
    v_lshl_add_u32 v24, v25, 3, v24
    v_cmp_eq_u32 vcc, 4, v7
    v_lshlrev_b32 v25, 4, v5
    v_lshlrev_b32 v26, 3, v5
    v_cndmask_b32 v25, v25, v26, vcc
    v_add3_u32 v206, v17, v24, v25
    v_mov_b32 v25, 256
    v_mov_b32 v26, 128
    v_cndmask_b32 v25, v25, v26, vcc
    v_add_u32 v207, v206, v25
    v_add_u32 v7, 16, v6
    v_mul_u32_u24 v17, 52, v7
    v_lshrrev_b32 v17, 8, v17
    v_mul_u32_u24 v24, 5, v17
    v_sub_u32 v7, v7, v24
    v_mul_u32_u24 v17, 2560, v17
    v_add_u32 v17, s36, v17
    v_lshrrev_b32 v24, 1, v7
    v_lshlrev_b32 v24, 9, v24
    v_and_b32 v25, 1, v7
    v_lshl_add_u32 v24, v25, 3, v24
    v_cmp_eq_u32 vcc, 4, v7
    v_lshlrev_b32 v25, 4, v5
    v_lshlrev_b32 v26, 3, v5
    v_cndmask_b32 v25, v25, v26, vcc
    v_add3_u32 v208, v17, v24, v25
    v_mov_b32 v25, 256
    v_mov_b32 v26, 128
    v_cndmask_b32 v25, v25, v26, vcc
    v_add_u32 v209, v208, v25
    v_pk_fma_f32 v[80:81], v[160:161], v[8:9], v[80:81] op_sel_hi:[1,0,1] neg_lo:[0,1,0] neg_hi:[0,1,0]
    v_pk_mul_f32 v[80:81], v[80:81], v[8:9] op_sel:[0,1] op_sel_hi:[1,1]
    v_pk_fma_f32 v[82:83], v[162:163], v[8:9], v[82:83] op_sel_hi:[1,0,1] neg_lo:[0,1,0] neg_hi:[0,1,0]
    v_pk_mul_f32 v[82:83], v[82:83], v[8:9] op_sel:[0,1] op_sel_hi:[1,1]
    v_pk_fma_f32 v[84:85], v[164:165], v[8:9], v[84:85] op_sel_hi:[1,0,1] neg_lo:[0,1,0] neg_hi:[0,1,0]
    v_pk_mul_f32 v[84:85], v[84:85], v[8:9] op_sel:[0,1] op_sel_hi:[1,1]
    v_pk_fma_f32 v[86:87], v[166:167], v[8:9], v[86:87] op_sel_hi:[1,0,1] neg_lo:[0,1,0] neg_hi:[0,1,0]
    v_pk_mul_f32 v[86:87], v[86:87], v[8:9] op_sel:[0,1] op_sel_hi:[1,1]
    v_pk_fma_f32 v[88:89], v[168:169], v[8:9], v[88:89] op_sel_hi:[1,0,1] neg_lo:[0,1,0] neg_hi:[0,1,0]
    v_pk_mul_f32 v[88:89], v[88:89], v[8:9] op_sel:[0,1] op_sel_hi:[1,1]
    v_pk_fma_f32 v[90:91], v[170:171], v[8:9], v[90:91] op_sel_hi:[1,0,1] neg_lo:[0,1,0] neg_hi:[0,1,0]
    v_pk_mul_f32 v[90:91], v[90:91], v[8:9] op_sel:[0,1] op_sel_hi:[1,1]
    v_pk_fma_f32 v[92:93], v[172:173], v[8:9], v[92:93] op_sel_hi:[1,0,1] neg_lo:[0,1,0] neg_hi:[0,1,0]
    v_pk_mul_f32 v[92:93], v[92:93], v[8:9] op_sel:[0,1] op_sel_hi:[1,1]
    v_pk_fma_f32 v[94:95], v[174:175], v[8:9], v[94:95] op_sel_hi:[1,0,1] neg_lo:[0,1,0] neg_hi:[0,1,0]
    v_pk_mul_f32 v[94:95], v[94:95], v[8:9] op_sel:[0,1] op_sel_hi:[1,1]
    v_pk_fma_f32 v[96:97], v[176:177], v[8:9], v[96:97] op_sel_hi:[1,0,1] neg_lo:[0,1,0] neg_hi:[0,1,0]
    v_pk_mul_f32 v[96:97], v[96:97], v[8:9] op_sel:[0,1] op_sel_hi:[1,1]
    v_pk_fma_f32 v[98:99], v[178:179], v[8:9], v[98:99] op_sel_hi:[1,0,1] neg_lo:[0,1,0] neg_hi:[0,1,0]
    v_pk_mul_f32 v[98:99], v[98:99], v[8:9] op_sel:[0,1] op_sel_hi:[1,1]
    v_cvt_pk_bf16_f32 v80, v80, v81
    v_cvt_pk_bf16_f32 v81, v82, v83
    ds_write_b64 v200, v[80:81] offset:0
    v_cvt_pk_bf16_f32 v84, v84, v85
    v_cvt_pk_bf16_f32 v85, v86, v87
    ds_write_b64 v202, v[84:85] offset:0
    v_cvt_pk_bf16_f32 v88, v88, v89
    v_cvt_pk_bf16_f32 v89, v90, v91
    ds_write_b64 v204, v[88:89] offset:0
    v_cvt_pk_bf16_f32 v92, v92, v93
    v_cvt_pk_bf16_f32 v93, v94, v95
    ds_write_b64 v206, v[92:93] offset:0
    v_cvt_pk_bf16_f32 v96, v96, v97
    v_cvt_pk_bf16_f32 v97, v98, v99
    ds_write_b64 v208, v[96:97] offset:0
    v_pk_fma_f32 v[100:101], v[160:161], v[10:11], v[100:101] op_sel_hi:[1,0,1] neg_lo:[0,1,0] neg_hi:[0,1,0]
    v_pk_mul_f32 v[100:101], v[100:101], v[10:11] op_sel:[0,1] op_sel_hi:[1,1]
    v_pk_fma_f32 v[102:103], v[162:163], v[10:11], v[102:103] op_sel_hi:[1,0,1] neg_lo:[0,1,0] neg_hi:[0,1,0]
    v_pk_mul_f32 v[102:103], v[102:103], v[10:11] op_sel:[0,1] op_sel_hi:[1,1]
    v_pk_fma_f32 v[104:105], v[164:165], v[10:11], v[104:105] op_sel_hi:[1,0,1] neg_lo:[0,1,0] neg_hi:[0,1,0]
    v_pk_mul_f32 v[104:105], v[104:105], v[10:11] op_sel:[0,1] op_sel_hi:[1,1]
    v_pk_fma_f32 v[106:107], v[166:167], v[10:11], v[106:107] op_sel_hi:[1,0,1] neg_lo:[0,1,0] neg_hi:[0,1,0]
    v_pk_mul_f32 v[106:107], v[106:107], v[10:11] op_sel:[0,1] op_sel_hi:[1,1]
    v_pk_fma_f32 v[108:109], v[168:169], v[10:11], v[108:109] op_sel_hi:[1,0,1] neg_lo:[0,1,0] neg_hi:[0,1,0]
    v_pk_mul_f32 v[108:109], v[108:109], v[10:11] op_sel:[0,1] op_sel_hi:[1,1]
    v_pk_fma_f32 v[110:111], v[170:171], v[10:11], v[110:111] op_sel_hi:[1,0,1] neg_lo:[0,1,0] neg_hi:[0,1,0]
    v_pk_mul_f32 v[110:111], v[110:111], v[10:11] op_sel:[0,1] op_sel_hi:[1,1]
    v_pk_fma_f32 v[112:113], v[172:173], v[10:11], v[112:113] op_sel_hi:[1,0,1] neg_lo:[0,1,0] neg_hi:[0,1,0]
    v_pk_mul_f32 v[112:113], v[112:113], v[10:11] op_sel:[0,1] op_sel_hi:[1,1]
    v_pk_fma_f32 v[114:115], v[174:175], v[10:11], v[114:115] op_sel_hi:[1,0,1] neg_lo:[0,1,0] neg_hi:[0,1,0]
    v_pk_mul_f32 v[114:115], v[114:115], v[10:11] op_sel:[0,1] op_sel_hi:[1,1]
    v_pk_fma_f32 v[116:117], v[176:177], v[10:11], v[116:117] op_sel_hi:[1,0,1] neg_lo:[0,1,0] neg_hi:[0,1,0]
    v_pk_mul_f32 v[116:117], v[116:117], v[10:11] op_sel:[0,1] op_sel_hi:[1,1]
    v_pk_fma_f32 v[118:119], v[178:179], v[10:11], v[118:119] op_sel_hi:[1,0,1] neg_lo:[0,1,0] neg_hi:[0,1,0]
    v_pk_mul_f32 v[118:119], v[118:119], v[10:11] op_sel:[0,1] op_sel_hi:[1,1]
    v_cvt_pk_bf16_f32 v100, v100, v101
    v_cvt_pk_bf16_f32 v101, v102, v103
    ds_write_b64 v201, v[100:101] offset:0
    v_cvt_pk_bf16_f32 v104, v104, v105
    v_cvt_pk_bf16_f32 v105, v106, v107
    ds_write_b64 v203, v[104:105] offset:0
    v_cvt_pk_bf16_f32 v108, v108, v109
    v_cvt_pk_bf16_f32 v109, v110, v111
    ds_write_b64 v205, v[108:109] offset:0
    v_cvt_pk_bf16_f32 v112, v112, v113
    v_cvt_pk_bf16_f32 v113, v114, v115
    ds_write_b64 v207, v[112:113] offset:0
    v_cvt_pk_bf16_f32 v116, v116, v117
    v_cvt_pk_bf16_f32 v117, v118, v119
    ds_write_b64 v209, v[116:117] offset:0
    v_pk_fma_f32 v[120:121], v[160:161], v[12:13], v[120:121] op_sel_hi:[1,0,1] neg_lo:[0,1,0] neg_hi:[0,1,0]
    v_pk_mul_f32 v[120:121], v[120:121], v[12:13] op_sel:[0,1] op_sel_hi:[1,1]
    v_pk_fma_f32 v[122:123], v[162:163], v[12:13], v[122:123] op_sel_hi:[1,0,1] neg_lo:[0,1,0] neg_hi:[0,1,0]
    v_pk_mul_f32 v[122:123], v[122:123], v[12:13] op_sel:[0,1] op_sel_hi:[1,1]
    v_pk_fma_f32 v[124:125], v[164:165], v[12:13], v[124:125] op_sel_hi:[1,0,1] neg_lo:[0,1,0] neg_hi:[0,1,0]
    v_pk_mul_f32 v[124:125], v[124:125], v[12:13] op_sel:[0,1] op_sel_hi:[1,1]
    v_pk_fma_f32 v[126:127], v[166:167], v[12:13], v[126:127] op_sel_hi:[1,0,1] neg_lo:[0,1,0] neg_hi:[0,1,0]
    v_pk_mul_f32 v[126:127], v[126:127], v[12:13] op_sel:[0,1] op_sel_hi:[1,1]
    v_pk_fma_f32 v[128:129], v[168:169], v[12:13], v[128:129] op_sel_hi:[1,0,1] neg_lo:[0,1,0] neg_hi:[0,1,0]
    v_pk_mul_f32 v[128:129], v[128:129], v[12:13] op_sel:[0,1] op_sel_hi:[1,1]
    v_pk_fma_f32 v[130:131], v[170:171], v[12:13], v[130:131] op_sel_hi:[1,0,1] neg_lo:[0,1,0] neg_hi:[0,1,0]
    v_pk_mul_f32 v[130:131], v[130:131], v[12:13] op_sel:[0,1] op_sel_hi:[1,1]
    v_pk_fma_f32 v[132:133], v[172:173], v[12:13], v[132:133] op_sel_hi:[1,0,1] neg_lo:[0,1,0] neg_hi:[0,1,0]
    v_pk_mul_f32 v[132:133], v[132:133], v[12:13] op_sel:[0,1] op_sel_hi:[1,1]
    v_pk_fma_f32 v[134:135], v[174:175], v[12:13], v[134:135] op_sel_hi:[1,0,1] neg_lo:[0,1,0] neg_hi:[0,1,0]
    v_pk_mul_f32 v[134:135], v[134:135], v[12:13] op_sel:[0,1] op_sel_hi:[1,1]
    v_pk_fma_f32 v[136:137], v[176:177], v[12:13], v[136:137] op_sel_hi:[1,0,1] neg_lo:[0,1,0] neg_hi:[0,1,0]
    v_pk_mul_f32 v[136:137], v[136:137], v[12:13] op_sel:[0,1] op_sel_hi:[1,1]
    v_pk_fma_f32 v[138:139], v[178:179], v[12:13], v[138:139] op_sel_hi:[1,0,1] neg_lo:[0,1,0] neg_hi:[0,1,0]
    v_pk_mul_f32 v[138:139], v[138:139], v[12:13] op_sel:[0,1] op_sel_hi:[1,1]
    v_cvt_pk_bf16_f32 v120, v120, v121
    v_cvt_pk_bf16_f32 v121, v122, v123
    ds_write_b64 v200, v[120:121] offset:1280
    v_cvt_pk_bf16_f32 v124, v124, v125
    v_cvt_pk_bf16_f32 v125, v126, v127
    ds_write_b64 v202, v[124:125] offset:1280
    v_cvt_pk_bf16_f32 v128, v128, v129
    v_cvt_pk_bf16_f32 v129, v130, v131
    ds_write_b64 v204, v[128:129] offset:1280
    v_cvt_pk_bf16_f32 v132, v132, v133
    v_cvt_pk_bf16_f32 v133, v134, v135
    ds_write_b64 v206, v[132:133] offset:1280
    v_cvt_pk_bf16_f32 v136, v136, v137
    v_cvt_pk_bf16_f32 v137, v138, v139
    ds_write_b64 v208, v[136:137] offset:1280
    v_pk_fma_f32 v[140:141], v[160:161], v[14:15], v[140:141] op_sel_hi:[1,0,1] neg_lo:[0,1,0] neg_hi:[0,1,0]
    v_pk_mul_f32 v[140:141], v[140:141], v[14:15] op_sel:[0,1] op_sel_hi:[1,1]
    v_pk_fma_f32 v[142:143], v[162:163], v[14:15], v[142:143] op_sel_hi:[1,0,1] neg_lo:[0,1,0] neg_hi:[0,1,0]
    v_pk_mul_f32 v[142:143], v[142:143], v[14:15] op_sel:[0,1] op_sel_hi:[1,1]
    v_pk_fma_f32 v[144:145], v[164:165], v[14:15], v[144:145] op_sel_hi:[1,0,1] neg_lo:[0,1,0] neg_hi:[0,1,0]
    v_pk_mul_f32 v[144:145], v[144:145], v[14:15] op_sel:[0,1] op_sel_hi:[1,1]
    v_pk_fma_f32 v[146:147], v[166:167], v[14:15], v[146:147] op_sel_hi:[1,0,1] neg_lo:[0,1,0] neg_hi:[0,1,0]
    v_pk_mul_f32 v[146:147], v[146:147], v[14:15] op_sel:[0,1] op_sel_hi:[1,1]
    v_pk_fma_f32 v[148:149], v[168:169], v[14:15], v[148:149] op_sel_hi:[1,0,1] neg_lo:[0,1,0] neg_hi:[0,1,0]
    v_pk_mul_f32 v[148:149], v[148:149], v[14:15] op_sel:[0,1] op_sel_hi:[1,1]
    v_pk_fma_f32 v[150:151], v[170:171], v[14:15], v[150:151] op_sel_hi:[1,0,1] neg_lo:[0,1,0] neg_hi:[0,1,0]
    v_pk_mul_f32 v[150:151], v[150:151], v[14:15] op_sel:[0,1] op_sel_hi:[1,1]
    v_pk_fma_f32 v[152:153], v[172:173], v[14:15], v[152:153] op_sel_hi:[1,0,1] neg_lo:[0,1,0] neg_hi:[0,1,0]
    v_pk_mul_f32 v[152:153], v[152:153], v[14:15] op_sel:[0,1] op_sel_hi:[1,1]
    v_pk_fma_f32 v[154:155], v[174:175], v[14:15], v[154:155] op_sel_hi:[1,0,1] neg_lo:[0,1,0] neg_hi:[0,1,0]
    v_pk_mul_f32 v[154:155], v[154:155], v[14:15] op_sel:[0,1] op_sel_hi:[1,1]
    v_pk_fma_f32 v[156:157], v[176:177], v[14:15], v[156:157] op_sel_hi:[1,0,1] neg_lo:[0,1,0] neg_hi:[0,1,0]
    v_pk_mul_f32 v[156:157], v[156:157], v[14:15] op_sel:[0,1] op_sel_hi:[1,1]
    v_pk_fma_f32 v[158:159], v[178:179], v[14:15], v[158:159] op_sel_hi:[1,0,1] neg_lo:[0,1,0] neg_hi:[0,1,0]
    v_pk_mul_f32 v[158:159], v[158:159], v[14:15] op_sel:[0,1] op_sel_hi:[1,1]
    v_cvt_pk_bf16_f32 v140, v140, v141
    v_cvt_pk_bf16_f32 v141, v142, v143
    ds_write_b64 v201, v[140:141] offset:1280
    v_cvt_pk_bf16_f32 v144, v144, v145
    v_cvt_pk_bf16_f32 v145, v146, v147
    ds_write_b64 v203, v[144:145] offset:1280
    v_cvt_pk_bf16_f32 v148, v148, v149
    v_cvt_pk_bf16_f32 v149, v150, v151
    ds_write_b64 v205, v[148:149] offset:1280
    v_cvt_pk_bf16_f32 v152, v152, v153
    v_cvt_pk_bf16_f32 v153, v154, v155
    ds_write_b64 v207, v[152:153] offset:1280
    v_cvt_pk_bf16_f32 v156, v156, v157
    v_cvt_pk_bf16_f32 v157, v158, v159
    ds_write_b64 v209, v[156:157] offset:1280
    s_cmp_lt_u32 s41, 4
    s_mov_b32 s12, 0x1500000
    s_cselect_b32 s12, 0x2700000, s12
    s_add_u32 s12, s32, s12
    s_addc_u32 s13, s33, 0
    s_cmp_lt_u32 s41, 4
    s_mov_b32 s14, 0x540000
    s_cselect_b32 s14, 0x280000, s14
    s_mov_b32 s15, 0x00020000
    s_mov_b32 s37, 172032
    s_cselect_b32 s37, 81920, s37
    s_mov_b32 s38, 2688
    s_cselect_b32 s38, 1280, s38
    s_and_b32 s39, s41, 3
    s_lshl_b32 s39, s39, 3
    s_lshl_b32 s30, s29, 2
    s_add_u32 s39, s39, s30
    s_mul_i32 s39, s39, s37
    s_lshl_b32 s46, s40, 2
    s_lshl_b32 s30, s28, 1
    s_add_u32 s46, s46, s30
    s_mul_i32 s46, s46, s38
    s_add_u32 s39, s39, s46
    s_mul_i32 s46, s29, s38
    s_xor_b32 s30, s29, 1
    s_mul_i32 s47, s30, s38
    v_lshlrev_b32 v5, 4, v0
    v_add_u32 v6, s36, v5
    s_waitcnt lgkmcnt(0)
    ds_read_b128 v[80:83], v6 offset:0
    ds_read_b128 v[84:87], v6 offset:1280
    ds_read_b128 v[88:91], v6 offset:2560
    ds_read_b128 v[92:95], v6 offset:3840
    ds_read_b128 v[96:99], v6 offset:5120
    ds_read_b128 v[100:103], v6 offset:6400
    ds_read_b128 v[104:107], v6 offset:7680
    ds_read_b128 v[108:111], v6 offset:8960
    v_lshrrev_b32 v7, 4, v0
    v_mul_u32_u24 v17, 1280, v7
    v_and_b32 v24, 15, v0
    v_lshl_add_u32 v17, v24, 4, v17
    v_add_u32 v25, s36, v17
    ds_read_b128 v[112:115], v25 offset:1024
    ds_read_b128 v[116:119], v25 offset:6144
    v_lshrrev_b32 v26, 1, v7
    v_mul_lo_u32 v26, v26, s37
    v_and_b32 v7, 1, v7
    v_xor_b32 v7, s29, v7
    v_mul_lo_u32 v7, v7, s38
    v_lshlrev_b32 v24, 4, v24
    v_add3_u32 v26, v26, v7, v24
    v_add_u32 v26, 1024, v26
    s_mul_i32 s30, s37, 0
    s_add_u32 s30, s30, s39
    s_add_u32 s52, s30, s46
    s_waitcnt lgkmcnt(9)
    buffer_store_dwordx4 v[80:83], v5, s[12:15], s52 offen
    s_mul_i32 s30, s37, 0
    s_add_u32 s30, s30, s39
    s_add_u32 s53, s30, s47
    s_waitcnt lgkmcnt(8)
    buffer_store_dwordx4 v[84:87], v5, s[12:15], s53 offen
    s_mul_i32 s30, s37, 1
    s_add_u32 s30, s30, s39
    s_add_u32 s54, s30, s46
    s_waitcnt lgkmcnt(7)
    buffer_store_dwordx4 v[88:91], v5, s[12:15], s54 offen
    s_mul_i32 s30, s37, 1
    s_add_u32 s30, s30, s39
    s_add_u32 s55, s30, s47
    s_waitcnt lgkmcnt(6)
    buffer_store_dwordx4 v[92:95], v5, s[12:15], s55 offen
    s_mul_i32 s30, s37, 2
    s_add_u32 s30, s30, s39
    s_add_u32 s52, s30, s46
    s_waitcnt lgkmcnt(5)
    buffer_store_dwordx4 v[96:99], v5, s[12:15], s52 offen
    s_mul_i32 s30, s37, 2
    s_add_u32 s30, s30, s39
    s_add_u32 s53, s30, s47
    s_waitcnt lgkmcnt(4)
    buffer_store_dwordx4 v[100:103], v5, s[12:15], s53 offen
    s_mul_i32 s30, s37, 3
    s_add_u32 s30, s30, s39
    s_add_u32 s54, s30, s46
    s_waitcnt lgkmcnt(3)
    buffer_store_dwordx4 v[104:107], v5, s[12:15], s54 offen
    s_mul_i32 s30, s37, 3
    s_add_u32 s30, s30, s39
    s_add_u32 s55, s30, s47
    s_waitcnt lgkmcnt(2)
    buffer_store_dwordx4 v[108:111], v5, s[12:15], s55 offen
    s_mul_i32 s30, s37, 0
    s_add_u32 s52, s30, s39
    s_waitcnt lgkmcnt(1)
    buffer_store_dwordx4 v[112:115], v26, s[12:15], s52 offen
    s_mul_i32 s30, s37, 2
    s_add_u32 s53, s30, s39
    s_waitcnt lgkmcnt(0)
    buffer_store_dwordx4 v[116:119], v26, s[12:15], s53 offen
    s_branch k1_kernel_done
k1_kernel_eph:
    v_mul_u32_u24 v200, 160, v5
    v_lshl_add_u32 v200, v6, 3, v200
    v_add_u32 v200, s36, v200
    s_mul_i32 s30, s29, 5120
    v_add_u32 v201, s30, v200
    s_xor_b32 s30, s29, 1
    s_mul_i32 s30, s30, 5120
    v_add_u32 v202, s30, v200
    v_mov_b32 v40, 0xc0135761
    v_mov_b32 v41, 0xc0135761
    s_mov_b32 s48, 0xbdd2d3e8
    s_mov_b32 s49, 0xbdd2d3e8
    v_pk_fma_f32 v[80:81], v[160:161], v[8:9], v[80:81] op_sel_hi:[1,0,1] neg_lo:[0,1,0] neg_hi:[0,1,0]
    v_pk_mul_f32 v[80:81], v[80:81], v[8:9] op_sel:[0,1] op_sel_hi:[1,1]
    v_pk_fma_f32 v[82:83], v[162:163], v[8:9], v[82:83] op_sel_hi:[1,0,1] neg_lo:[0,1,0] neg_hi:[0,1,0]
    v_pk_mul_f32 v[82:83], v[82:83], v[8:9] op_sel:[0,1] op_sel_hi:[1,1]
    v_pk_fma_f32 v[84:85], v[164:165], v[8:9], v[84:85] op_sel_hi:[1,0,1] neg_lo:[0,1,0] neg_hi:[0,1,0]
    v_pk_mul_f32 v[84:85], v[84:85], v[8:9] op_sel:[0,1] op_sel_hi:[1,1]
    v_pk_fma_f32 v[86:87], v[166:167], v[8:9], v[86:87] op_sel_hi:[1,0,1] neg_lo:[0,1,0] neg_hi:[0,1,0]
    v_pk_mul_f32 v[86:87], v[86:87], v[8:9] op_sel:[0,1] op_sel_hi:[1,1]
    v_pk_fma_f32 v[88:89], v[168:169], v[8:9], v[88:89] op_sel_hi:[1,0,1] neg_lo:[0,1,0] neg_hi:[0,1,0]
    v_pk_mul_f32 v[88:89], v[88:89], v[8:9] op_sel:[0,1] op_sel_hi:[1,1]
    v_pk_fma_f32 v[90:91], v[170:171], v[8:9], v[90:91] op_sel_hi:[1,0,1] neg_lo:[0,1,0] neg_hi:[0,1,0]
    v_pk_mul_f32 v[90:91], v[90:91], v[8:9] op_sel:[0,1] op_sel_hi:[1,1]
    v_pk_fma_f32 v[92:93], v[172:173], v[8:9], v[92:93] op_sel_hi:[1,0,1] neg_lo:[0,1,0] neg_hi:[0,1,0]
    v_pk_mul_f32 v[92:93], v[92:93], v[8:9] op_sel:[0,1] op_sel_hi:[1,1]
    v_pk_fma_f32 v[94:95], v[174:175], v[8:9], v[94:95] op_sel_hi:[1,0,1] neg_lo:[0,1,0] neg_hi:[0,1,0]
    v_pk_mul_f32 v[94:95], v[94:95], v[8:9] op_sel:[0,1] op_sel_hi:[1,1]
    v_pk_fma_f32 v[96:97], v[176:177], v[8:9], v[96:97] op_sel_hi:[1,0,1] neg_lo:[0,1,0] neg_hi:[0,1,0]
    v_pk_mul_f32 v[96:97], v[96:97], v[8:9] op_sel:[0,1] op_sel_hi:[1,1]
    v_pk_fma_f32 v[98:99], v[178:179], v[8:9], v[98:99] op_sel_hi:[1,0,1] neg_lo:[0,1,0] neg_hi:[0,1,0]
    v_pk_mul_f32 v[98:99], v[98:99], v[8:9] op_sel:[0,1] op_sel_hi:[1,1]
    v_pk_mul_f32 v[24:25], v[80:81], v[80:81]
    v_pk_mul_f32 v[26:27], v[82:83], v[82:83]
    v_pk_mul_f32 v[28:29], v[84:85], v[84:85]
    v_pk_mul_f32 v[30:31], v[86:87], v[86:87]
    v_pk_fma_f32 v[24:25], v[24:25], s[48:49], v[40:41]
    v_pk_fma_f32 v[26:27], v[26:27], s[48:49], v[40:41]
    v_pk_fma_f32 v[28:29], v[28:29], s[48:49], v[40:41]
    v_pk_fma_f32 v[30:31], v[30:31], s[48:49], v[40:41]
    v_pk_mul_f32 v[24:25], v[24:25], v[80:81]
    v_pk_mul_f32 v[26:27], v[26:27], v[82:83]
    v_pk_mul_f32 v[28:29], v[28:29], v[84:85]
    v_pk_mul_f32 v[30:31], v[30:31], v[86:87]
    v_exp_f32 v24, v24
    v_exp_f32 v25, v25
    v_exp_f32 v26, v26
    v_exp_f32 v27, v27
    v_exp_f32 v28, v28
    v_exp_f32 v29, v29
    v_exp_f32 v30, v30
    v_exp_f32 v31, v31
    v_pk_add_f32 v[24:25], v[24:25], 1.0 op_sel_hi:[1,0]
    v_pk_add_f32 v[26:27], v[26:27], 1.0 op_sel_hi:[1,0]
    v_pk_add_f32 v[28:29], v[28:29], 1.0 op_sel_hi:[1,0]
    v_pk_add_f32 v[30:31], v[30:31], 1.0 op_sel_hi:[1,0]
    v_rcp_f32 v24, v24
    v_rcp_f32 v25, v25
    v_rcp_f32 v26, v26
    v_rcp_f32 v27, v27
    v_rcp_f32 v28, v28
    v_rcp_f32 v29, v29
    v_rcp_f32 v30, v30
    v_rcp_f32 v31, v31
    v_pk_mul_f32 v[80:81], v[24:25], v[80:81]
    v_pk_mul_f32 v[82:83], v[26:27], v[82:83]
    v_pk_mul_f32 v[84:85], v[28:29], v[84:85]
    v_pk_mul_f32 v[86:87], v[30:31], v[86:87]
    v_cvt_pk_bf16_f32 v80, v80, v81
    v_cvt_pk_bf16_f32 v81, v82, v83
    ds_write_b64 v201, v[80:81] offset:0
    v_cvt_pk_bf16_f32 v84, v84, v85
    v_cvt_pk_bf16_f32 v85, v86, v87
    ds_write_b64 v201, v[84:85] offset:32
    v_pk_mul_f32 v[24:25], v[88:89], v[88:89]
    v_pk_mul_f32 v[26:27], v[90:91], v[90:91]
    v_pk_mul_f32 v[28:29], v[92:93], v[92:93]
    v_pk_mul_f32 v[30:31], v[94:95], v[94:95]
    v_pk_fma_f32 v[24:25], v[24:25], s[48:49], v[40:41]
    v_pk_fma_f32 v[26:27], v[26:27], s[48:49], v[40:41]
    v_pk_fma_f32 v[28:29], v[28:29], s[48:49], v[40:41]
    v_pk_fma_f32 v[30:31], v[30:31], s[48:49], v[40:41]
    v_pk_mul_f32 v[24:25], v[24:25], v[88:89]
    v_pk_mul_f32 v[26:27], v[26:27], v[90:91]
    v_pk_mul_f32 v[28:29], v[28:29], v[92:93]
    v_pk_mul_f32 v[30:31], v[30:31], v[94:95]
    v_exp_f32 v24, v24
    v_exp_f32 v25, v25
    v_exp_f32 v26, v26
    v_exp_f32 v27, v27
    v_exp_f32 v28, v28
    v_exp_f32 v29, v29
    v_exp_f32 v30, v30
    v_exp_f32 v31, v31
    v_pk_add_f32 v[24:25], v[24:25], 1.0 op_sel_hi:[1,0]
    v_pk_add_f32 v[26:27], v[26:27], 1.0 op_sel_hi:[1,0]
    v_pk_add_f32 v[28:29], v[28:29], 1.0 op_sel_hi:[1,0]
    v_pk_add_f32 v[30:31], v[30:31], 1.0 op_sel_hi:[1,0]
    v_rcp_f32 v24, v24
    v_rcp_f32 v25, v25
    v_rcp_f32 v26, v26
    v_rcp_f32 v27, v27
    v_rcp_f32 v28, v28
    v_rcp_f32 v29, v29
    v_rcp_f32 v30, v30
    v_rcp_f32 v31, v31
    v_pk_mul_f32 v[88:89], v[24:25], v[88:89]
    v_pk_mul_f32 v[90:91], v[26:27], v[90:91]
    v_pk_mul_f32 v[92:93], v[28:29], v[92:93]
    v_pk_mul_f32 v[94:95], v[30:31], v[94:95]
    v_cvt_pk_bf16_f32 v88, v88, v89
    v_cvt_pk_bf16_f32 v89, v90, v91
    ds_write_b64 v201, v[88:89] offset:64
    v_cvt_pk_bf16_f32 v92, v92, v93
    v_cvt_pk_bf16_f32 v93, v94, v95
    ds_write_b64 v201, v[92:93] offset:96
    v_pk_mul_f32 v[24:25], v[96:97], v[96:97]
    v_pk_mul_f32 v[26:27], v[98:99], v[98:99]
    v_pk_fma_f32 v[24:25], v[24:25], s[48:49], v[40:41]
    v_pk_fma_f32 v[26:27], v[26:27], s[48:49], v[40:41]
    v_pk_mul_f32 v[24:25], v[24:25], v[96:97]
    v_pk_mul_f32 v[26:27], v[26:27], v[98:99]
    v_exp_f32 v24, v24
    v_exp_f32 v25, v25
    v_exp_f32 v26, v26
    v_exp_f32 v27, v27
    v_pk_add_f32 v[24:25], v[24:25], 1.0 op_sel_hi:[1,0]
    v_pk_add_f32 v[26:27], v[26:27], 1.0 op_sel_hi:[1,0]
    v_rcp_f32 v24, v24
    v_rcp_f32 v25, v25
    v_rcp_f32 v26, v26
    v_rcp_f32 v27, v27
    v_pk_mul_f32 v[96:97], v[24:25], v[96:97]
    v_pk_mul_f32 v[98:99], v[26:27], v[98:99]
    v_cvt_pk_bf16_f32 v96, v96, v97
    v_cvt_pk_bf16_f32 v97, v98, v99
    ds_write_b64 v201, v[96:97] offset:128
    v_pk_fma_f32 v[100:101], v[160:161], v[10:11], v[100:101] op_sel_hi:[1,0,1] neg_lo:[0,1,0] neg_hi:[0,1,0]
    v_pk_mul_f32 v[100:101], v[100:101], v[10:11] op_sel:[0,1] op_sel_hi:[1,1]
    v_pk_fma_f32 v[102:103], v[162:163], v[10:11], v[102:103] op_sel_hi:[1,0,1] neg_lo:[0,1,0] neg_hi:[0,1,0]
    v_pk_mul_f32 v[102:103], v[102:103], v[10:11] op_sel:[0,1] op_sel_hi:[1,1]
    v_pk_fma_f32 v[104:105], v[164:165], v[10:11], v[104:105] op_sel_hi:[1,0,1] neg_lo:[0,1,0] neg_hi:[0,1,0]
    v_pk_mul_f32 v[104:105], v[104:105], v[10:11] op_sel:[0,1] op_sel_hi:[1,1]
    v_pk_fma_f32 v[106:107], v[166:167], v[10:11], v[106:107] op_sel_hi:[1,0,1] neg_lo:[0,1,0] neg_hi:[0,1,0]
    v_pk_mul_f32 v[106:107], v[106:107], v[10:11] op_sel:[0,1] op_sel_hi:[1,1]
    v_pk_fma_f32 v[108:109], v[168:169], v[10:11], v[108:109] op_sel_hi:[1,0,1] neg_lo:[0,1,0] neg_hi:[0,1,0]
    v_pk_mul_f32 v[108:109], v[108:109], v[10:11] op_sel:[0,1] op_sel_hi:[1,1]
    v_pk_fma_f32 v[110:111], v[170:171], v[10:11], v[110:111] op_sel_hi:[1,0,1] neg_lo:[0,1,0] neg_hi:[0,1,0]
    v_pk_mul_f32 v[110:111], v[110:111], v[10:11] op_sel:[0,1] op_sel_hi:[1,1]
    v_pk_fma_f32 v[112:113], v[172:173], v[10:11], v[112:113] op_sel_hi:[1,0,1] neg_lo:[0,1,0] neg_hi:[0,1,0]
    v_pk_mul_f32 v[112:113], v[112:113], v[10:11] op_sel:[0,1] op_sel_hi:[1,1]
    v_pk_fma_f32 v[114:115], v[174:175], v[10:11], v[114:115] op_sel_hi:[1,0,1] neg_lo:[0,1,0] neg_hi:[0,1,0]
    v_pk_mul_f32 v[114:115], v[114:115], v[10:11] op_sel:[0,1] op_sel_hi:[1,1]
    v_pk_fma_f32 v[116:117], v[176:177], v[10:11], v[116:117] op_sel_hi:[1,0,1] neg_lo:[0,1,0] neg_hi:[0,1,0]
    v_pk_mul_f32 v[116:117], v[116:117], v[10:11] op_sel:[0,1] op_sel_hi:[1,1]
    v_pk_fma_f32 v[118:119], v[178:179], v[10:11], v[118:119] op_sel_hi:[1,0,1] neg_lo:[0,1,0] neg_hi:[0,1,0]
    v_pk_mul_f32 v[118:119], v[118:119], v[10:11] op_sel:[0,1] op_sel_hi:[1,1]
    v_pk_mul_f32 v[24:25], v[100:101], v[100:101]
    v_pk_mul_f32 v[26:27], v[102:103], v[102:103]
    v_pk_mul_f32 v[28:29], v[104:105], v[104:105]
    v_pk_mul_f32 v[30:31], v[106:107], v[106:107]
    v_pk_fma_f32 v[24:25], v[24:25], s[48:49], v[40:41]
    v_pk_fma_f32 v[26:27], v[26:27], s[48:49], v[40:41]
    v_pk_fma_f32 v[28:29], v[28:29], s[48:49], v[40:41]
    v_pk_fma_f32 v[30:31], v[30:31], s[48:49], v[40:41]
    v_pk_mul_f32 v[24:25], v[24:25], v[100:101]
    v_pk_mul_f32 v[26:27], v[26:27], v[102:103]
    v_pk_mul_f32 v[28:29], v[28:29], v[104:105]
    v_pk_mul_f32 v[30:31], v[30:31], v[106:107]
    v_exp_f32 v24, v24
    v_exp_f32 v25, v25
    v_exp_f32 v26, v26
    v_exp_f32 v27, v27
    v_exp_f32 v28, v28
    v_exp_f32 v29, v29
    v_exp_f32 v30, v30
    v_exp_f32 v31, v31
    v_pk_add_f32 v[24:25], v[24:25], 1.0 op_sel_hi:[1,0]
    v_pk_add_f32 v[26:27], v[26:27], 1.0 op_sel_hi:[1,0]
    v_pk_add_f32 v[28:29], v[28:29], 1.0 op_sel_hi:[1,0]
    v_pk_add_f32 v[30:31], v[30:31], 1.0 op_sel_hi:[1,0]
    v_rcp_f32 v24, v24
    v_rcp_f32 v25, v25
    v_rcp_f32 v26, v26
    v_rcp_f32 v27, v27
    v_rcp_f32 v28, v28
    v_rcp_f32 v29, v29
    v_rcp_f32 v30, v30
    v_rcp_f32 v31, v31
    v_pk_mul_f32 v[100:101], v[24:25], v[100:101]
    v_pk_mul_f32 v[102:103], v[26:27], v[102:103]
    v_pk_mul_f32 v[104:105], v[28:29], v[104:105]
    v_pk_mul_f32 v[106:107], v[30:31], v[106:107]
    v_cvt_pk_bf16_f32 v100, v100, v101
    v_cvt_pk_bf16_f32 v101, v102, v103
    ds_write_b64 v201, v[100:101] offset:2560
    v_cvt_pk_bf16_f32 v104, v104, v105
    v_cvt_pk_bf16_f32 v105, v106, v107
    ds_write_b64 v201, v[104:105] offset:2592
    v_pk_mul_f32 v[24:25], v[108:109], v[108:109]
    v_pk_mul_f32 v[26:27], v[110:111], v[110:111]
    v_pk_mul_f32 v[28:29], v[112:113], v[112:113]
    v_pk_mul_f32 v[30:31], v[114:115], v[114:115]
    v_pk_fma_f32 v[24:25], v[24:25], s[48:49], v[40:41]
    v_pk_fma_f32 v[26:27], v[26:27], s[48:49], v[40:41]
    v_pk_fma_f32 v[28:29], v[28:29], s[48:49], v[40:41]
    v_pk_fma_f32 v[30:31], v[30:31], s[48:49], v[40:41]
    v_pk_mul_f32 v[24:25], v[24:25], v[108:109]
    v_pk_mul_f32 v[26:27], v[26:27], v[110:111]
    v_pk_mul_f32 v[28:29], v[28:29], v[112:113]
    v_pk_mul_f32 v[30:31], v[30:31], v[114:115]
    v_exp_f32 v24, v24
    v_exp_f32 v25, v25
    v_exp_f32 v26, v26
    v_exp_f32 v27, v27
    v_exp_f32 v28, v28
    v_exp_f32 v29, v29
    v_exp_f32 v30, v30
    v_exp_f32 v31, v31
    v_pk_add_f32 v[24:25], v[24:25], 1.0 op_sel_hi:[1,0]
    v_pk_add_f32 v[26:27], v[26:27], 1.0 op_sel_hi:[1,0]
    v_pk_add_f32 v[28:29], v[28:29], 1.0 op_sel_hi:[1,0]
    v_pk_add_f32 v[30:31], v[30:31], 1.0 op_sel_hi:[1,0]
    v_rcp_f32 v24, v24
    v_rcp_f32 v25, v25
    v_rcp_f32 v26, v26
    v_rcp_f32 v27, v27
    v_rcp_f32 v28, v28
    v_rcp_f32 v29, v29
    v_rcp_f32 v30, v30
    v_rcp_f32 v31, v31
    v_pk_mul_f32 v[108:109], v[24:25], v[108:109]
    v_pk_mul_f32 v[110:111], v[26:27], v[110:111]
    v_pk_mul_f32 v[112:113], v[28:29], v[112:113]
    v_pk_mul_f32 v[114:115], v[30:31], v[114:115]
    v_cvt_pk_bf16_f32 v108, v108, v109
    v_cvt_pk_bf16_f32 v109, v110, v111
    ds_write_b64 v201, v[108:109] offset:2624
    v_cvt_pk_bf16_f32 v112, v112, v113
    v_cvt_pk_bf16_f32 v113, v114, v115
    ds_write_b64 v201, v[112:113] offset:2656
    v_pk_mul_f32 v[24:25], v[116:117], v[116:117]
    v_pk_mul_f32 v[26:27], v[118:119], v[118:119]
    v_pk_fma_f32 v[24:25], v[24:25], s[48:49], v[40:41]
    v_pk_fma_f32 v[26:27], v[26:27], s[48:49], v[40:41]
    v_pk_mul_f32 v[24:25], v[24:25], v[116:117]
    v_pk_mul_f32 v[26:27], v[26:27], v[118:119]
    v_exp_f32 v24, v24
    v_exp_f32 v25, v25
    v_exp_f32 v26, v26
    v_exp_f32 v27, v27
    v_pk_add_f32 v[24:25], v[24:25], 1.0 op_sel_hi:[1,0]
    v_pk_add_f32 v[26:27], v[26:27], 1.0 op_sel_hi:[1,0]
    v_rcp_f32 v24, v24
    v_rcp_f32 v25, v25
    v_rcp_f32 v26, v26
    v_rcp_f32 v27, v27
    v_pk_mul_f32 v[116:117], v[24:25], v[116:117]
    v_pk_mul_f32 v[118:119], v[26:27], v[118:119]
    v_cvt_pk_bf16_f32 v116, v116, v117
    v_cvt_pk_bf16_f32 v117, v118, v119
    ds_write_b64 v201, v[116:117] offset:2688
    v_pk_fma_f32 v[120:121], v[160:161], v[12:13], v[120:121] op_sel_hi:[1,0,1] neg_lo:[0,1,0] neg_hi:[0,1,0]
    v_pk_mul_f32 v[120:121], v[120:121], v[12:13] op_sel:[0,1] op_sel_hi:[1,1]
    v_pk_fma_f32 v[122:123], v[162:163], v[12:13], v[122:123] op_sel_hi:[1,0,1] neg_lo:[0,1,0] neg_hi:[0,1,0]
    v_pk_mul_f32 v[122:123], v[122:123], v[12:13] op_sel:[0,1] op_sel_hi:[1,1]
    v_pk_fma_f32 v[124:125], v[164:165], v[12:13], v[124:125] op_sel_hi:[1,0,1] neg_lo:[0,1,0] neg_hi:[0,1,0]
    v_pk_mul_f32 v[124:125], v[124:125], v[12:13] op_sel:[0,1] op_sel_hi:[1,1]
    v_pk_fma_f32 v[126:127], v[166:167], v[12:13], v[126:127] op_sel_hi:[1,0,1] neg_lo:[0,1,0] neg_hi:[0,1,0]
    v_pk_mul_f32 v[126:127], v[126:127], v[12:13] op_sel:[0,1] op_sel_hi:[1,1]
    v_pk_fma_f32 v[128:129], v[168:169], v[12:13], v[128:129] op_sel_hi:[1,0,1] neg_lo:[0,1,0] neg_hi:[0,1,0]
    v_pk_mul_f32 v[128:129], v[128:129], v[12:13] op_sel:[0,1] op_sel_hi:[1,1]
    v_pk_fma_f32 v[130:131], v[170:171], v[12:13], v[130:131] op_sel_hi:[1,0,1] neg_lo:[0,1,0] neg_hi:[0,1,0]
    v_pk_mul_f32 v[130:131], v[130:131], v[12:13] op_sel:[0,1] op_sel_hi:[1,1]
    v_pk_fma_f32 v[132:133], v[172:173], v[12:13], v[132:133] op_sel_hi:[1,0,1] neg_lo:[0,1,0] neg_hi:[0,1,0]
    v_pk_mul_f32 v[132:133], v[132:133], v[12:13] op_sel:[0,1] op_sel_hi:[1,1]
    v_pk_fma_f32 v[134:135], v[174:175], v[12:13], v[134:135] op_sel_hi:[1,0,1] neg_lo:[0,1,0] neg_hi:[0,1,0]
    v_pk_mul_f32 v[134:135], v[134:135], v[12:13] op_sel:[0,1] op_sel_hi:[1,1]
    v_pk_fma_f32 v[136:137], v[176:177], v[12:13], v[136:137] op_sel_hi:[1,0,1] neg_lo:[0,1,0] neg_hi:[0,1,0]
    v_pk_mul_f32 v[136:137], v[136:137], v[12:13] op_sel:[0,1] op_sel_hi:[1,1]
    v_pk_fma_f32 v[138:139], v[178:179], v[12:13], v[138:139] op_sel_hi:[1,0,1] neg_lo:[0,1,0] neg_hi:[0,1,0]
    v_pk_mul_f32 v[138:139], v[138:139], v[12:13] op_sel:[0,1] op_sel_hi:[1,1]
    v_pk_mul_f32 v[24:25], v[120:121], v[120:121]
    v_pk_mul_f32 v[26:27], v[122:123], v[122:123]
    v_pk_mul_f32 v[28:29], v[124:125], v[124:125]
    v_pk_mul_f32 v[30:31], v[126:127], v[126:127]
    v_pk_fma_f32 v[24:25], v[24:25], s[48:49], v[40:41]
    v_pk_fma_f32 v[26:27], v[26:27], s[48:49], v[40:41]
    v_pk_fma_f32 v[28:29], v[28:29], s[48:49], v[40:41]
    v_pk_fma_f32 v[30:31], v[30:31], s[48:49], v[40:41]
    v_pk_mul_f32 v[24:25], v[24:25], v[120:121]
    v_pk_mul_f32 v[26:27], v[26:27], v[122:123]
    v_pk_mul_f32 v[28:29], v[28:29], v[124:125]
    v_pk_mul_f32 v[30:31], v[30:31], v[126:127]
    v_exp_f32 v24, v24
    v_exp_f32 v25, v25
    v_exp_f32 v26, v26
    v_exp_f32 v27, v27
    v_exp_f32 v28, v28
    v_exp_f32 v29, v29
    v_exp_f32 v30, v30
    v_exp_f32 v31, v31
    v_pk_add_f32 v[24:25], v[24:25], 1.0 op_sel_hi:[1,0]
    v_pk_add_f32 v[26:27], v[26:27], 1.0 op_sel_hi:[1,0]
    v_pk_add_f32 v[28:29], v[28:29], 1.0 op_sel_hi:[1,0]
    v_pk_add_f32 v[30:31], v[30:31], 1.0 op_sel_hi:[1,0]
    v_rcp_f32 v24, v24
    v_rcp_f32 v25, v25
    v_rcp_f32 v26, v26
    v_rcp_f32 v27, v27
    v_rcp_f32 v28, v28
    v_rcp_f32 v29, v29
    v_rcp_f32 v30, v30
    v_rcp_f32 v31, v31
    v_pk_mul_f32 v[120:121], v[24:25], v[120:121]
    v_pk_mul_f32 v[122:123], v[26:27], v[122:123]
    v_pk_mul_f32 v[124:125], v[28:29], v[124:125]
    v_pk_mul_f32 v[126:127], v[30:31], v[126:127]
    v_cvt_pk_bf16_f32 v120, v120, v121
    v_cvt_pk_bf16_f32 v121, v122, v123
    ds_write_b64 v202, v[120:121] offset:0
    v_cvt_pk_bf16_f32 v124, v124, v125
    v_cvt_pk_bf16_f32 v125, v126, v127
    ds_write_b64 v202, v[124:125] offset:32
    v_pk_mul_f32 v[24:25], v[128:129], v[128:129]
    v_pk_mul_f32 v[26:27], v[130:131], v[130:131]
    v_pk_mul_f32 v[28:29], v[132:133], v[132:133]
    v_pk_mul_f32 v[30:31], v[134:135], v[134:135]
    v_pk_fma_f32 v[24:25], v[24:25], s[48:49], v[40:41]
    v_pk_fma_f32 v[26:27], v[26:27], s[48:49], v[40:41]
    v_pk_fma_f32 v[28:29], v[28:29], s[48:49], v[40:41]
    v_pk_fma_f32 v[30:31], v[30:31], s[48:49], v[40:41]
    v_pk_mul_f32 v[24:25], v[24:25], v[128:129]
    v_pk_mul_f32 v[26:27], v[26:27], v[130:131]
    v_pk_mul_f32 v[28:29], v[28:29], v[132:133]
    v_pk_mul_f32 v[30:31], v[30:31], v[134:135]
    v_exp_f32 v24, v24
    v_exp_f32 v25, v25
    v_exp_f32 v26, v26
    v_exp_f32 v27, v27
    v_exp_f32 v28, v28
    v_exp_f32 v29, v29
    v_exp_f32 v30, v30
    v_exp_f32 v31, v31
    v_pk_add_f32 v[24:25], v[24:25], 1.0 op_sel_hi:[1,0]
    v_pk_add_f32 v[26:27], v[26:27], 1.0 op_sel_hi:[1,0]
    v_pk_add_f32 v[28:29], v[28:29], 1.0 op_sel_hi:[1,0]
    v_pk_add_f32 v[30:31], v[30:31], 1.0 op_sel_hi:[1,0]
    v_rcp_f32 v24, v24
    v_rcp_f32 v25, v25
    v_rcp_f32 v26, v26
    v_rcp_f32 v27, v27
    v_rcp_f32 v28, v28
    v_rcp_f32 v29, v29
    v_rcp_f32 v30, v30
    v_rcp_f32 v31, v31
    v_pk_mul_f32 v[128:129], v[24:25], v[128:129]
    v_pk_mul_f32 v[130:131], v[26:27], v[130:131]
    v_pk_mul_f32 v[132:133], v[28:29], v[132:133]
    v_pk_mul_f32 v[134:135], v[30:31], v[134:135]
    v_cvt_pk_bf16_f32 v128, v128, v129
    v_cvt_pk_bf16_f32 v129, v130, v131
    ds_write_b64 v202, v[128:129] offset:64
    v_cvt_pk_bf16_f32 v132, v132, v133
    v_cvt_pk_bf16_f32 v133, v134, v135
    ds_write_b64 v202, v[132:133] offset:96
    v_pk_mul_f32 v[24:25], v[136:137], v[136:137]
    v_pk_mul_f32 v[26:27], v[138:139], v[138:139]
    v_pk_fma_f32 v[24:25], v[24:25], s[48:49], v[40:41]
    v_pk_fma_f32 v[26:27], v[26:27], s[48:49], v[40:41]
    v_pk_mul_f32 v[24:25], v[24:25], v[136:137]
    v_pk_mul_f32 v[26:27], v[26:27], v[138:139]
    v_exp_f32 v24, v24
    v_exp_f32 v25, v25
    v_exp_f32 v26, v26
    v_exp_f32 v27, v27
    v_pk_add_f32 v[24:25], v[24:25], 1.0 op_sel_hi:[1,0]
    v_pk_add_f32 v[26:27], v[26:27], 1.0 op_sel_hi:[1,0]
    v_rcp_f32 v24, v24
    v_rcp_f32 v25, v25
    v_rcp_f32 v26, v26
    v_rcp_f32 v27, v27
    v_pk_mul_f32 v[136:137], v[24:25], v[136:137]
    v_pk_mul_f32 v[138:139], v[26:27], v[138:139]
    v_cvt_pk_bf16_f32 v136, v136, v137
    v_cvt_pk_bf16_f32 v137, v138, v139
    ds_write_b64 v202, v[136:137] offset:128
    v_pk_fma_f32 v[140:141], v[160:161], v[14:15], v[140:141] op_sel_hi:[1,0,1] neg_lo:[0,1,0] neg_hi:[0,1,0]
    v_pk_mul_f32 v[140:141], v[140:141], v[14:15] op_sel:[0,1] op_sel_hi:[1,1]
    v_pk_fma_f32 v[142:143], v[162:163], v[14:15], v[142:143] op_sel_hi:[1,0,1] neg_lo:[0,1,0] neg_hi:[0,1,0]
    v_pk_mul_f32 v[142:143], v[142:143], v[14:15] op_sel:[0,1] op_sel_hi:[1,1]
    v_pk_fma_f32 v[144:145], v[164:165], v[14:15], v[144:145] op_sel_hi:[1,0,1] neg_lo:[0,1,0] neg_hi:[0,1,0]
    v_pk_mul_f32 v[144:145], v[144:145], v[14:15] op_sel:[0,1] op_sel_hi:[1,1]
    v_pk_fma_f32 v[146:147], v[166:167], v[14:15], v[146:147] op_sel_hi:[1,0,1] neg_lo:[0,1,0] neg_hi:[0,1,0]
    v_pk_mul_f32 v[146:147], v[146:147], v[14:15] op_sel:[0,1] op_sel_hi:[1,1]
    v_pk_fma_f32 v[148:149], v[168:169], v[14:15], v[148:149] op_sel_hi:[1,0,1] neg_lo:[0,1,0] neg_hi:[0,1,0]
    v_pk_mul_f32 v[148:149], v[148:149], v[14:15] op_sel:[0,1] op_sel_hi:[1,1]
    v_pk_fma_f32 v[150:151], v[170:171], v[14:15], v[150:151] op_sel_hi:[1,0,1] neg_lo:[0,1,0] neg_hi:[0,1,0]
    v_pk_mul_f32 v[150:151], v[150:151], v[14:15] op_sel:[0,1] op_sel_hi:[1,1]
    v_pk_fma_f32 v[152:153], v[172:173], v[14:15], v[152:153] op_sel_hi:[1,0,1] neg_lo:[0,1,0] neg_hi:[0,1,0]
    v_pk_mul_f32 v[152:153], v[152:153], v[14:15] op_sel:[0,1] op_sel_hi:[1,1]
    v_pk_fma_f32 v[154:155], v[174:175], v[14:15], v[154:155] op_sel_hi:[1,0,1] neg_lo:[0,1,0] neg_hi:[0,1,0]
    v_pk_mul_f32 v[154:155], v[154:155], v[14:15] op_sel:[0,1] op_sel_hi:[1,1]
    v_pk_fma_f32 v[156:157], v[176:177], v[14:15], v[156:157] op_sel_hi:[1,0,1] neg_lo:[0,1,0] neg_hi:[0,1,0]
    v_pk_mul_f32 v[156:157], v[156:157], v[14:15] op_sel:[0,1] op_sel_hi:[1,1]
    v_pk_fma_f32 v[158:159], v[178:179], v[14:15], v[158:159] op_sel_hi:[1,0,1] neg_lo:[0,1,0] neg_hi:[0,1,0]
    v_pk_mul_f32 v[158:159], v[158:159], v[14:15] op_sel:[0,1] op_sel_hi:[1,1]
    v_pk_mul_f32 v[24:25], v[140:141], v[140:141]
    v_pk_mul_f32 v[26:27], v[142:143], v[142:143]
    v_pk_mul_f32 v[28:29], v[144:145], v[144:145]
    v_pk_mul_f32 v[30:31], v[146:147], v[146:147]
    v_pk_fma_f32 v[24:25], v[24:25], s[48:49], v[40:41]
    v_pk_fma_f32 v[26:27], v[26:27], s[48:49], v[40:41]
    v_pk_fma_f32 v[28:29], v[28:29], s[48:49], v[40:41]
    v_pk_fma_f32 v[30:31], v[30:31], s[48:49], v[40:41]
    v_pk_mul_f32 v[24:25], v[24:25], v[140:141]
    v_pk_mul_f32 v[26:27], v[26:27], v[142:143]
    v_pk_mul_f32 v[28:29], v[28:29], v[144:145]
    v_pk_mul_f32 v[30:31], v[30:31], v[146:147]
    v_exp_f32 v24, v24
    v_exp_f32 v25, v25
    v_exp_f32 v26, v26
    v_exp_f32 v27, v27
    v_exp_f32 v28, v28
    v_exp_f32 v29, v29
    v_exp_f32 v30, v30
    v_exp_f32 v31, v31
    v_pk_add_f32 v[24:25], v[24:25], 1.0 op_sel_hi:[1,0]
    v_pk_add_f32 v[26:27], v[26:27], 1.0 op_sel_hi:[1,0]
    v_pk_add_f32 v[28:29], v[28:29], 1.0 op_sel_hi:[1,0]
    v_pk_add_f32 v[30:31], v[30:31], 1.0 op_sel_hi:[1,0]
    v_rcp_f32 v24, v24
    v_rcp_f32 v25, v25
    v_rcp_f32 v26, v26
    v_rcp_f32 v27, v27
    v_rcp_f32 v28, v28
    v_rcp_f32 v29, v29
    v_rcp_f32 v30, v30
    v_rcp_f32 v31, v31
    v_pk_mul_f32 v[140:141], v[24:25], v[140:141]
    v_pk_mul_f32 v[142:143], v[26:27], v[142:143]
    v_pk_mul_f32 v[144:145], v[28:29], v[144:145]
    v_pk_mul_f32 v[146:147], v[30:31], v[146:147]
    v_cvt_pk_bf16_f32 v140, v140, v141
    v_cvt_pk_bf16_f32 v141, v142, v143
    ds_write_b64 v202, v[140:141] offset:2560
    v_cvt_pk_bf16_f32 v144, v144, v145
    v_cvt_pk_bf16_f32 v145, v146, v147
    ds_write_b64 v202, v[144:145] offset:2592
    v_pk_mul_f32 v[24:25], v[148:149], v[148:149]
    v_pk_mul_f32 v[26:27], v[150:151], v[150:151]
    v_pk_mul_f32 v[28:29], v[152:153], v[152:153]
    v_pk_mul_f32 v[30:31], v[154:155], v[154:155]
    v_pk_fma_f32 v[24:25], v[24:25], s[48:49], v[40:41]
    v_pk_fma_f32 v[26:27], v[26:27], s[48:49], v[40:41]
    v_pk_fma_f32 v[28:29], v[28:29], s[48:49], v[40:41]
    v_pk_fma_f32 v[30:31], v[30:31], s[48:49], v[40:41]
    v_pk_mul_f32 v[24:25], v[24:25], v[148:149]
    v_pk_mul_f32 v[26:27], v[26:27], v[150:151]
    v_pk_mul_f32 v[28:29], v[28:29], v[152:153]
    v_pk_mul_f32 v[30:31], v[30:31], v[154:155]
    v_exp_f32 v24, v24
    v_exp_f32 v25, v25
    v_exp_f32 v26, v26
    v_exp_f32 v27, v27
    v_exp_f32 v28, v28
    v_exp_f32 v29, v29
    v_exp_f32 v30, v30
    v_exp_f32 v31, v31
    v_pk_add_f32 v[24:25], v[24:25], 1.0 op_sel_hi:[1,0]
    v_pk_add_f32 v[26:27], v[26:27], 1.0 op_sel_hi:[1,0]
    v_pk_add_f32 v[28:29], v[28:29], 1.0 op_sel_hi:[1,0]
    v_pk_add_f32 v[30:31], v[30:31], 1.0 op_sel_hi:[1,0]
    v_rcp_f32 v24, v24
    v_rcp_f32 v25, v25
    v_rcp_f32 v26, v26
    v_rcp_f32 v27, v27
    v_rcp_f32 v28, v28
    v_rcp_f32 v29, v29
    v_rcp_f32 v30, v30
    v_rcp_f32 v31, v31
    v_pk_mul_f32 v[148:149], v[24:25], v[148:149]
    v_pk_mul_f32 v[150:151], v[26:27], v[150:151]
    v_pk_mul_f32 v[152:153], v[28:29], v[152:153]
    v_pk_mul_f32 v[154:155], v[30:31], v[154:155]
    v_cvt_pk_bf16_f32 v148, v148, v149
    v_cvt_pk_bf16_f32 v149, v150, v151
    ds_write_b64 v202, v[148:149] offset:2624
    v_cvt_pk_bf16_f32 v152, v152, v153
    v_cvt_pk_bf16_f32 v153, v154, v155
    ds_write_b64 v202, v[152:153] offset:2656
    v_pk_mul_f32 v[24:25], v[156:157], v[156:157]
    v_pk_mul_f32 v[26:27], v[158:159], v[158:159]
    v_pk_fma_f32 v[24:25], v[24:25], s[48:49], v[40:41]
    v_pk_fma_f32 v[26:27], v[26:27], s[48:49], v[40:41]
    v_pk_mul_f32 v[24:25], v[24:25], v[156:157]
    v_pk_mul_f32 v[26:27], v[26:27], v[158:159]
    v_exp_f32 v24, v24
    v_exp_f32 v25, v25
    v_exp_f32 v26, v26
    v_exp_f32 v27, v27
    v_pk_add_f32 v[24:25], v[24:25], 1.0 op_sel_hi:[1,0]
    v_pk_add_f32 v[26:27], v[26:27], 1.0 op_sel_hi:[1,0]
    v_rcp_f32 v24, v24
    v_rcp_f32 v25, v25
    v_rcp_f32 v26, v26
    v_rcp_f32 v27, v27
    v_pk_mul_f32 v[156:157], v[24:25], v[156:157]
    v_pk_mul_f32 v[158:159], v[26:27], v[158:159]
    v_cvt_pk_bf16_f32 v156, v156, v157
    v_cvt_pk_bf16_f32 v157, v158, v159
    ds_write_b64 v202, v[156:157] offset:2688
    s_add_u32 s12, s32, 0x780000
    s_addc_u32 s13, s33, 0
    s_mov_b32 s14, 0x280000
    s_mov_b32 s15, 0x00020000
    v_lshlrev_b32 v5, 4, v0
    v_add_u32 v6, s36, v5
    s_waitcnt lgkmcnt(0)
    ds_read_b128 v[80:83], v6 offset:0
    ds_read_b128 v[84:87], v6 offset:960
    ds_read_b128 v[88:91], v6 offset:1920
    ds_read_b128 v[92:95], v6 offset:2880
    ds_read_b128 v[96:99], v6 offset:3840
    ds_read_b128 v[100:103], v6 offset:4800
    ds_read_b128 v[104:107], v6 offset:5760
    ds_read_b128 v[108:111], v6 offset:6720
    ds_read_b128 v[112:115], v6 offset:7680
    ds_read_b128 v[116:119], v6 offset:8640
    ds_read_b128 v[120:123], v6 offset:9600
    v_mul_u32_u24 v7, 205, v0
    v_lshrrev_b32 v7, 11, v7
    v_mul_u32_u24 v17, 10, v7
    v_sub_u32 v17, v0, v17
    v_mul_u32_u24 v24, 1280, v7
    v_lshl_add_u32 v24, v17, 4, v24
    v_mov_b32 v25, 0x7ff00000
    v_cmp_gt_u32 vcc, 6, v7
    s_nop 1
    v_cndmask_b32 v26, v25, v24, vcc
    v_cmp_gt_u32 vcc, 4, v7
    s_nop 1
    v_cndmask_b32 v27, v25, v24, vcc
    s_lshl_b32 s47, s28, 6
    s_add_u32 s47, s47, s42
    s_mul_i32 s47, s47, 1280
    s_sub_u32 s46, s41, 12
    s_mul_i32 s46, s46, 320
    s_mul_i32 s30, s29, 160
    s_add_u32 s46, s46, s30
    s_add_u32 s47, s47, s46
    s_add_u32 s52, s47, 0
    s_waitcnt lgkmcnt(10)
    buffer_store_dwordx4 v[80:83], v26, s[12:15], s52 offen
    s_add_u32 s53, s47, 7680
    s_waitcnt lgkmcnt(9)
    buffer_store_dwordx4 v[84:87], v26, s[12:15], s53 offen
    s_add_u32 s54, s47, 15360
    s_waitcnt lgkmcnt(8)
    buffer_store_dwordx4 v[88:91], v26, s[12:15], s54 offen
    s_add_u32 s55, s47, 23040
    s_waitcnt lgkmcnt(7)
    buffer_store_dwordx4 v[92:95], v26, s[12:15], s55 offen
    s_add_u32 s52, s47, 30720
    s_waitcnt lgkmcnt(6)
    buffer_store_dwordx4 v[96:99], v26, s[12:15], s52 offen
    s_add_u32 s53, s47, 38400
    s_waitcnt lgkmcnt(5)
    buffer_store_dwordx4 v[100:103], v26, s[12:15], s53 offen
    s_add_u32 s54, s47, 46080
    s_waitcnt lgkmcnt(4)
    buffer_store_dwordx4 v[104:107], v26, s[12:15], s54 offen
    s_add_u32 s55, s47, 53760
    s_waitcnt lgkmcnt(3)
    buffer_store_dwordx4 v[108:111], v26, s[12:15], s55 offen
    s_add_u32 s52, s47, 61440
    s_waitcnt lgkmcnt(2)
    buffer_store_dwordx4 v[112:115], v26, s[12:15], s52 offen
    s_add_u32 s53, s47, 69120
    s_waitcnt lgkmcnt(1)
    buffer_store_dwordx4 v[116:119], v26, s[12:15], s53 offen
    s_add_u32 s54, s47, 76800
    s_waitcnt lgkmcnt(0)
    buffer_store_dwordx4 v[120:123], v27, s[12:15], s54 offen
    s_branch k1_kernel_done
k1_kernel_epv:
    s_mul_i32 s36, s26, 12288
    s_lshl_b32 s30, s28, 6
    v_lshlrev_b32 v7, 2, v6
    v_add_u32 v7, s30, v7
    v_lshlrev_b32 v41, 2, v7
    v_add_u32 v41, 110592, v41
    s_lshl_b32 s46, s29, 7
    v_xor_b32 v41, s46, v41
    v_xor_b32 v7, 128, v41
    ds_read_b128 v[8:11], v41 offset:0
    ds_read_b128 v[12:15], v41 offset:512
    ds_read_b128 v[16:19], v41 offset:64
    ds_read_b128 v[20:23], v41 offset:576
    ds_read_b128 v[24:27], v7 offset:0
    ds_read_b128 v[28:31], v7 offset:512
    ds_read_b128 v[32:35], v7 offset:64
    ds_read_b128 v[36:39], v7 offset:576
    v_and_b32 v44, 1, v6
    v_mul_u32_u24 v44, 352, v44
    v_lshrrev_b32 v45, 1, v6
    v_lshl_add_u32 v44, v45, 3, v44
    v_add_u32 v44, s36, v44
    v_add_u32 v7, 0, v5
    v_mul_u32_u24 v41, 205, v7
    v_lshrrev_b32 v41, 12, v41
    v_mul_u32_u24 v45, 20, v41
    v_sub_u32 v7, v7, v45
    v_mul_u32_u24 v41, 2816, v41
    v_lshl_add_u32 v41, v7, 4, v41
    v_add_u32 v200, v41, v44
    v_add_u32 v7, 16, v5
    v_mul_u32_u24 v41, 205, v7
    v_lshrrev_b32 v41, 12, v41
    v_mul_u32_u24 v45, 20, v41
    v_sub_u32 v7, v7, v45
    v_mul_u32_u24 v41, 2816, v41
    v_lshl_add_u32 v41, v7, 4, v41
    v_add_u32 v201, v41, v44
    v_add_u32 v7, 32, v5
    v_mul_u32_u24 v41, 205, v7
    v_lshrrev_b32 v41, 12, v41
    v_mul_u32_u24 v45, 20, v41
    v_sub_u32 v7, v7, v45
    v_mul_u32_u24 v41, 2816, v41
    v_lshl_add_u32 v41, v7, 4, v41
    v_add_u32 v202, v41, v44
    v_add_u32 v7, 48, v5
    v_mul_u32_u24 v41, 205, v7
    v_lshrrev_b32 v41, 12, v41
    v_mul_u32_u24 v45, 20, v41
    v_sub_u32 v7, v7, v45
    v_mul_u32_u24 v41, 2816, v41
    v_lshl_add_u32 v41, v7, 4, v41
    v_add_u32 v203, v41, v44
    v_add_u32 v7, 64, v5
    v_mul_u32_u24 v41, 205, v7
    v_lshrrev_b32 v41, 12, v41
    v_mul_u32_u24 v45, 20, v41
    v_sub_u32 v7, v7, v45
    v_mul_u32_u24 v41, 2816, v41
    v_lshl_add_u32 v41, v7, 4, v41
    v_add_u32 v204, v41, v44
    v_lshrrev_b32 v7, 3, v0
    v_mul_u32_u24 v7, 1408, v7
    v_lshrrev_b32 v41, 1, v0
    v_and_b32 v41, 3, v41
    v_mul_u32_u24 v41, 352, v41
    v_and_b32 v45, 1, v0
    v_lshlrev_b32 v46, 4, v45
    v_add3_u32 v7, v7, v41, v46
    v_add_u32 v7, s36, v7
    v_cmp_eq_u32 vcc, 0, v45
    v_mov_b32 v46, 0x3f803f80
    s_nop 0
    v_cndmask_b32 v48, 0, v46, vcc
    v_mov_b32 v49, v48
    v_mov_b32 v50, v48
    v_mov_b32 v51, v48
    ds_write_b128 v7, v[48:51] offset:320
    s_waitcnt lgkmcnt(1)
    v_fma_f32 v80, -v8, v160, v80
    v_fma_f32 v81, -v9, v160, v81
    v_fma_f32 v82, -v10, v160, v82
    v_fma_f32 v83, -v11, v160, v83
    v_pk_mul_f32 v[80:81], v[80:81], v[12:13]
    v_pk_mul_f32 v[82:83], v[82:83], v[14:15]
    v_cvt_pk_bf16_f32 v80, v80, v81
    v_cvt_pk_bf16_f32 v81, v82, v83
    ds_write_b64 v200, v[80:81] offset:0
    v_fma_f32 v84, -v8, v164, v84
    v_fma_f32 v85, -v9, v164, v85
    v_fma_f32 v86, -v10, v164, v86
    v_fma_f32 v87, -v11, v164, v87
    v_pk_mul_f32 v[84:85], v[84:85], v[12:13]
    v_pk_mul_f32 v[86:87], v[86:87], v[14:15]
    v_cvt_pk_bf16_f32 v84, v84, v85
    v_cvt_pk_bf16_f32 v85, v86, v87
    ds_write_b64 v201, v[84:85] offset:0
    v_fma_f32 v88, -v8, v168, v88
    v_fma_f32 v89, -v9, v168, v89
    v_fma_f32 v90, -v10, v168, v90
    v_fma_f32 v91, -v11, v168, v91
    v_pk_mul_f32 v[88:89], v[88:89], v[12:13]
    v_pk_mul_f32 v[90:91], v[90:91], v[14:15]
    v_cvt_pk_bf16_f32 v88, v88, v89
    v_cvt_pk_bf16_f32 v89, v90, v91
    ds_write_b64 v202, v[88:89] offset:0
    v_fma_f32 v92, -v8, v172, v92
    v_fma_f32 v93, -v9, v172, v93
    v_fma_f32 v94, -v10, v172, v94
    v_fma_f32 v95, -v11, v172, v95
    v_pk_mul_f32 v[92:93], v[92:93], v[12:13]
    v_pk_mul_f32 v[94:95], v[94:95], v[14:15]
    v_cvt_pk_bf16_f32 v92, v92, v93
    v_cvt_pk_bf16_f32 v93, v94, v95
    ds_write_b64 v203, v[92:93] offset:0
    v_fma_f32 v96, -v8, v176, v96
    v_fma_f32 v97, -v9, v176, v97
    v_fma_f32 v98, -v10, v176, v98
    v_fma_f32 v99, -v11, v176, v99
    v_pk_mul_f32 v[96:97], v[96:97], v[12:13]
    v_pk_mul_f32 v[98:99], v[98:99], v[14:15]
    v_cvt_pk_bf16_f32 v96, v96, v97
    v_cvt_pk_bf16_f32 v97, v98, v99
    ds_write_b64 v204, v[96:97] offset:0
    v_fma_f32 v100, -v16, v160, v100
    v_fma_f32 v101, -v17, v160, v101
    v_fma_f32 v102, -v18, v160, v102
    v_fma_f32 v103, -v19, v160, v103
    v_pk_mul_f32 v[100:101], v[100:101], v[20:21]
    v_pk_mul_f32 v[102:103], v[102:103], v[22:23]
    v_cvt_pk_bf16_f32 v100, v100, v101
    v_cvt_pk_bf16_f32 v101, v102, v103
    ds_write_b64 v200, v[100:101] offset:704
    v_fma_f32 v104, -v16, v164, v104
    v_fma_f32 v105, -v17, v164, v105
    v_fma_f32 v106, -v18, v164, v106
    v_fma_f32 v107, -v19, v164, v107
    v_pk_mul_f32 v[104:105], v[104:105], v[20:21]
    v_pk_mul_f32 v[106:107], v[106:107], v[22:23]
    v_cvt_pk_bf16_f32 v104, v104, v105
    v_cvt_pk_bf16_f32 v105, v106, v107
    ds_write_b64 v201, v[104:105] offset:704
    v_fma_f32 v108, -v16, v168, v108
    v_fma_f32 v109, -v17, v168, v109
    v_fma_f32 v110, -v18, v168, v110
    v_fma_f32 v111, -v19, v168, v111
    v_pk_mul_f32 v[108:109], v[108:109], v[20:21]
    v_pk_mul_f32 v[110:111], v[110:111], v[22:23]
    v_cvt_pk_bf16_f32 v108, v108, v109
    v_cvt_pk_bf16_f32 v109, v110, v111
    ds_write_b64 v202, v[108:109] offset:704
    v_fma_f32 v112, -v16, v172, v112
    v_fma_f32 v113, -v17, v172, v113
    v_fma_f32 v114, -v18, v172, v114
    v_fma_f32 v115, -v19, v172, v115
    v_pk_mul_f32 v[112:113], v[112:113], v[20:21]
    v_pk_mul_f32 v[114:115], v[114:115], v[22:23]
    v_cvt_pk_bf16_f32 v112, v112, v113
    v_cvt_pk_bf16_f32 v113, v114, v115
    ds_write_b64 v203, v[112:113] offset:704
    v_fma_f32 v116, -v16, v176, v116
    v_fma_f32 v117, -v17, v176, v117
    v_fma_f32 v118, -v18, v176, v118
    v_fma_f32 v119, -v19, v176, v119
    v_pk_mul_f32 v[116:117], v[116:117], v[20:21]
    v_pk_mul_f32 v[118:119], v[118:119], v[22:23]
    v_cvt_pk_bf16_f32 v116, v116, v117
    v_cvt_pk_bf16_f32 v117, v118, v119
    ds_write_b64 v204, v[116:117] offset:704
    v_fma_f32 v120, -v24, v160, v120
    v_fma_f32 v121, -v25, v160, v121
    v_fma_f32 v122, -v26, v160, v122
    v_fma_f32 v123, -v27, v160, v123
    v_pk_mul_f32 v[120:121], v[120:121], v[28:29]
    v_pk_mul_f32 v[122:123], v[122:123], v[30:31]
    v_cvt_pk_bf16_f32 v120, v120, v121
    v_cvt_pk_bf16_f32 v121, v122, v123
    ds_write_b64 v200, v[120:121] offset:1408
    v_fma_f32 v124, -v24, v164, v124
    v_fma_f32 v125, -v25, v164, v125
    v_fma_f32 v126, -v26, v164, v126
    v_fma_f32 v127, -v27, v164, v127
    v_pk_mul_f32 v[124:125], v[124:125], v[28:29]
    v_pk_mul_f32 v[126:127], v[126:127], v[30:31]
    v_cvt_pk_bf16_f32 v124, v124, v125
    v_cvt_pk_bf16_f32 v125, v126, v127
    ds_write_b64 v201, v[124:125] offset:1408
    v_fma_f32 v128, -v24, v168, v128
    v_fma_f32 v129, -v25, v168, v129
    v_fma_f32 v130, -v26, v168, v130
    v_fma_f32 v131, -v27, v168, v131
    v_pk_mul_f32 v[128:129], v[128:129], v[28:29]
    v_pk_mul_f32 v[130:131], v[130:131], v[30:31]
    v_cvt_pk_bf16_f32 v128, v128, v129
    v_cvt_pk_bf16_f32 v129, v130, v131
    ds_write_b64 v202, v[128:129] offset:1408
    v_fma_f32 v132, -v24, v172, v132
    v_fma_f32 v133, -v25, v172, v133
    v_fma_f32 v134, -v26, v172, v134
    v_fma_f32 v135, -v27, v172, v135
    v_pk_mul_f32 v[132:133], v[132:133], v[28:29]
    v_pk_mul_f32 v[134:135], v[134:135], v[30:31]
    v_cvt_pk_bf16_f32 v132, v132, v133
    v_cvt_pk_bf16_f32 v133, v134, v135
    ds_write_b64 v203, v[132:133] offset:1408
    v_fma_f32 v136, -v24, v176, v136
    v_fma_f32 v137, -v25, v176, v137
    v_fma_f32 v138, -v26, v176, v138
    v_fma_f32 v139, -v27, v176, v139
    v_pk_mul_f32 v[136:137], v[136:137], v[28:29]
    v_pk_mul_f32 v[138:139], v[138:139], v[30:31]
    v_cvt_pk_bf16_f32 v136, v136, v137
    v_cvt_pk_bf16_f32 v137, v138, v139
    ds_write_b64 v204, v[136:137] offset:1408
    v_fma_f32 v140, -v32, v160, v140
    v_fma_f32 v141, -v33, v160, v141
    v_fma_f32 v142, -v34, v160, v142
    v_fma_f32 v143, -v35, v160, v143
    v_pk_mul_f32 v[140:141], v[140:141], v[36:37]
    v_pk_mul_f32 v[142:143], v[142:143], v[38:39]
    v_cvt_pk_bf16_f32 v140, v140, v141
    v_cvt_pk_bf16_f32 v141, v142, v143
    ds_write_b64 v200, v[140:141] offset:2112
    v_fma_f32 v144, -v32, v164, v144
    v_fma_f32 v145, -v33, v164, v145
    v_fma_f32 v146, -v34, v164, v146
    v_fma_f32 v147, -v35, v164, v147
    v_pk_mul_f32 v[144:145], v[144:145], v[36:37]
    v_pk_mul_f32 v[146:147], v[146:147], v[38:39]
    v_cvt_pk_bf16_f32 v144, v144, v145
    v_cvt_pk_bf16_f32 v145, v146, v147
    ds_write_b64 v201, v[144:145] offset:2112
    v_fma_f32 v148, -v32, v168, v148
    v_fma_f32 v149, -v33, v168, v149
    v_fma_f32 v150, -v34, v168, v150
    v_fma_f32 v151, -v35, v168, v151
    v_pk_mul_f32 v[148:149], v[148:149], v[36:37]
    v_pk_mul_f32 v[150:151], v[150:151], v[38:39]
    v_cvt_pk_bf16_f32 v148, v148, v149
    v_cvt_pk_bf16_f32 v149, v150, v151
    ds_write_b64 v202, v[148:149] offset:2112
    v_fma_f32 v152, -v32, v172, v152
    v_fma_f32 v153, -v33, v172, v153
    v_fma_f32 v154, -v34, v172, v154
    v_fma_f32 v155, -v35, v172, v155
    v_pk_mul_f32 v[152:153], v[152:153], v[36:37]
    v_pk_mul_f32 v[154:155], v[154:155], v[38:39]
    v_cvt_pk_bf16_f32 v152, v152, v153
    v_cvt_pk_bf16_f32 v153, v154, v155
    ds_write_b64 v203, v[152:153] offset:2112
    v_fma_f32 v156, -v32, v176, v156
    v_fma_f32 v157, -v33, v176, v157
    v_fma_f32 v158, -v34, v176, v158
    v_fma_f32 v159, -v35, v176, v159
    v_pk_mul_f32 v[156:157], v[156:157], v[36:37]
    v_pk_mul_f32 v[158:159], v[158:159], v[38:39]
    v_cvt_pk_bf16_f32 v156, v156, v157
    v_cvt_pk_bf16_f32 v157, v158, v159
    ds_write_b64 v204, v[156:157] offset:2112
    s_add_u32 s12, s32, 0x1500000
    s_addc_u32 s13, s33, 0
    s_mov_b32 s14, 0x540000
    s_mov_b32 s15, 0x00020000
    s_sub_u32 s39, s41, 8
    s_lshl_b32 s39, s39, 3
    s_lshl_b32 s30, s29, 2
    s_add_u32 s39, s39, s30
    s_mul_i32 s39, s39, 172032
    s_lshl_b32 s46, s40, 2
    s_lshl_b32 s30, s28, 1
    s_add_u32 s46, s46, s30
    s_mul_i32 s46, s46, 2688
    s_add_u32 s39, s39, s46
    s_add_u32 s39, s39, 1280
    s_mul_i32 s46, s29, 2688
    s_xor_b32 s30, s29, 1
    s_mul_i32 s47, s30, 2688
    v_lshlrev_b32 v5, 4, v0
    v_add_u32 v6, s36, v5
    s_waitcnt lgkmcnt(0)
    ds_read_b128 v[80:83], v6 offset:0
    ds_read_b128 v[84:87], v6 offset:1408
    ds_read_b128 v[88:91], v6 offset:2816
    ds_read_b128 v[92:95], v6 offset:4224
    ds_read_b128 v[96:99], v6 offset:5632
    ds_read_b128 v[100:103], v6 offset:7040
    ds_read_b128 v[104:107], v6 offset:8448
    ds_read_b128 v[108:111], v6 offset:9856
    v_cmp_le_u32 vcc, 24, v0
    s_nop 1
    v_cndmask_b32 v7, 0, 1, vcc
    v_mul_u32_u24 v44, 24, v7
    v_sub_u32 v44, v0, v44
    v_lshlrev_b32 v44, 4, v44
    v_mul_u32_u24 v45, 1408, v7
    v_add3_u32 v45, v45, v44, s36
    ds_read_b128 v[112:115], v45 offset:1024
    ds_read_b128 v[116:119], v45 offset:3840
    ds_read_b128 v[120:123], v45 offset:6656
    ds_read_b128 v[124:127], v45 offset:9472
    v_xor_b32 v7, s29, v7
    v_mul_u32_u24 v7, 2688, v7
    v_add_u32 v7, v7, v44
    v_add_u32 v7, 1024, v7
    v_mov_b32 v47, 0x7ff00000
    v_cmp_gt_u32 vcc, 48, v0
    s_nop 1
    v_cndmask_b32 v7, v47, v7, vcc
    s_add_u32 s30, s39, 0
    s_add_u32 s52, s30, s46
    s_waitcnt lgkmcnt(11)
    buffer_store_dwordx4 v[80:83], v5, s[12:15], s52 offen
    s_add_u32 s30, s39, 0
    s_add_u32 s53, s30, s47
    s_waitcnt lgkmcnt(10)
    buffer_store_dwordx4 v[84:87], v5, s[12:15], s53 offen
    s_add_u32 s30, s39, 172032
    s_add_u32 s54, s30, s46
    s_waitcnt lgkmcnt(9)
    buffer_store_dwordx4 v[88:91], v5, s[12:15], s54 offen
    s_add_u32 s30, s39, 172032
    s_add_u32 s55, s30, s47
    s_waitcnt lgkmcnt(8)
    buffer_store_dwordx4 v[92:95], v5, s[12:15], s55 offen
    s_add_u32 s30, s39, 344064
    s_add_u32 s52, s30, s46
    s_waitcnt lgkmcnt(7)
    buffer_store_dwordx4 v[96:99], v5, s[12:15], s52 offen
    s_add_u32 s30, s39, 344064
    s_add_u32 s53, s30, s47
    s_waitcnt lgkmcnt(6)
    buffer_store_dwordx4 v[100:103], v5, s[12:15], s53 offen
    s_add_u32 s30, s39, 516096
    s_add_u32 s54, s30, s46
    s_waitcnt lgkmcnt(5)
    buffer_store_dwordx4 v[104:107], v5, s[12:15], s54 offen
    s_add_u32 s30, s39, 516096
    s_add_u32 s55, s30, s47
    s_waitcnt lgkmcnt(4)
    buffer_store_dwordx4 v[108:111], v5, s[12:15], s55 offen
    s_add_u32 s52, s39, 0
    s_waitcnt lgkmcnt(3)
    buffer_store_dwordx4 v[112:115], v7, s[12:15], s52 offen
    s_add_u32 s53, s39, 172032
    s_waitcnt lgkmcnt(2)
    buffer_store_dwordx4 v[116:119], v7, s[12:15], s53 offen
    s_add_u32 s54, s39, 344064
    s_waitcnt lgkmcnt(1)
    buffer_store_dwordx4 v[120:123], v7, s[12:15], s54 offen
    s_add_u32 s55, s39, 516096
    s_waitcnt lgkmcnt(0)
    buffer_store_dwordx4 v[124:127], v7, s[12:15], s55 offen
k1_kernel_done:
    s_endpgm
k1_kernel_exit:
    s_endpgm
.globl k2_kernel
.p2align 8
.type k2_kernel,@function
k2_kernel:
    s_cmp_ge_u32 s2, 512
    s_cbranch_scc1 k2_kernel_exit
    s_load_dwordx16 s[64:79], s[0:1], 0
    s_load_dwordx4 s[80:83], s[0:1], 64
    s_load_dwordx2 s[32:33], s[0:1], 80
    s_cmp_ge_u32 s2, 256
    s_cbranch_scc1 k2_kernel_bchain
    v_readfirstlane_b32 s26, v0
    v_and_b32 v0, 63, v0
    s_nop 2
    s_lshr_b32 s26, s26, 6
    s_setprio 3
    s_mul_i32 s27, s26, 3072
    v_lshlrev_b32 v5, 4, v0
    v_add_u32 v5, s27, v5
    s_mov_b32 s24, s27
    s_mov_b32 s31, 0
    s_mul_i32 s34, s26, 5
    s_cmp_gt_u32 s26, 0
    s_addc_u32 s34, s34, 0
    s_lshl_b32 s34, s34, 10
    s_cmp_eq_u32 s26, 0
    s_cselect_b32 s35, 6, 5
    s_cmp_ge_u32 s26, 4
    s_cselect_b32 s35, 0, s35
    v_lshlrev_b32 v7, 4, v0
    v_add_u32 v7, s34, v7
    v_and_b32 v1, 31, v0
    v_lshrrev_b32 v2, 5, v0
    v_mov_b32 v4, 1280
    v_lshlrev_b32 v8, 4, v0
    v_lshlrev_b32 v9, 3, v1
    v_add_u32 v9, 1024, v9
    v_min_u32 v10, 21, v1
    v_lshlrev_b32 v10, 4, v10
    v_mul_u32_u24 v3, 352, v2
    v_add3_u32 v10, v10, v3, v4
    v_add_u32 v11, 21504, v8
    v_add_u32 v12, 21504, v9
    v_add_u32 v13, 21504, v10
    v_mov_b32 v48, 0
    v_mov_b32 v49, 0
    v_mov_b32 v50, 0
    v_mov_b32 v51, 0
    v_mov_b32 v52, 0
    v_mov_b32 v53, 0
    v_mov_b32 v54, 0
    v_mov_b32 v55, 0
    v_mov_b32 v56, 0
    v_mov_b32 v57, 0
    v_mov_b32 v58, 0
    v_mov_b32 v59, 0
    v_mov_b32 v60, 0
    v_mov_b32 v61, 0
    v_mov_b32 v62, 0
    v_mov_b32 v63, 0
    v_mov_b32 v68, 0
    v_mov_b32 v84, 0
    v_mov_b32 v69, 0
    v_mov_b32 v85, 0
    v_mov_b32 v70, 0
    v_mov_b32 v86, 0
    v_mov_b32 v71, 0
    v_mov_b32 v87, 0
    v_lshlrev_b32 v6, 3, v1
    s_waitcnt lgkmcnt(0)
    s_add_u32 s4, s32, 0x1500000
    s_addc_u32 s5, s33, 0
    s_mov_b32 s6, 0x540000
    s_mov_b32 s7, 0x00020000
    s_add_u32 s8, s32, 0x2700000
    s_addc_u32 s9, s33, 0
    s_mov_b32 s10, 0x280000
    s_mov_b32 s11, 0x00020000
    s_and_b32 s3, s2, 7
    s_lshl_b32 s3, s3, 2
    s_lshr_b32 s16, s2, 3
    s_and_b32 s16, s16, 3
    s_add_u32 s40, s3, s16
    s_lshr_b32 s41, s2, 5
    s_mul_i32 s21, s40, 172032
    s_mov_b32 s42, s21
    s_cmp_eq_u32 s26, 7
    s_cbranch_scc1 k2_kernel_at_nodma0
    s_mov_b32 m0, s24
    s_nop 0
    buffer_load_dwordx4 v5, s[4:7], s21 offen offset:0 lds
    buffer_load_dwordx4 v5, s[4:7], s21 offen offset:1024 lds
    buffer_load_dwordx4 v5, s[4:7], s21 offen offset:2048 lds
k2_kernel_at_nodma0:
    s_mul_i32 s16, s40, 81920
    s_lshl_b32 s17, s41, 3
    s_add_u32 s17, s17, s26
    s_mul_i32 s17, s17, 1280
    s_add_u32 s16, s16, s17
    buffer_load_dwordx4 v[88:91], v8, s[8:11], s16 offen
    buffer_load_dwordx2 v[78:79], v6, s[8:11], s16 offen offset:1024
    s_add_u32 s21, s21, 21504
    s_add_u32 s24, s24, 21504
    s_cmp_eq_u32 s26, 7
    s_cbranch_scc1 k2_kernel_at_nodma0b
    s_mov_b32 m0, s24
    s_nop 0
    buffer_load_dwordx4 v5, s[4:7], s21 offen offset:0 lds
    buffer_load_dwordx4 v5, s[4:7], s21 offen offset:1024 lds
    buffer_load_dwordx4 v5, s[4:7], s21 offen offset:2048 lds
k2_kernel_at_nodma0b:
    v_cmp_eq_u32 vcc, 0, v2
    s_cmp_eq_u32 s26, 7
    s_cbranch_scc1 k2_kernel_at_w7
    s_waitcnt vmcnt(3)
    s_branch k2_kernel_at_w7b
k2_kernel_at_w7:
    s_waitcnt vmcnt(0)
k2_kernel_at_w7b:
    v_cndmask_b32 v78, 0, v78, vcc
    v_cndmask_b32 v79, 0, v79, vcc
    s_barrier
    ds_read_b128 v[72:75], v8
    ds_read_b64 v[76:77], v9
    s_waitcnt lgkmcnt(0)
    v_mfma_f32_32x32x16_bf16 v[16:31], v[72:75], v[88:91], 0
    v_mfma_f32_32x32x8_bf16 v[16:31], v[76:77], v[78:79], v[16:31]
    ds_read_b128 v[72:75], v8 offset:2688
    ds_read_b64 v[76:77], v9 offset:2688
    ds_read_b128 v[80:83], v10
    s_mov_b32 s19, 0
    s_mov_b32 s28, 1
    s_nop 9
    s_setprio 1
k2_kernel_at_loop:
    s_waitcnt lgkmcnt(1)
    v_exp_f32 v16, v16
    v_exp_f32 v17, v17
    v_exp_f32 v18, v18
    v_mfma_f32_32x32x16_bf16 v[32:47], v[72:75], v[88:91], 0
    v_exp_f32 v19, v19
    v_cvt_pk_bf16_f32 v64, v16, v17
    v_exp_f32 v20, v20
    v_cvt_pk_bf16_f32 v65, v18, v19
    v_exp_f32 v21, v21
    v_exp_f32 v22, v22
    v_mfma_f32_32x32x16_bf16 v[48:63], v[84:87], v[68:71], v[48:63]
    ds_read_b128 v[84:87], v10 offset:704
    v_exp_f32 v23, v23
    v_cvt_pk_bf16_f32 v66, v20, v21
    v_exp_f32 v24, v24
    v_cvt_pk_bf16_f32 v67, v22, v23
    v_exp_f32 v25, v25
    v_exp_f32 v26, v26
    v_mfma_f32_32x32x8_bf16 v[32:47], v[76:77], v[78:79], v[32:47]
    ds_read_b128 v[72:75], v8 offset:5376
    ds_read_b64 v[76:77], v9 offset:5376
    v_exp_f32 v27, v27
    v_cvt_pk_bf16_f32 v68, v24, v25
    v_exp_f32 v28, v28
    v_cvt_pk_bf16_f32 v69, v26, v27
    v_exp_f32 v29, v29
    s_waitcnt lgkmcnt(3)
    v_mfma_f32_32x32x16_bf16 v[48:63], v[80:83], v[64:67], v[48:63]
    ds_read_b128 v[80:83], v10 offset:2688
    s_cmp_le_u32 s31, 4
    s_cbranch_scc1 k2_kernel_at_d0_4
    s_add_u32 m0, s36, 4096
    s_nop 0
    buffer_load_dwordx4 v7, s[4:7], s38 offen offset:0 lds
k2_kernel_at_d0_4:
    s_cmp_le_u32 s31, 5
    s_cbranch_scc1 k2_kernel_at_d0_5
    s_add_u32 m0, s36, 4096
    s_nop 0
    buffer_load_dwordx4 v7, s[4:7], s38 offen offset:1024 lds
k2_kernel_at_d0_5:
    v_exp_f32 v30, v30
    v_exp_f32 v31, v31
    v_cvt_pk_bf16_f32 v70, v28, v29
    v_cvt_pk_bf16_f32 v71, v30, v31
    s_waitcnt lgkmcnt(1)
    v_exp_f32 v32, v32
    v_exp_f32 v33, v33
    v_exp_f32 v34, v34
    v_mfma_f32_32x32x16_bf16 v[16:31], v[72:75], v[88:91], 0
    v_exp_f32 v35, v35
    v_cvt_pk_bf16_f32 v64, v32, v33
    v_exp_f32 v36, v36
    v_cvt_pk_bf16_f32 v65, v34, v35
    v_exp_f32 v37, v37
    v_exp_f32 v38, v38
    v_mfma_f32_32x32x16_bf16 v[48:63], v[84:87], v[68:71], v[48:63]
    ds_read_b128 v[84:87], v10 offset:3392
    v_exp_f32 v39, v39
    v_cvt_pk_bf16_f32 v66, v36, v37
    v_exp_f32 v40, v40
    v_cvt_pk_bf16_f32 v67, v38, v39
    v_exp_f32 v41, v41
    v_exp_f32 v42, v42
    v_mfma_f32_32x32x8_bf16 v[16:31], v[76:77], v[78:79], v[16:31]
    ds_read_b128 v[72:75], v8 offset:8064
    ds_read_b64 v[76:77], v9 offset:8064
    v_exp_f32 v43, v43
    v_cvt_pk_bf16_f32 v68, v40, v41
    v_exp_f32 v44, v44
    v_cvt_pk_bf16_f32 v69, v42, v43
    v_exp_f32 v45, v45
    s_waitcnt lgkmcnt(3)
    v_mfma_f32_32x32x16_bf16 v[48:63], v[80:83], v[64:67], v[48:63]
    ds_read_b128 v[80:83], v10 offset:5376
    v_exp_f32 v46, v46
    v_exp_f32 v47, v47
    v_cvt_pk_bf16_f32 v70, v44, v45
    v_cvt_pk_bf16_f32 v71, v46, v47
    s_waitcnt lgkmcnt(1)
    v_exp_f32 v16, v16
    v_exp_f32 v17, v17
    v_exp_f32 v18, v18
    v_mfma_f32_32x32x16_bf16 v[32:47], v[72:75], v[88:91], 0
    v_exp_f32 v19, v19
    v_cvt_pk_bf16_f32 v64, v16, v17
    v_exp_f32 v20, v20
    v_cvt_pk_bf16_f32 v65, v18, v19
    v_exp_f32 v21, v21
    v_exp_f32 v22, v22
    v_mfma_f32_32x32x16_bf16 v[48:63], v[84:87], v[68:71], v[48:63]
    ds_read_b128 v[84:87], v10 offset:6080
    v_exp_f32 v23, v23
    v_cvt_pk_bf16_f32 v66, v20, v21
    v_exp_f32 v24, v24
    v_cvt_pk_bf16_f32 v67, v22, v23
    v_exp_f32 v25, v25
    v_exp_f32 v26, v26
    v_mfma_f32_32x32x8_bf16 v[32:47], v[76:77], v[78:79], v[32:47]
    ds_read_b128 v[72:75], v8 offset:10752
    ds_read_b64 v[76:77], v9 offset:10752
    v_exp_f32 v27, v27
    v_cvt_pk_bf16_f32 v68, v24, v25
    v_exp_f32 v28, v28
    v_cvt_pk_bf16_f32 v69, v26, v27
    v_exp_f32 v29, v29
    s_waitcnt lgkmcnt(3)
    v_mfma_f32_32x32x16_bf16 v[48:63], v[80:83], v[64:67], v[48:63]
    ds_read_b128 v[80:83], v10 offset:8064
    v_exp_f32 v30, v30
    v_exp_f32 v31, v31
    v_cvt_pk_bf16_f32 v70, v28, v29
    v_cvt_pk_bf16_f32 v71, v30, v31
    s_waitcnt lgkmcnt(1)
    v_exp_f32 v32, v32
    v_exp_f32 v33, v33
    v_exp_f32 v34, v34
    v_mfma_f32_32x32x16_bf16 v[16:31], v[72:75], v[88:91], 0
    v_exp_f32 v35, v35
    v_cvt_pk_bf16_f32 v64, v32, v33
    v_exp_f32 v36, v36
    v_cvt_pk_bf16_f32 v65, v34, v35
    v_exp_f32 v37, v37
    v_exp_f32 v38, v38
    v_mfma_f32_32x32x16_bf16 v[48:63], v[84:87], v[68:71], v[48:63]
    ds_read_b128 v[84:87], v10 offset:8768
    v_exp_f32 v39, v39
    v_cvt_pk_bf16_f32 v66, v36, v37
    v_exp_f32 v40, v40
    v_cvt_pk_bf16_f32 v67, v38, v39
    v_exp_f32 v41, v41
    v_exp_f32 v42, v42
    v_mfma_f32_32x32x8_bf16 v[16:31], v[76:77], v[78:79], v[16:31]
    ds_read_b128 v[72:75], v8 offset:13440
    ds_read_b64 v[76:77], v9 offset:13440
    v_exp_f32 v43, v43
    v_cvt_pk_bf16_f32 v68, v40, v41
    v_exp_f32 v44, v44
    v_cvt_pk_bf16_f32 v69, v42, v43
    v_exp_f32 v45, v45
    s_waitcnt lgkmcnt(3)
    v_mfma_f32_32x32x16_bf16 v[48:63], v[80:83], v[64:67], v[48:63]
    ds_read_b128 v[80:83], v10 offset:10752
    v_exp_f32 v46, v46
    v_exp_f32 v47, v47
    v_cvt_pk_bf16_f32 v70, v44, v45
    v_cvt_pk_bf16_f32 v71, v46, v47
    s_waitcnt lgkmcnt(1)
    v_exp_f32 v16, v16
    v_exp_f32 v17, v17
    v_exp_f32 v18, v18
    v_mfma_f32_32x32x16_bf16 v[32:47], v[72:75], v[88:91], 0
    v_exp_f32 v19, v19
    v_cvt_pk_bf16_f32 v64, v16, v17
    v_exp_f32 v20, v20
    v_cvt_pk_bf16_f32 v65, v18, v19
    v_exp_f32 v21, v21
    v_exp_f32 v22, v22
    v_mfma_f32_32x32x16_bf16 v[48:63], v[84:87], v[68:71], v[48:63]
    ds_read_b128 v[84:87], v10 offset:11456
    v_exp_f32 v23, v23
    v_cvt_pk_bf16_f32 v66, v20, v21
    v_exp_f32 v24, v24
    v_cvt_pk_bf16_f32 v67, v22, v23
    v_exp_f32 v25, v25
    v_exp_f32 v26, v26
    v_mfma_f32_32x32x8_bf16 v[32:47], v[76:77], v[78:79], v[32:47]
    ds_read_b128 v[72:75], v8 offset:16128
    ds_read_b64 v[76:77], v9 offset:16128
    v_exp_f32 v27, v27
    v_cvt_pk_bf16_f32 v68, v24, v25
    v_exp_f32 v28, v28
    v_cvt_pk_bf16_f32 v69, v26, v27
    v_exp_f32 v29, v29
    s_waitcnt lgkmcnt(3)
    v_mfma_f32_32x32x16_bf16 v[48:63], v[80:83], v[64:67], v[48:63]
    ds_read_b128 v[80:83], v10 offset:13440
    v_exp_f32 v30, v30
    v_exp_f32 v31, v31
    v_cvt_pk_bf16_f32 v70, v28, v29
    v_cvt_pk_bf16_f32 v71, v30, v31
    s_waitcnt lgkmcnt(1)
    v_exp_f32 v32, v32
    v_exp_f32 v33, v33
    v_exp_f32 v34, v34
    v_mfma_f32_32x32x16_bf16 v[16:31], v[72:75], v[88:91], 0
    v_exp_f32 v35, v35
    v_cvt_pk_bf16_f32 v64, v32, v33
    v_exp_f32 v36, v36
    v_cvt_pk_bf16_f32 v65, v34, v35
    v_exp_f32 v37, v37
    v_exp_f32 v38, v38
    v_mfma_f32_32x32x16_bf16 v[48:63], v[84:87], v[68:71], v[48:63]
    ds_read_b128 v[84:87], v10 offset:14144
    v_exp_f32 v39, v39
    v_cvt_pk_bf16_f32 v66, v36, v37
    v_exp_f32 v40, v40
    v_cvt_pk_bf16_f32 v67, v38, v39
    v_exp_f32 v41, v41
    v_exp_f32 v42, v42
    v_mfma_f32_32x32x8_bf16 v[16:31], v[76:77], v[78:79], v[16:31]
    ds_read_b128 v[72:75], v8 offset:18816
    ds_read_b64 v[76:77], v9 offset:18816
    v_exp_f32 v43, v43
    v_cvt_pk_bf16_f32 v68, v40, v41
    v_exp_f32 v44, v44
    v_cvt_pk_bf16_f32 v69, v42, v43
    v_exp_f32 v45, v45
    s_waitcnt lgkmcnt(3)
    v_mfma_f32_32x32x16_bf16 v[48:63], v[80:83], v[64:67], v[48:63]
    ds_read_b128 v[80:83], v10 offset:16128
    v_exp_f32 v46, v46
    v_exp_f32 v47, v47
    v_cvt_pk_bf16_f32 v70, v44, v45
    v_cvt_pk_bf16_f32 v71, v46, v47
    s_waitcnt vmcnt(0)
    s_barrier
    s_add_u32 s21, s21, 21504
    s_add_u32 s24, s24, 21504
    s_add_u32 s29, s27, 64512
    s_cmp_eq_u32 s24, s29
    s_cselect_b32 s24, s27, s24
    s_sub_u32 s36, s24, s27
    s_add_u32 s36, s36, s34
    s_sub_u32 s37, s21, 0
    s_add_u32 s38, s37, 4096
    s_cmp_ge_u32 s19, 6
    s_cselect_b32 s31, 0, s35
    s_waitcnt lgkmcnt(1)
    v_exp_f32 v16, v16
    v_exp_f32 v17, v17
    v_exp_f32 v18, v18
    v_mfma_f32_32x32x16_bf16 v[32:47], v[72:75], v[88:91], 0
    v_exp_f32 v19, v19
    v_cvt_pk_bf16_f32 v64, v16, v17
    v_exp_f32 v20, v20
    v_cvt_pk_bf16_f32 v65, v18, v19
    v_exp_f32 v21, v21
    v_exp_f32 v22, v22
    v_mfma_f32_32x32x16_bf16 v[48:63], v[84:87], v[68:71], v[48:63]
    ds_read_b128 v[84:87], v10 offset:16832
    v_exp_f32 v23, v23
    v_cvt_pk_bf16_f32 v66, v20, v21
    v_exp_f32 v24, v24
    v_cvt_pk_bf16_f32 v67, v22, v23
    v_exp_f32 v25, v25
    v_exp_f32 v26, v26
    v_mfma_f32_32x32x8_bf16 v[32:47], v[76:77], v[78:79], v[32:47]
    ds_read_b128 v[72:75], v11 offset:0
    ds_read_b64 v[76:77], v12 offset:0
    v_exp_f32 v27, v27
    v_cvt_pk_bf16_f32 v68, v24, v25
    v_exp_f32 v28, v28
    v_cvt_pk_bf16_f32 v69, v26, v27
    v_exp_f32 v29, v29
    s_waitcnt lgkmcnt(3)
    v_mfma_f32_32x32x16_bf16 v[48:63], v[80:83], v[64:67], v[48:63]
    ds_read_b128 v[80:83], v10 offset:18816
    s_cmp_le_u32 s31, 0
    s_cbranch_scc1 k2_kernel_at_d6_0
    s_add_u32 m0, s36, 0
    s_nop 0
    buffer_load_dwordx4 v7, s[4:7], s37 offen offset:0 lds
k2_kernel_at_d6_0:
    s_cmp_le_u32 s31, 1
    s_cbranch_scc1 k2_kernel_at_d6_1
    s_add_u32 m0, s36, 0
    s_nop 0
    buffer_load_dwordx4 v7, s[4:7], s37 offen offset:1024 lds
k2_kernel_at_d6_1:
    v_exp_f32 v30, v30
    v_exp_f32 v31, v31
    v_cvt_pk_bf16_f32 v70, v28, v29
    v_cvt_pk_bf16_f32 v71, v30, v31
    s_waitcnt lgkmcnt(1)
    v_exp_f32 v32, v32
    v_exp_f32 v33, v33
    v_exp_f32 v34, v34
    v_mfma_f32_32x32x16_bf16 v[16:31], v[72:75], v[88:91], 0
    v_exp_f32 v35, v35
    v_cvt_pk_bf16_f32 v64, v32, v33
    v_exp_f32 v36, v36
    v_cvt_pk_bf16_f32 v65, v34, v35
    v_exp_f32 v37, v37
    v_exp_f32 v38, v38
    v_mfma_f32_32x32x16_bf16 v[48:63], v[84:87], v[68:71], v[48:63]
    ds_read_b128 v[84:87], v10 offset:19520
    v_exp_f32 v39, v39
    v_cvt_pk_bf16_f32 v66, v36, v37
    v_exp_f32 v40, v40
    v_cvt_pk_bf16_f32 v67, v38, v39
    v_exp_f32 v41, v41
    v_exp_f32 v42, v42
    v_mfma_f32_32x32x8_bf16 v[16:31], v[76:77], v[78:79], v[16:31]
    ds_read_b128 v[72:75], v11 offset:2688
    ds_read_b64 v[76:77], v12 offset:2688
    v_exp_f32 v43, v43
    v_cvt_pk_bf16_f32 v68, v40, v41
    v_exp_f32 v44, v44
    v_cvt_pk_bf16_f32 v69, v42, v43
    v_exp_f32 v45, v45
    s_waitcnt lgkmcnt(3)
    v_mfma_f32_32x32x16_bf16 v[48:63], v[80:83], v[64:67], v[48:63]
    ds_read_b128 v[80:83], v13 offset:0
    s_cmp_le_u32 s31, 2
    s_cbranch_scc1 k2_kernel_at_d7_2
    s_add_u32 m0, s36, 0
    s_nop 0
    buffer_load_dwordx4 v7, s[4:7], s37 offen offset:2048 lds
k2_kernel_at_d7_2:
    s_cmp_le_u32 s31, 3
    s_cbranch_scc1 k2_kernel_at_d7_3
    s_add_u32 m0, s36, 0
    s_nop 0
    buffer_load_dwordx4 v7, s[4:7], s37 offen offset:3072 lds
k2_kernel_at_d7_3:
    v_exp_f32 v46, v46
    v_exp_f32 v47, v47
    v_cvt_pk_bf16_f32 v70, v44, v45
    v_cvt_pk_bf16_f32 v71, v46, v47
    v_mov_b32 v8, v11
    v_mov_b32 v9, v12
    v_mov_b32 v10, v13
    s_add_u32 s28, s28, 1
    s_cmp_eq_u32 s28, 3
    s_cselect_b32 s28, 0, s28
    s_cmp_eq_u32 s28, 0
    s_mov_b32 s30, 21504
    s_cselect_b32 s30, 0xffff5800, s30
    v_add_u32 v11, s30, v11
    v_add_u32 v12, s30, v12
    v_add_u32 v13, s30, v13
    s_add_u32 s19, s19, 1
    s_cmp_lt_u32 s19, 8
    s_cbranch_scc1 k2_kernel_at_loop
    s_waitcnt lgkmcnt(0)
    s_nop 1
    v_mfma_f32_32x32x16_bf16 v[48:63], v[84:87], v[68:71], v[48:63]
    s_mov_b32 s43, 0
k2_kernel_at_fin:
    s_nop 11
    v_mov_b32 v1, v56
    v_mov_b32 v2, v56
    s_nop 1
    v_permlane32_swap_b32 v1, v2
    s_nop 1
    s_cmp_lg_u32 s43, 0
    s_cbranch_scc1 k2_kernel_at_store
    v_mov_b32 v3, 0
    v_fma_f32 v3, v48, 0, v3
    v_fma_f32 v3, v49, 0, v3
    v_fma_f32 v3, v50, 0, v3
    v_fma_f32 v3, v51, 0, v3
    v_fma_f32 v3, v52, 0, v3
    v_fma_f32 v3, v53, 0, v3
    v_fma_f32 v3, v54, 0, v3
    v_fma_f32 v3, v55, 0, v3
    v_fma_f32 v3, v56, 0, v3
    v_fma_f32 v3, v57, 0, v3
    v_fma_f32 v3, v58, 0, v3
    v_fma_f32 v3, v59, 0, v3
    s_mov_b32 s16, 0x1f800000
    s_mov_b32 s17, 0x5f800000
    v_cmp_le_f32 vcc, s16, v2
    v_cmp_ge_f32 s[44:45], s17, v2
    v_cmp_o_f32 s[46:47], v3, v3
    s_nop 3
    s_and_b64 s[44:45], s[44:45], vcc
    s_and_b64 s[44:45], s[44:45], s[46:47]
    s_cmp_eq_u64 s[44:45], exec
    s_cbranch_scc0 k2_kernel_at_slow
k2_kernel_at_store:
    v_rcp_f32 v2, v2
    s_nop 0
    v_mul_f32 v48, v48, v2
    v_mul_f32 v49, v49, v2
    v_mul_f32 v50, v50, v2
    v_mul_f32 v51, v51, v2
    v_mul_f32 v52, v52, v2
    v_mul_f32 v53, v53, v2
    v_mul_f32 v54, v54, v2
    v_mul_f32 v55, v55, v2
    v_mul_f32 v56, v56, v2
    v_mul_f32 v57, v57, v2
    v_mul_f32 v58, v58, v2
    v_mul_f32 v59, v59, v2
    v_cvt_pk_bf16_f32 v48, v48, v49
    v_cvt_pk_bf16_f32 v49, v50, v51
    v_cvt_pk_bf16_f32 v50, v52, v53
    v_cvt_pk_bf16_f32 v51, v54, v55
    v_cvt_pk_bf16_f32 v52, v56, v57
    v_cvt_pk_bf16_f32 v53, v58, v59
    v_cmp_gt_u32 vcc, 32, v0
    v_mov_b32 v54, 0
    v_mov_b32 v55, 0
    v_cndmask_b32 v52, 0, v52, vcc
    v_cndmask_b32 v53, 0, v53, vcc
    v_permlane32_swap_b32 v48, v50
    v_permlane32_swap_b32 v49, v51
    s_add_u32 s12, s32, 0x2a00000
    s_addc_u32 s13, s33, 0
    s_mov_b32 s14, 0x300000
    s_mov_b32 s15, 0x00020000
    v_and_b32 v1, 31, v0
    v_lshrrev_b32 v2, 5, v0
    v_mul_u32_u24 v1, 48, v1
    v_mul_u32_u24 v3, 1552, v2
    v_add_u32 v3, v3, v1
    v_add_u32 v3, 32, v3
    v_lshl_add_u32 v1, v2, 4, v1
    s_lshl_b32 s16, s41, 8
    s_lshl_b32 s17, s26, 5
    s_add_u32 s16, s16, s17
    s_mul_i32 s16, s16, 48
    s_mul_i32 s17, s40, 98304
    s_add_u32 s16, s16, s17
    s_mul_i32 s17, s26, 2048
    s_add_u32 s17, s17, 64512
    v_add_u32 v2, s17, v1
    v_min_u32 v3, 2032, v3
    v_add_u32 v3, s17, v3
    ds_write_b128 v2, v[48:51]
    ds_write_b128 v3, v[52:55]
    v_lshlrev_b32 v1, 4, v0
    v_add_u32 v2, s17, v1
    v_add_u32 v3, 1024, v1
    v_mov_b32 v4, 0x7ff00000
    v_cmp_gt_u32 vcc, 32, v0
    s_waitcnt lgkmcnt(0)
    ds_read_b128 v[48:51], v2
    ds_read_b128 v[52:55], v2 offset:1024
    v_cndmask_b32 v3, v4, v3, vcc
    s_waitcnt lgkmcnt(0)
    buffer_store_dwordx4 v[48:51], v1, s[12:15], s16 offen sc1
    buffer_store_dwordx4 v[52:55], v3, s[12:15], s16 offen sc1
    s_mov_b64 exec, -1
    s_waitcnt vmcnt(0)
    s_barrier
    s_cmp_lg_u32 s26, 0
    s_cbranch_scc1 k2_kernel_at_nopub
    s_add_u32 s30, s41, 32
    s_lshl_b32 s30, s30, 8
    s_add_u32 s30, s30, 0x1a70000
    v_mov_b32 v1, s30
    v_mov_b32 v2, 1
    s_mov_b32 exec_lo, 1
    s_mov_b32 exec_hi, 0
    global_atomic_add v1, v2, s[32:33] sc1
    s_mov_b64 exec, -1
k2_kernel_at_nopub:
    s_endpgm
k2_kernel_at_slow:
    v_and_b32 v1, 31, v0
    v_lshrrev_b32 v2, 5, v0
    v_mov_b32 v4, 1280
    v_lshlrev_b32 v8, 4, v0
    v_lshlrev_b32 v9, 3, v1
    v_add_u32 v9, 1024, v9
    v_min_u32 v10, 21, v1
    v_lshlrev_b32 v10, 4, v10
    v_mul_u32_u24 v3, 352, v2
    v_add3_u32 v10, v10, v3, v4
    v_mov_b32 v4, 0xff800000
    s_mov_b32 s21, s42
    s_mov_b32 s19, 64
k2_kernel_at_slow1:
    buffer_load_dwordx4 v[72:75], v8, s[4:7], s21 offen
    buffer_load_dwordx2 v[76:77], v9, s[4:7], s21 offen
    s_waitcnt vmcnt(0)
    v_mfma_f32_32x32x16_bf16 v[16:31], v[72:75], v[88:91], 0
    v_mfma_f32_32x32x8_bf16 v[16:31], v[76:77], v[78:79], v[16:31]
    s_nop 13
    v_max3_f32 v4, v16, v17, v4
    v_max3_f32 v4, v18, v19, v4
    v_max3_f32 v4, v20, v21, v4
    v_max3_f32 v4, v22, v23, v4
    v_max3_f32 v4, v24, v25, v4
    v_max3_f32 v4, v26, v27, v4
    v_max3_f32 v4, v28, v29, v4
    v_max3_f32 v4, v30, v31, v4
    s_add_u32 s21, s21, 2688
    s_sub_u32 s19, s19, 1
    s_cmp_lg_u32 s19, 0
    s_cbranch_scc1 k2_kernel_at_slow1
    v_mov_b32 v3, v4
    s_nop 1
    v_permlane32_swap_b32 v3, v4
    s_nop 1
    v_max_f32 v4, v3, v4
    v_sub_f32 v92, 0, v4
    v_sub_f32 v93, 0, v4
    v_sub_f32 v94, 0, v4
    v_sub_f32 v95, 0, v4
    v_sub_f32 v96, 0, v4
    v_sub_f32 v97, 0, v4
    v_sub_f32 v98, 0, v4
    v_sub_f32 v99, 0, v4
    v_sub_f32 v100, 0, v4
    v_sub_f32 v101, 0, v4
    v_sub_f32 v102, 0, v4
    v_sub_f32 v103, 0, v4
    v_sub_f32 v104, 0, v4
    v_sub_f32 v105, 0, v4
    v_sub_f32 v106, 0, v4
    v_sub_f32 v107, 0, v4
    v_mov_b32 v48, 0
    v_mov_b32 v49, 0
    v_mov_b32 v50, 0
    v_mov_b32 v51, 0
    v_mov_b32 v52, 0
    v_mov_b32 v53, 0
    v_mov_b32 v54, 0
    v_mov_b32 v55, 0
    v_mov_b32 v56, 0
    v_mov_b32 v57, 0
    v_mov_b32 v58, 0
    v_mov_b32 v59, 0
    v_mov_b32 v60, 0
    v_mov_b32 v61, 0
    v_mov_b32 v62, 0
    v_mov_b32 v63, 0
    s_mov_b32 s21, s42
    s_mov_b32 s19, 64
k2_kernel_at_slow2:
    buffer_load_dwordx4 v[72:75], v8, s[4:7], s21 offen
    buffer_load_dwordx2 v[76:77], v9, s[4:7], s21 offen
    buffer_load_dwordx4 v[80:83], v10, s[4:7], s21 offen
    buffer_load_dwordx4 v[84:87], v10, s[4:7], s21 offen offset:704
    s_waitcnt vmcnt(0)
    v_mfma_f32_32x32x16_bf16 v[16:31], v[72:75], v[88:91], v[92:107]
    s_nop 11
    v_mfma_f32_32x32x8_bf16 v[16:31], v[76:77], v[78:79], v[16:31]
    s_nop 13
    v_exp_f32 v16, v16
    v_exp_f32 v17, v17
    v_exp_f32 v18, v18
    v_exp_f32 v19, v19
    v_exp_f32 v20, v20
    v_exp_f32 v21, v21
    v_exp_f32 v22, v22
    v_exp_f32 v23, v23
    v_exp_f32 v24, v24
    v_exp_f32 v25, v25
    v_exp_f32 v26, v26
    v_exp_f32 v27, v27
    v_exp_f32 v28, v28
    v_exp_f32 v29, v29
    v_exp_f32 v30, v30
    v_exp_f32 v31, v31
    s_nop 0
    v_cvt_pk_bf16_f32 v64, v16, v17
    v_cvt_pk_bf16_f32 v65, v18, v19
    v_cvt_pk_bf16_f32 v66, v20, v21
    v_cvt_pk_bf16_f32 v67, v22, v23
    v_cvt_pk_bf16_f32 v68, v24, v25
    v_cvt_pk_bf16_f32 v69, v26, v27
    v_cvt_pk_bf16_f32 v70, v28, v29
    v_cvt_pk_bf16_f32 v71, v30, v31
    s_nop 1
    v_mfma_f32_32x32x16_bf16 v[48:63], v[80:83], v[64:67], v[48:63]
    v_mfma_f32_32x32x16_bf16 v[48:63], v[84:87], v[68:71], v[48:63]
    s_add_u32 s21, s21, 2688
    s_sub_u32 s19, s19, 1
    s_cmp_lg_u32 s19, 0
    s_cbranch_scc1 k2_kernel_at_slow2
    s_mov_b32 s43, 1
    s_branch k2_kernel_at_fin
k2_kernel_bchain:
    s_sub_u32 s2, s2, 256
    v_readfirstlane_b32 s26, v0
    v_and_b32 v0, 63, v0
    s_nop 2
    s_lshr_b32 s26, s26, 6
    s_lshr_b32 s28, s26, 1
    s_and_b32 s28, s28, 1
    s_and_b32 s29, s26, 1
    s_cmp_ge_u32 s26, 4
    s_cbranch_scc1 k2_kernel_bl
    s_setprio 2
    v_and_b32 v4, 15, v0
    v_lshrrev_b32 v5, 4, v0
    v_lshrrev_b32 v6, 1, v4
    v_xor_b32 v6, v6, v5
    s_lshl_b32 s30, s26, 4
    v_add_u32 v4, s30, v4
    v_lshlrev_b32 v4, 7, v4
    v_lshl_add_u32 v1, v6, 4, v4
    v_xor_b32 v2, 64, v1
    v_lshlrev_b32 v3, 4, v0
    v_add_u32 v3, 32768, v3
    s_and_b32 s3, s2, 7
    s_lshr_b32 s16, s2, 3
    s_and_b32 s52, s16, 3
    s_lshr_b32 s53, s16, 2
    s_lshl_b32 s17, s3, 2
    s_add_u32 s40, s17, s52
    s_mov_b32 s41, s53
    s_and_b32 s34, s16, 1
    s_lshr_b32 s55, s16, 1
    s_lshl_b32 s17, s3, 1
    s_add_u32 s54, s17, s34
    s_lshl_b32 s42, s40, 6
    s_mov_b32 s43, 1280
    s_mul_i32 s44, s41, 160
    s_mov_b32 s23, 81920
    s_mov_b32 s27, 0
    s_mov_b32 s16, 0
    v_and_b32 v4, 15, v0
    v_lshrrev_b32 v5, 4, v0
    s_lshl_b32 s30, s26, 4
    s_add_u32 s30, s30, s42
    v_add_u32 v121, s30, v4
    v_mul_u32_u24 v120, 0x500, v121
    v_lshl_add_u32 v120, v5, 3, v120
    v_add_u32 v120, s44, v120
    s_waitcnt lgkmcnt(0)
    s_cmp_lt_u32 s26, 2
    s_cbranch_scc1 k2_kernel_nocs
    s_add_u32 s12, s32, 0x1a80000
    s_addc_u32 s13, s33, 0
    s_mov_b32 s14, 0x1e000
    s_mov_b32 s15, 0x00020000
    s_sub_u32 s30, s26, 2
    s_lshl_b32 s30, s30, 6
    v_add_u32 v5, s30, v0
    v_min_u32 v5, 96, v5
    s_mul_i32 s30, s55, 96
    v_add_u32 v4, s30, v5
    v_lshlrev_b32 v4, 2, v4
    s_mov_b32 s30, 0
    buffer_load_dword v8, v4, s[12:15], s30 offen
    s_mov_b32 s30, 6144
    buffer_load_dword v9, v4, s[12:15], s30 offen
    s_mov_b32 s30, 12288
    buffer_load_dword v10, v4, s[12:15], s30 offen
    s_mov_b32 s30, 18432
    buffer_load_dword v11, v4, s[12:15], s30 offen
    s_mov_b32 s30, 24576
    buffer_load_dword v12, v4, s[12:15], s30 offen
    s_mov_b32 s30, 30720
    buffer_load_dword v13, v4, s[12:15], s30 offen
    s_mov_b32 s30, 36864
    buffer_load_dword v14, v4, s[12:15], s30 offen
    s_mov_b32 s30, 43008
    buffer_load_dword v15, v4, s[12:15], s30 offen
    s_mov_b32 s30, 49152
    buffer_load_dword v16, v4, s[12:15], s30 offen
    s_mov_b32 s30, 55296
    buffer_load_dword v17, v4, s[12:15], s30 offen
    s_mov_b32 s30, 61440
    buffer_load_dword v18, v4, s[12:15], s30 offen
    s_mov_b32 s30, 67584
    buffer_load_dword v19, v4, s[12:15], s30 offen
    s_mov_b32 s30, 73728
    buffer_load_dword v20, v4, s[12:15], s30 offen
    s_mov_b32 s30, 79872
    buffer_load_dword v21, v4, s[12:15], s30 offen
    s_mov_b32 s30, 86016
    buffer_load_dword v22, v4, s[12:15], s30 offen
    s_mov_b32 s30, 92160
    buffer_load_dword v23, v4, s[12:15], s30 offen
    s_mov_b32 s30, 98304
    buffer_load_dword v24, v4, s[12:15], s30 offen
    s_mov_b32 s30, 104448
    buffer_load_dword v25, v4, s[12:15], s30 offen
    s_mov_b32 s30, 110592
    buffer_load_dword v26, v4, s[12:15], s30 offen
    s_mov_b32 s30, 116736
    buffer_load_dword v27, v4, s[12:15], s30 offen
    s_waitcnt vmcnt(0)
    v_add_f32 v8, v8, v9
    v_add_f32 v8, v8, v10
    v_add_f32 v8, v8, v11
    v_add_f32 v8, v8, v12
    v_add_f32 v8, v8, v13
    v_add_f32 v8, v8, v14
    v_add_f32 v8, v8, v15
    v_add_f32 v8, v8, v16
    v_add_f32 v8, v8, v17
    v_add_f32 v8, v8, v18
    v_add_f32 v8, v8, v19
    v_add_f32 v8, v8, v20
    v_add_f32 v8, v8, v21
    v_add_f32 v8, v8, v22
    v_add_f32 v8, v8, v23
    v_add_f32 v8, v8, v24
    v_add_f32 v8, v8, v25
    v_add_f32 v8, v8, v26
    v_add_f32 v8, v8, v27
    v_lshlrev_b32 v5, 2, v5
    v_add_u32 v5, 74752, v5
    ds_write_b32 v5, v8
    s_waitcnt lgkmcnt(0)
k2_kernel_nocs:
    s_mov_b32 s12, s64
    s_mov_b32 s13, s65
    s_mov_b32 s14, 0x280000
    s_mov_b32 s15, 0x00020000
    buffer_load_dwordx2 v[100:101], v120, s[12:15], 0 offen offset:0
    buffer_load_dwordx2 v[102:103], v120, s[12:15], 0 offen offset:32
    buffer_load_dwordx2 v[104:105], v120, s[12:15], 0 offen offset:64
    buffer_load_dwordx2 v[106:107], v120, s[12:15], 0 offen offset:96
    buffer_load_dwordx2 v[108:109], v120, s[12:15], 0 offen offset:128
    s_add_u32 s12, s32, 0x1a60000
    s_addc_u32 s13, s33, 0
    s_mov_b32 s14, 0x4000
    s_mov_b32 s15, 0x00020000
    v_lshlrev_b32 v4, 3, v121
    buffer_load_dwordx2 v[122:123], v4, s[12:15], 0 offen
    s_barrier
    ds_read_b128 v[8:11], v1 offset:0
    ds_read_b128 v[12:15], v3 offset:0
    ds_read_b128 v[16:19], v3 offset:1024
    ds_read_b128 v[20:23], v3 offset:2048
    ds_read_b128 v[24:27], v3 offset:3072
    ds_read_b128 v[28:31], v3 offset:4096
    s_waitcnt lgkmcnt(0)
    v_mfma_f32_16x16x32_bf16 v[64:67], v[12:15], v[8:11], 0
    ds_read_b128 v[32:35], v2 offset:0
    v_mfma_f32_16x16x32_bf16 v[68:71], v[16:19], v[8:11], 0
    ds_read_b128 v[36:39], v3 offset:5120
    v_mfma_f32_16x16x32_bf16 v[72:75], v[20:23], v[8:11], 0
    ds_read_b128 v[40:43], v3 offset:6144
    v_mfma_f32_16x16x32_bf16 v[76:79], v[24:27], v[8:11], 0
    ds_read_b128 v[44:47], v3 offset:7168
    v_mfma_f32_16x16x32_bf16 v[80:83], v[28:31], v[8:11], 0
    ds_read_b128 v[48:51], v3 offset:8192
    ds_read_b128 v[52:55], v3 offset:9216
    s_waitcnt lgkmcnt(0)
    s_barrier
    v_mfma_f32_16x16x32_bf16 v[64:67], v[36:39], v[32:35], v[64:67]
    ds_read_b128 v[8:11], v1 offset:8192
    v_mfma_f32_16x16x32_bf16 v[68:71], v[40:43], v[32:35], v[68:71]
    ds_read_b128 v[12:15], v3 offset:10240
    v_mfma_f32_16x16x32_bf16 v[72:75], v[44:47], v[32:35], v[72:75]
    ds_read_b128 v[16:19], v3 offset:11264
    v_mfma_f32_16x16x32_bf16 v[76:79], v[48:51], v[32:35], v[76:79]
    ds_read_b128 v[20:23], v3 offset:12288
    v_mfma_f32_16x16x32_bf16 v[80:83], v[52:55], v[32:35], v[80:83]
    ds_read_b128 v[24:27], v3 offset:13312
    ds_read_b128 v[28:31], v3 offset:14336
    s_waitcnt lgkmcnt(0)
    v_mfma_f32_16x16x32_bf16 v[64:67], v[12:15], v[8:11], v[64:67]
    ds_read_b128 v[32:35], v2 offset:8192
    v_mfma_f32_16x16x32_bf16 v[68:71], v[16:19], v[8:11], v[68:71]
    ds_read_b128 v[36:39], v3 offset:15360
    v_mfma_f32_16x16x32_bf16 v[72:75], v[20:23], v[8:11], v[72:75]
    ds_read_b128 v[40:43], v3 offset:16384
    v_mfma_f32_16x16x32_bf16 v[76:79], v[24:27], v[8:11], v[76:79]
    ds_read_b128 v[44:47], v3 offset:17408
    v_mfma_f32_16x16x32_bf16 v[80:83], v[28:31], v[8:11], v[80:83]
    ds_read_b128 v[48:51], v3 offset:18432
    ds_read_b128 v[52:55], v3 offset:19456
    s_waitcnt lgkmcnt(0)
    s_barrier
    v_mfma_f32_16x16x32_bf16 v[64:67], v[36:39], v[32:35], v[64:67]
    ds_read_b128 v[8:11], v1 offset:16384
    v_mfma_f32_16x16x32_bf16 v[68:71], v[40:43], v[32:35], v[68:71]
    ds_read_b128 v[12:15], v3 offset:20480
    v_mfma_f32_16x16x32_bf16 v[72:75], v[44:47], v[32:35], v[72:75]
    ds_read_b128 v[16:19], v3 offset:21504
    v_mfma_f32_16x16x32_bf16 v[76:79], v[48:51], v[32:35], v[76:79]
    ds_read_b128 v[20:23], v3 offset:22528
    v_mfma_f32_16x16x32_bf16 v[80:83], v[52:55], v[32:35], v[80:83]
    ds_read_b128 v[24:27], v3 offset:23552
    ds_read_b128 v[28:31], v3 offset:24576
    s_waitcnt lgkmcnt(0)
    v_mfma_f32_16x16x32_bf16 v[64:67], v[12:15], v[8:11], v[64:67]
    ds_read_b128 v[32:35], v2 offset:16384
    v_mfma_f32_16x16x32_bf16 v[68:71], v[16:19], v[8:11], v[68:71]
    ds_read_b128 v[36:39], v3 offset:25600
    v_mfma_f32_16x16x32_bf16 v[72:75], v[20:23], v[8:11], v[72:75]
    ds_read_b128 v[40:43], v3 offset:26624
    v_mfma_f32_16x16x32_bf16 v[76:79], v[24:27], v[8:11], v[76:79]
    ds_read_b128 v[44:47], v3 offset:27648
    v_mfma_f32_16x16x32_bf16 v[80:83], v[28:31], v[8:11], v[80:83]
    ds_read_b128 v[48:51], v3 offset:28672
    ds_read_b128 v[52:55], v3 offset:29696
    s_waitcnt lgkmcnt(0)
    s_barrier
    v_mfma_f32_16x16x32_bf16 v[64:67], v[36:39], v[32:35], v[64:67]
    ds_read_b128 v[8:11], v1 offset:24576
    v_mfma_f32_16x16x32_bf16 v[68:71], v[40:43], v[32:35], v[68:71]
    ds_read_b128 v[12:15], v3 offset:30720
    v_mfma_f32_16x16x32_bf16 v[72:75], v[44:47], v[32:35], v[72:75]
    ds_read_b128 v[16:19], v3 offset:31744
    v_mfma_f32_16x16x32_bf16 v[76:79], v[48:51], v[32:35], v[76:79]
    ds_read_b128 v[20:23], v3 offset:32768
    v_mfma_f32_16x16x32_bf16 v[80:83], v[52:55], v[32:35], v[80:83]
    ds_read_b128 v[24:27], v3 offset:33792
    ds_read_b128 v[28:31], v3 offset:34816
    s_waitcnt lgkmcnt(0)
    v_mfma_f32_16x16x32_bf16 v[64:67], v[12:15], v[8:11], v[64:67]
    ds_read_b128 v[32:35], v2 offset:24576
    v_mfma_f32_16x16x32_bf16 v[68:71], v[16:19], v[8:11], v[68:71]
    ds_read_b128 v[36:39], v3 offset:35840
    v_mfma_f32_16x16x32_bf16 v[72:75], v[20:23], v[8:11], v[72:75]
    ds_read_b128 v[40:43], v3 offset:36864
    v_mfma_f32_16x16x32_bf16 v[76:79], v[24:27], v[8:11], v[76:79]
    ds_read_b128 v[44:47], v3 offset:37888
    v_mfma_f32_16x16x32_bf16 v[80:83], v[28:31], v[8:11], v[80:83]
    ds_read_b128 v[48:51], v3 offset:38912
    ds_read_b128 v[52:55], v3 offset:39936
    s_waitcnt lgkmcnt(0)
    s_barrier
    v_mfma_f32_16x16x32_bf16 v[64:67], v[36:39], v[32:35], v[64:67]
    ds_read_b128 v[8:11], v1 offset:0
    v_mfma_f32_16x16x32_bf16 v[68:71], v[40:43], v[32:35], v[68:71]
    ds_read_b128 v[12:15], v3 offset:0
    v_mfma_f32_16x16x32_bf16 v[72:75], v[44:47], v[32:35], v[72:75]
    ds_read_b128 v[16:19], v3 offset:1024
    v_mfma_f32_16x16x32_bf16 v[76:79], v[48:51], v[32:35], v[76:79]
    ds_read_b128 v[20:23], v3 offset:2048
    v_mfma_f32_16x16x32_bf16 v[80:83], v[52:55], v[32:35], v[80:83]
    ds_read_b128 v[24:27], v3 offset:3072
    ds_read_b128 v[28:31], v3 offset:4096
    s_waitcnt lgkmcnt(0)
    v_mfma_f32_16x16x32_bf16 v[64:67], v[12:15], v[8:11], v[64:67]
    ds_read_b128 v[32:35], v2 offset:0
    v_mfma_f32_16x16x32_bf16 v[68:71], v[16:19], v[8:11], v[68:71]
    ds_read_b128 v[36:39], v3 offset:5120
    v_mfma_f32_16x16x32_bf16 v[72:75], v[20:23], v[8:11], v[72:75]
    ds_read_b128 v[40:43], v3 offset:6144
    v_mfma_f32_16x16x32_bf16 v[76:79], v[24:27], v[8:11], v[76:79]
    ds_read_b128 v[44:47], v3 offset:7168
    v_mfma_f32_16x16x32_bf16 v[80:83], v[28:31], v[8:11], v[80:83]
    ds_read_b128 v[48:51], v3 offset:8192
    ds_read_b128 v[52:55], v3 offset:9216
    s_waitcnt lgkmcnt(0)
    s_barrier
    v_mfma_f32_16x16x32_bf16 v[64:67], v[36:39], v[32:35], v[64:67]
    ds_read_b128 v[8:11], v1 offset:8192
    v_mfma_f32_16x16x32_bf16 v[68:71], v[40:43], v[32:35], v[68:71]
    ds_read_b128 v[12:15], v3 offset:10240
    v_mfma_f32_16x16x32_bf16 v[72:75], v[44:47], v[32:35], v[72:75]
    ds_read_b128 v[16:19], v3 offset:11264
    v_mfma_f32_16x16x32_bf16 v[76:79], v[48:51], v[32:35], v[76:79]
    ds_read_b128 v[20:23], v3 offset:12288
    v_mfma_f32_16x16x32_bf16 v[80:83], v[52:55], v[32:35], v[80:83]
    ds_read_b128 v[24:27], v3 offset:13312
    ds_read_b128 v[28:31], v3 offset:14336
    s_waitcnt lgkmcnt(0)
    v_mfma_f32_16x16x32_bf16 v[64:67], v[12:15], v[8:11], v[64:67]
    ds_read_b128 v[32:35], v2 offset:8192
    v_mfma_f32_16x16x32_bf16 v[68:71], v[16:19], v[8:11], v[68:71]
    ds_read_b128 v[36:39], v3 offset:15360
    v_mfma_f32_16x16x32_bf16 v[72:75], v[20:23], v[8:11], v[72:75]
    ds_read_b128 v[40:43], v3 offset:16384
    v_mfma_f32_16x16x32_bf16 v[76:79], v[24:27], v[8:11], v[76:79]
    ds_read_b128 v[44:47], v3 offset:17408
    v_mfma_f32_16x16x32_bf16 v[80:83], v[28:31], v[8:11], v[80:83]
    ds_read_b128 v[48:51], v3 offset:18432
    ds_read_b128 v[52:55], v3 offset:19456
    s_waitcnt lgkmcnt(0)
    s_barrier
    v_mfma_f32_16x16x32_bf16 v[64:67], v[36:39], v[32:35], v[64:67]
    ds_read_b128 v[8:11], v1 offset:16384
    v_mfma_f32_16x16x32_bf16 v[68:71], v[40:43], v[32:35], v[68:71]
    ds_read_b128 v[12:15], v3 offset:20480
    v_mfma_f32_16x16x32_bf16 v[72:75], v[44:47], v[32:35], v[72:75]
    ds_read_b128 v[16:19], v3 offset:21504
    v_mfma_f32_16x16x32_bf16 v[76:79], v[48:51], v[32:35], v[76:79]
    ds_read_b128 v[20:23], v3 offset:22528
    v_mfma_f32_16x16x32_bf16 v[80:83], v[52:55], v[32:35], v[80:83]
    ds_read_b128 v[24:27], v3 offset:23552
    ds_read_b128 v[28:31], v3 offset:24576
    s_waitcnt lgkmcnt(0)
    v_mfma_f32_16x16x32_bf16 v[64:67], v[12:15], v[8:11], v[64:67]
    ds_read_b128 v[32:35], v2 offset:16384
    v_mfma_f32_16x16x32_bf16 v[68:71], v[16:19], v[8:11], v[68:71]
    ds_read_b128 v[36:39], v3 offset:25600
    v_mfma_f32_16x16x32_bf16 v[72:75], v[20:23], v[8:11], v[72:75]
    ds_read_b128 v[40:43], v3 offset:26624
    v_mfma_f32_16x16x32_bf16 v[76:79], v[24:27], v[8:11], v[76:79]
    ds_read_b128 v[44:47], v3 offset:27648
    v_mfma_f32_16x16x32_bf16 v[80:83], v[28:31], v[8:11], v[80:83]
    ds_read_b128 v[48:51], v3 offset:28672
    ds_read_b128 v[52:55], v3 offset:29696
    s_waitcnt lgkmcnt(0)
    s_barrier
    v_mfma_f32_16x16x32_bf16 v[64:67], v[36:39], v[32:35], v[64:67]
    ds_read_b128 v[8:11], v1 offset:24576
    v_mfma_f32_16x16x32_bf16 v[68:71], v[40:43], v[32:35], v[68:71]
    ds_read_b128 v[12:15], v3 offset:30720
    v_mfma_f32_16x16x32_bf16 v[72:75], v[44:47], v[32:35], v[72:75]
    ds_read_b128 v[16:19], v3 offset:31744
    v_mfma_f32_16x16x32_bf16 v[76:79], v[48:51], v[32:35], v[76:79]
    ds_read_b128 v[20:23], v3 offset:32768
    v_mfma_f32_16x16x32_bf16 v[80:83], v[52:55], v[32:35], v[80:83]
    ds_read_b128 v[24:27], v3 offset:33792
    ds_read_b128 v[28:31], v3 offset:34816
    s_waitcnt lgkmcnt(0)
    v_mfma_f32_16x16x32_bf16 v[64:67], v[12:15], v[8:11], v[64:67]
    ds_read_b128 v[32:35], v2 offset:24576
    v_mfma_f32_16x16x32_bf16 v[68:71], v[16:19], v[8:11], v[68:71]
    ds_read_b128 v[36:39], v3 offset:35840
    v_mfma_f32_16x16x32_bf16 v[72:75], v[20:23], v[8:11], v[72:75]
    ds_read_b128 v[40:43], v3 offset:36864
    v_mfma_f32_16x16x32_bf16 v[76:79], v[24:27], v[8:11], v[76:79]
    ds_read_b128 v[44:47], v3 offset:37888
    v_mfma_f32_16x16x32_bf16 v[80:83], v[28:31], v[8:11], v[80:83]
    ds_read_b128 v[48:51], v3 offset:38912
    ds_read_b128 v[52:55], v3 offset:39936
    s_waitcnt lgkmcnt(0)
    s_barrier
    v_mfma_f32_16x16x32_bf16 v[64:67], v[36:39], v[32:35], v[64:67]
    ds_read_b128 v[8:11], v1 offset:0
    v_mfma_f32_16x16x32_bf16 v[68:71], v[40:43], v[32:35], v[68:71]
    ds_read_b128 v[12:15], v3 offset:0
    v_mfma_f32_16x16x32_bf16 v[72:75], v[44:47], v[32:35], v[72:75]
    ds_read_b128 v[16:19], v3 offset:1024
    v_mfma_f32_16x16x32_bf16 v[76:79], v[48:51], v[32:35], v[76:79]
    ds_read_b128 v[20:23], v3 offset:2048
    v_mfma_f32_16x16x32_bf16 v[80:83], v[52:55], v[32:35], v[80:83]
    ds_read_b128 v[24:27], v3 offset:3072
    ds_read_b128 v[28:31], v3 offset:4096
    s_waitcnt lgkmcnt(0)
    v_mfma_f32_16x16x32_bf16 v[64:67], v[12:15], v[8:11], v[64:67]
    ds_read_b128 v[32:35], v2 offset:0
    v_mfma_f32_16x16x32_bf16 v[68:71], v[16:19], v[8:11], v[68:71]
    ds_read_b128 v[36:39], v3 offset:5120
    v_mfma_f32_16x16x32_bf16 v[72:75], v[20:23], v[8:11], v[72:75]
    ds_read_b128 v[40:43], v3 offset:6144
    v_mfma_f32_16x16x32_bf16 v[76:79], v[24:27], v[8:11], v[76:79]
    ds_read_b128 v[44:47], v3 offset:7168
    v_mfma_f32_16x16x32_bf16 v[80:83], v[28:31], v[8:11], v[80:83]
    ds_read_b128 v[48:51], v3 offset:8192
    ds_read_b128 v[52:55], v3 offset:9216
    s_waitcnt lgkmcnt(0)
    s_barrier
    v_mfma_f32_16x16x32_bf16 v[64:67], v[36:39], v[32:35], v[64:67]
    ds_read_b128 v[8:11], v1 offset:8192
    v_mfma_f32_16x16x32_bf16 v[68:71], v[40:43], v[32:35], v[68:71]
    ds_read_b128 v[12:15], v3 offset:10240
    v_mfma_f32_16x16x32_bf16 v[72:75], v[44:47], v[32:35], v[72:75]
    ds_read_b128 v[16:19], v3 offset:11264
    v_mfma_f32_16x16x32_bf16 v[76:79], v[48:51], v[32:35], v[76:79]
    ds_read_b128 v[20:23], v3 offset:12288
    v_mfma_f32_16x16x32_bf16 v[80:83], v[52:55], v[32:35], v[80:83]
    ds_read_b128 v[24:27], v3 offset:13312
    ds_read_b128 v[28:31], v3 offset:14336
    s_waitcnt lgkmcnt(0)
    v_mfma_f32_16x16x32_bf16 v[64:67], v[12:15], v[8:11], v[64:67]
    ds_read_b128 v[32:35], v2 offset:8192
    v_mfma_f32_16x16x32_bf16 v[68:71], v[16:19], v[8:11], v[68:71]
    ds_read_b128 v[36:39], v3 offset:15360
    v_mfma_f32_16x16x32_bf16 v[72:75], v[20:23], v[8:11], v[72:75]
    ds_read_b128 v[40:43], v3 offset:16384
    v_mfma_f32_16x16x32_bf16 v[76:79], v[24:27], v[8:11], v[76:79]
    ds_read_b128 v[44:47], v3 offset:17408
    v_mfma_f32_16x16x32_bf16 v[80:83], v[28:31], v[8:11], v[80:83]
    ds_read_b128 v[48:51], v3 offset:18432
    ds_read_b128 v[52:55], v3 offset:19456
    s_waitcnt lgkmcnt(0)
    s_barrier
    v_mfma_f32_16x16x32_bf16 v[64:67], v[36:39], v[32:35], v[64:67]
    ds_read_b128 v[8:11], v1 offset:16384
    v_mfma_f32_16x16x32_bf16 v[68:71], v[40:43], v[32:35], v[68:71]
    ds_read_b128 v[12:15], v3 offset:20480
    v_mfma_f32_16x16x32_bf16 v[72:75], v[44:47], v[32:35], v[72:75]
    ds_read_b128 v[16:19], v3 offset:21504
    v_mfma_f32_16x16x32_bf16 v[76:79], v[48:51], v[32:35], v[76:79]
    ds_read_b128 v[20:23], v3 offset:22528
    v_mfma_f32_16x16x32_bf16 v[80:83], v[52:55], v[32:35], v[80:83]
    ds_read_b128 v[24:27], v3 offset:23552
    ds_read_b128 v[28:31], v3 offset:24576
    s_waitcnt lgkmcnt(0)
    s_barrier
    s_waitcnt vmcnt(0)
    s_nop 3
    s_add_u32 s12, s32, 0xa00000
    s_addc_u32 s13, s33, 0
    s_mov_b32 s14, 0x280000
    s_mov_b32 s15, 0x00020000
    s_mul_i32 s36, s26, 2560
    v_and_b32 v24, 15, v0
    v_mul_u32_u24 v24, 160, v24
    v_lshrrev_b32 v25, 4, v0
    v_lshl_add_u32 v24, v25, 3, v24
    v_add_u32 v24, s36, v24
    v_mul_f32 v122, v122, v123
    v_mov_b32 v6, 0
    v_mov_b32 v7, 0
    v_lshlrev_b32 v32, 16, v100
    v_and_b32 v33, 0xffff0000, v100
    v_lshlrev_b32 v34, 16, v101
    v_and_b32 v35, 0xffff0000, v101
    v_fma_f32 v32, v32, v123, -v122
    v_fma_f32 v33, v33, v123, -v122
    v_fma_f32 v34, v34, v123, -v122
    v_fma_f32 v35, v35, v123, -v122
    v_pk_add_f32 v[64:65], v[64:65], v[32:33]
    v_pk_add_f32 v[66:67], v[66:67], v[34:35]
    v_add_f32 v6, v6, v64
    v_fmac_f32 v7, v64, v64
    v_add_f32 v6, v6, v65
    v_fmac_f32 v7, v65, v65
    v_add_f32 v6, v6, v66
    v_fmac_f32 v7, v66, v66
    v_add_f32 v6, v6, v67
    v_fmac_f32 v7, v67, v67
    v_cvt_pk_bf16_f32 v64, v64, v65
    v_cvt_pk_bf16_f32 v65, v66, v67
    ds_write_b64 v24, v[64:65] offset:0
    v_lshlrev_b32 v32, 16, v102
    v_and_b32 v33, 0xffff0000, v102
    v_lshlrev_b32 v34, 16, v103
    v_and_b32 v35, 0xffff0000, v103
    v_fma_f32 v32, v32, v123, -v122
    v_fma_f32 v33, v33, v123, -v122
    v_fma_f32 v34, v34, v123, -v122
    v_fma_f32 v35, v35, v123, -v122
    v_pk_add_f32 v[68:69], v[68:69], v[32:33]
    v_pk_add_f32 v[70:71], v[70:71], v[34:35]
    v_add_f32 v6, v6, v68
    v_fmac_f32 v7, v68, v68
    v_add_f32 v6, v6, v69
    v_fmac_f32 v7, v69, v69
    v_add_f32 v6, v6, v70
    v_fmac_f32 v7, v70, v70
    v_add_f32 v6, v6, v71
    v_fmac_f32 v7, v71, v71
    v_cvt_pk_bf16_f32 v68, v68, v69
    v_cvt_pk_bf16_f32 v69, v70, v71
    ds_write_b64 v24, v[68:69] offset:32
    v_lshlrev_b32 v32, 16, v104
    v_and_b32 v33, 0xffff0000, v104
    v_lshlrev_b32 v34, 16, v105
    v_and_b32 v35, 0xffff0000, v105
    v_fma_f32 v32, v32, v123, -v122
    v_fma_f32 v33, v33, v123, -v122
    v_fma_f32 v34, v34, v123, -v122
    v_fma_f32 v35, v35, v123, -v122
    v_pk_add_f32 v[72:73], v[72:73], v[32:33]
    v_pk_add_f32 v[74:75], v[74:75], v[34:35]
    v_add_f32 v6, v6, v72
    v_fmac_f32 v7, v72, v72
    v_add_f32 v6, v6, v73
    v_fmac_f32 v7, v73, v73
    v_add_f32 v6, v6, v74
    v_fmac_f32 v7, v74, v74
    v_add_f32 v6, v6, v75
    v_fmac_f32 v7, v75, v75
    v_cvt_pk_bf16_f32 v72, v72, v73
    v_cvt_pk_bf16_f32 v73, v74, v75
    ds_write_b64 v24, v[72:73] offset:64
    v_lshlrev_b32 v32, 16, v106
    v_and_b32 v33, 0xffff0000, v106
    v_lshlrev_b32 v34, 16, v107
    v_and_b32 v35, 0xffff0000, v107
    v_fma_f32 v32, v32, v123, -v122
    v_fma_f32 v33, v33, v123, -v122
    v_fma_f32 v34, v34, v123, -v122
    v_fma_f32 v35, v35, v123, -v122
    v_pk_add_f32 v[76:77], v[76:77], v[32:33]
    v_pk_add_f32 v[78:79], v[78:79], v[34:35]
    v_add_f32 v6, v6, v76
    v_fmac_f32 v7, v76, v76
    v_add_f32 v6, v6, v77
    v_fmac_f32 v7, v77, v77
    v_add_f32 v6, v6, v78
    v_fmac_f32 v7, v78, v78
    v_add_f32 v6, v6, v79
    v_fmac_f32 v7, v79, v79
    v_cvt_pk_bf16_f32 v76, v76, v77
    v_cvt_pk_bf16_f32 v77, v78, v79
    ds_write_b64 v24, v[76:77] offset:96
    v_lshlrev_b32 v32, 16, v108
    v_and_b32 v33, 0xffff0000, v108
    v_lshlrev_b32 v34, 16, v109
    v_and_b32 v35, 0xffff0000, v109
    v_fma_f32 v32, v32, v123, -v122
    v_fma_f32 v33, v33, v123, -v122
    v_fma_f32 v34, v34, v123, -v122
    v_fma_f32 v35, v35, v123, -v122
    v_pk_add_f32 v[80:81], v[80:81], v[32:33]
    v_pk_add_f32 v[82:83], v[82:83], v[34:35]
    v_add_f32 v6, v6, v80
    v_fmac_f32 v7, v80, v80
    v_add_f32 v6, v6, v81
    v_fmac_f32 v7, v81, v81
    v_add_f32 v6, v6, v82
    v_fmac_f32 v7, v82, v82
    v_add_f32 v6, v6, v83
    v_fmac_f32 v7, v83, v83
    v_cvt_pk_bf16_f32 v80, v80, v81
    v_cvt_pk_bf16_f32 v81, v82, v83
    ds_write_b64 v24, v[80:81] offset:128
    v_lshlrev_b32 v32, 4, v0
    v_add_u32 v32, s36, v32
    s_waitcnt lgkmcnt(0)
    ds_read_b128 v[8:11], v32 offset:0
    ds_read_b128 v[12:15], v32 offset:960
    ds_read_b128 v[16:19], v32 offset:1920
    v_mul_u32_u24 v33, 205, v0
    v_lshrrev_b32 v33, 11, v33
    v_mul_u32_u24 v34, 10, v33
    v_sub_u32 v34, v0, v34
    v_mul_u32_u24 v35, 1280, v33
    v_lshl_add_u32 v35, v34, 4, v35
    v_mov_b32 v34, 0x7ff00000
    v_cmp_gt_u32 vcc, 6, v33
    s_nop 1
    v_cndmask_b32 v36, v34, v35, vcc
    v_cmp_gt_u32 vcc, 4, v33
    s_nop 1
    v_cndmask_b32 v37, v34, v35, vcc
    s_lshl_b32 s47, s26, 4
    s_add_u32 s47, s47, s42
    s_mul_i32 s47, s47, 1280
    s_add_u32 s47, s47, s44
    s_add_u32 s48, s47, 0
    s_waitcnt lgkmcnt(2)
    buffer_store_dwordx4 v[8:11], v36, s[12:15], s48 offen sc1
    s_add_u32 s49, s47, 7680
    s_waitcnt lgkmcnt(1)
    buffer_store_dwordx4 v[12:15], v36, s[12:15], s49 offen sc1
    s_add_u32 s50, s47, 15360
    s_waitcnt lgkmcnt(0)
    buffer_store_dwordx4 v[16:19], v37, s[12:15], s50 offen sc1
    v_mov_b32 v4, v6
    s_nop 1
    v_permlane16_swap_b32 v4, v6
    s_nop 1
    v_add_f32 v6, v4, v6
    v_mov_b32 v4, v6
    s_nop 1
    v_permlane32_swap_b32 v4, v6
    s_nop 1
    v_add_f32 v6, v4, v6
    v_mov_b32 v4, v7
    s_nop 1
    v_permlane16_swap_b32 v4, v7
    s_nop 1
    v_add_f32 v7, v4, v7
    v_mov_b32 v4, v7
    s_nop 1
    v_permlane32_swap_b32 v4, v7
    s_nop 1
    v_add_f32 v7, v4, v7
    s_add_u32 s12, s32, 0x1a40000
    s_addc_u32 s13, s33, 0
    s_mov_b32 s14, 0x20000
    s_mov_b32 s15, 0x00020000
    v_lshlrev_b32 v4, 3, v121
    s_lshl_b32 s30, s41, 14
    v_add_u32 v4, s30, v4
    s_mov_b32 exec_lo, 0xffff
    s_mov_b32 exec_hi, 0
    buffer_store_dwordx2 v[6:7], v4, s[12:15], 0 offen sc1
    s_mov_b64 exec, -1
    s_waitcnt vmcnt(0)
    s_barrier
    s_cmp_lg_u32 s26, 0
    s_cbranch_scc1 k2_kernel_noflag
    s_lshr_b32 s30, s40, 1
    s_lshl_b32 s30, s30, 8
    s_add_u32 s30, s30, 0x1a70000
    v_mov_b32 v4, s30
    v_mov_b32 v5, 1
    s_mov_b32 exec_lo, 1
    s_mov_b32 exec_hi, 0
    global_atomic_add v4, v5, s[32:33] sc1
    s_mov_b64 exec, -1
k2_kernel_noflag:
    s_setprio 2
    s_lshl_b32 s42, s54, 7
    v_and_b32 v5, 15, v0
    v_lshrrev_b32 v6, 4, v0
    v_lshrrev_b32 v7, 1, v5
    v_xor_b32 v7, v7, v6
    s_mul_i32 s30, s28, 64
    v_add_u32 v5, s30, v5
    v_lshlrev_b32 v5, 7, v5
    v_lshl_add_u32 v1, v7, 4, v5
    v_xor_b32 v2, 64, v1
    v_lshrrev_b32 v5, 2, v0
    v_and_b32 v5, 3, v5
    v_lshl_add_u32 v5, v6, 3, v5
    v_mul_u32_u24 v5, 192, v5
    v_and_b32 v7, 3, v0
    v_lshl_add_u32 v5, v7, 3, v5
    v_add_u32 v5, 49152, v5
    v_and_b32 v6, 1, v6
    v_lshlrev_b32 v6, 5, v6
    s_mul_i32 s30, s29, 96
    v_add_u32 v5, s30, v5
    s_lshl_b32 s30, s29, 1
    s_sub_u32 s30, 1, s30
    v_mul_lo_u32 v6, v6, s30
    v_add_u32 v3, v5, v6
    v_sub_u32 v4, v5, v6
    s_mov_b32 s27, 0
    s_mov_b32 s16, 0
    s_barrier
    s_cmp_ge_u32 s26, 2
    s_cbranch_scc1 k2_kernel_nost
    s_add_u32 s12, s32, 0x1a40000
    s_addc_u32 s13, s33, 0
    s_mov_b32 s14, 0x20000
    s_mov_b32 s15, 0x00020000
    s_lshl_b32 s30, s26, 6
    v_add_u32 v6, s30, v0
    v_add_u32 v5, s42, v6
    v_lshlrev_b32 v5, 3, v5
    s_mov_b32 s30, 0
    buffer_load_dwordx2 v[8:9], v5, s[12:15], s30 offen sc1
    s_mov_b32 s30, 16384
    buffer_load_dwordx2 v[10:11], v5, s[12:15], s30 offen sc1
    s_mov_b32 s30, 32768
    buffer_load_dwordx2 v[12:13], v5, s[12:15], s30 offen sc1
    s_mov_b32 s30, 49152
    buffer_load_dwordx2 v[14:15], v5, s[12:15], s30 offen sc1
    s_mov_b32 s30, 65536
    buffer_load_dwordx2 v[16:17], v5, s[12:15], s30 offen sc1
    s_mov_b32 s30, 81920
    buffer_load_dwordx2 v[18:19], v5, s[12:15], s30 offen sc1
    s_mov_b32 s30, 98304
    buffer_load_dwordx2 v[20:21], v5, s[12:15], s30 offen sc1
    s_mov_b32 s30, 114688
    buffer_load_dwordx2 v[22:23], v5, s[12:15], s30 offen sc1
    s_waitcnt vmcnt(0)
    v_pk_add_f32 v[8:9], v[8:9], v[10:11]
    v_pk_add_f32 v[8:9], v[8:9], v[12:13]
    v_pk_add_f32 v[8:9], v[8:9], v[14:15]
    v_pk_add_f32 v[8:9], v[8:9], v[16:17]
    v_pk_add_f32 v[8:9], v[8:9], v[18:19]
    v_pk_add_f32 v[8:9], v[8:9], v[20:21]
    v_pk_add_f32 v[8:9], v[8:9], v[22:23]
    s_mov_b32 s30, 0x3acccccd
    v_mul_f32 v8, s30, v8
    v_mul_f32 v9, s30, v9
    v_fma_f32 v9, -v8, v8, v9
    v_max_f32 v9, 0, v9
    v_add_f32 v9, 0x3727c5ac, v9
    v_rsq_f32 v9, v9
    v_lshlrev_b32 v5, 3, v6
    v_add_u32 v5, 73728, v5
    ds_write_b64 v5, v[8:9]
    s_waitcnt lgkmcnt(0)
k2_kernel_nost:
    s_barrier
    ds_read_b128 v[8:11], v1 offset:0
    ds_read_b128 v[12:15], v1 offset:2048
    ds_read_b128 v[16:19], v1 offset:4096
    ds_read_b128 v[20:23], v1 offset:6144
    ds_read_b64_tr_b16 v[24:25], v3 offset:0
    ds_read_b64_tr_b16 v[26:27], v3 offset:768
    ds_read_b64_tr_b16 v[28:29], v4 offset:32
    ds_read_b64_tr_b16 v[30:31], v4 offset:800
    ds_read_b64_tr_b16 v[32:33], v3 offset:64
    ds_read_b64_tr_b16 v[34:35], v3 offset:832
    s_setprio 0
    s_waitcnt lgkmcnt(0)
    v_mfma_f32_16x16x32_bf16 v[64:67], v[24:27], v[8:11], 0
    ds_read_b128 v[36:39], v2 offset:0
    v_mfma_f32_16x16x32_bf16 v[76:79], v[24:27], v[12:15], 0
    ds_read_b128 v[40:43], v2 offset:2048
    v_mfma_f32_16x16x32_bf16 v[88:91], v[24:27], v[16:19], 0
    ds_read_b128 v[44:47], v2 offset:4096
    v_mfma_f32_16x16x32_bf16 v[100:103], v[24:27], v[20:23], 0
    ds_read_b128 v[48:51], v2 offset:6144
    v_mfma_f32_16x16x32_bf16 v[68:71], v[28:31], v[8:11], 0
    ds_read_b64_tr_b16 v[52:53], v3 offset:6144
    v_mfma_f32_16x16x32_bf16 v[80:83], v[28:31], v[12:15], 0
    ds_read_b64_tr_b16 v[54:55], v3 offset:6912
    v_mfma_f32_16x16x32_bf16 v[92:95], v[28:31], v[16:19], 0
    ds_read_b64_tr_b16 v[56:57], v4 offset:6176
    v_mfma_f32_16x16x32_bf16 v[104:107], v[28:31], v[20:23], 0
    ds_read_b64_tr_b16 v[58:59], v4 offset:6944
    v_mfma_f32_16x16x32_bf16 v[72:75], v[32:35], v[8:11], 0
    ds_read_b64_tr_b16 v[60:61], v3 offset:6208
    v_mfma_f32_16x16x32_bf16 v[84:87], v[32:35], v[12:15], 0
    ds_read_b64_tr_b16 v[62:63], v3 offset:6976
    v_mfma_f32_16x16x32_bf16 v[96:99], v[32:35], v[16:19], 0
    v_mfma_f32_16x16x32_bf16 v[108:111], v[32:35], v[20:23], 0
    s_waitcnt lgkmcnt(0)
    s_barrier
    v_mfma_f32_16x16x32_bf16 v[64:67], v[52:55], v[36:39], v[64:67]
    ds_read_b128 v[8:11], v1 offset:16384
    v_mfma_f32_16x16x32_bf16 v[76:79], v[52:55], v[40:43], v[76:79]
    ds_read_b128 v[12:15], v1 offset:18432
    v_mfma_f32_16x16x32_bf16 v[88:91], v[52:55], v[44:47], v[88:91]
    ds_read_b128 v[16:19], v1 offset:20480
    v_mfma_f32_16x16x32_bf16 v[100:103], v[52:55], v[48:51], v[100:103]
    ds_read_b128 v[20:23], v1 offset:22528
    v_mfma_f32_16x16x32_bf16 v[68:71], v[56:59], v[36:39], v[68:71]
    ds_read_b64_tr_b16 v[24:25], v3 offset:12288
    v_mfma_f32_16x16x32_bf16 v[80:83], v[56:59], v[40:43], v[80:83]
    ds_read_b64_tr_b16 v[26:27], v3 offset:13056
    v_mfma_f32_16x16x32_bf16 v[92:95], v[56:59], v[44:47], v[92:95]
    ds_read_b64_tr_b16 v[28:29], v4 offset:12320
    v_mfma_f32_16x16x32_bf16 v[104:107], v[56:59], v[48:51], v[104:107]
    ds_read_b64_tr_b16 v[30:31], v4 offset:13088
    v_mfma_f32_16x16x32_bf16 v[72:75], v[60:63], v[36:39], v[72:75]
    ds_read_b64_tr_b16 v[32:33], v3 offset:12352
    v_mfma_f32_16x16x32_bf16 v[84:87], v[60:63], v[40:43], v[84:87]
    ds_read_b64_tr_b16 v[34:35], v3 offset:13120
    v_mfma_f32_16x16x32_bf16 v[96:99], v[60:63], v[44:47], v[96:99]
    v_mfma_f32_16x16x32_bf16 v[108:111], v[60:63], v[48:51], v[108:111]
    s_waitcnt lgkmcnt(0)
    v_mfma_f32_16x16x32_bf16 v[64:67], v[24:27], v[8:11], v[64:67]
    ds_read_b128 v[36:39], v2 offset:16384
    v_mfma_f32_16x16x32_bf16 v[76:79], v[24:27], v[12:15], v[76:79]
    ds_read_b128 v[40:43], v2 offset:18432
    v_mfma_f32_16x16x32_bf16 v[88:91], v[24:27], v[16:19], v[88:91]
    ds_read_b128 v[44:47], v2 offset:20480
    v_mfma_f32_16x16x32_bf16 v[100:103], v[24:27], v[20:23], v[100:103]
    ds_read_b128 v[48:51], v2 offset:22528
    v_mfma_f32_16x16x32_bf16 v[68:71], v[28:31], v[8:11], v[68:71]
    ds_read_b64_tr_b16 v[52:53], v3 offset:18432
    v_mfma_f32_16x16x32_bf16 v[80:83], v[28:31], v[12:15], v[80:83]
    ds_read_b64_tr_b16 v[54:55], v3 offset:19200
    v_mfma_f32_16x16x32_bf16 v[92:95], v[28:31], v[16:19], v[92:95]
    ds_read_b64_tr_b16 v[56:57], v4 offset:18464
    v_mfma_f32_16x16x32_bf16 v[104:107], v[28:31], v[20:23], v[104:107]
    ds_read_b64_tr_b16 v[58:59], v4 offset:19232
    v_mfma_f32_16x16x32_bf16 v[72:75], v[32:35], v[8:11], v[72:75]
    ds_read_b64_tr_b16 v[60:61], v3 offset:18496
    v_mfma_f32_16x16x32_bf16 v[84:87], v[32:35], v[12:15], v[84:87]
    ds_read_b64_tr_b16 v[62:63], v3 offset:19264
    v_mfma_f32_16x16x32_bf16 v[96:99], v[32:35], v[16:19], v[96:99]
    v_mfma_f32_16x16x32_bf16 v[108:111], v[32:35], v[20:23], v[108:111]
    s_waitcnt lgkmcnt(0)
    s_barrier
    v_mfma_f32_16x16x32_bf16 v[64:67], v[52:55], v[36:39], v[64:67]
    ds_read_b128 v[8:11], v1 offset:32768
    v_mfma_f32_16x16x32_bf16 v[76:79], v[52:55], v[40:43], v[76:79]
    ds_read_b128 v[12:15], v1 offset:34816
    v_mfma_f32_16x16x32_bf16 v[88:91], v[52:55], v[44:47], v[88:91]
    ds_read_b128 v[16:19], v1 offset:36864
    v_mfma_f32_16x16x32_bf16 v[100:103], v[52:55], v[48:51], v[100:103]
    ds_read_b128 v[20:23], v1 offset:38912
    v_mfma_f32_16x16x32_bf16 v[68:71], v[56:59], v[36:39], v[68:71]
    ds_read_b64_tr_b16 v[24:25], v3 offset:0
    v_mfma_f32_16x16x32_bf16 v[80:83], v[56:59], v[40:43], v[80:83]
    ds_read_b64_tr_b16 v[26:27], v3 offset:768
    v_mfma_f32_16x16x32_bf16 v[92:95], v[56:59], v[44:47], v[92:95]
    ds_read_b64_tr_b16 v[28:29], v4 offset:32
    v_mfma_f32_16x16x32_bf16 v[104:107], v[56:59], v[48:51], v[104:107]
    ds_read_b64_tr_b16 v[30:31], v4 offset:800
    v_mfma_f32_16x16x32_bf16 v[72:75], v[60:63], v[36:39], v[72:75]
    ds_read_b64_tr_b16 v[32:33], v3 offset:64
    v_mfma_f32_16x16x32_bf16 v[84:87], v[60:63], v[40:43], v[84:87]
    ds_read_b64_tr_b16 v[34:35], v3 offset:832
    v_mfma_f32_16x16x32_bf16 v[96:99], v[60:63], v[44:47], v[96:99]
    v_mfma_f32_16x16x32_bf16 v[108:111], v[60:63], v[48:51], v[108:111]
    s_waitcnt lgkmcnt(0)
    v_mfma_f32_16x16x32_bf16 v[64:67], v[24:27], v[8:11], v[64:67]
    ds_read_b128 v[36:39], v2 offset:32768
    v_mfma_f32_16x16x32_bf16 v[76:79], v[24:27], v[12:15], v[76:79]
    ds_read_b128 v[40:43], v2 offset:34816
    v_mfma_f32_16x16x32_bf16 v[88:91], v[24:27], v[16:19], v[88:91]
    ds_read_b128 v[44:47], v2 offset:36864
    v_mfma_f32_16x16x32_bf16 v[100:103], v[24:27], v[20:23], v[100:103]
    ds_read_b128 v[48:51], v2 offset:38912
    v_mfma_f32_16x16x32_bf16 v[68:71], v[28:31], v[8:11], v[68:71]
    ds_read_b64_tr_b16 v[52:53], v3 offset:6144
    v_mfma_f32_16x16x32_bf16 v[80:83], v[28:31], v[12:15], v[80:83]
    ds_read_b64_tr_b16 v[54:55], v3 offset:6912
    v_mfma_f32_16x16x32_bf16 v[92:95], v[28:31], v[16:19], v[92:95]
    ds_read_b64_tr_b16 v[56:57], v4 offset:6176
    v_mfma_f32_16x16x32_bf16 v[104:107], v[28:31], v[20:23], v[104:107]
    ds_read_b64_tr_b16 v[58:59], v4 offset:6944
    v_mfma_f32_16x16x32_bf16 v[72:75], v[32:35], v[8:11], v[72:75]
    ds_read_b64_tr_b16 v[60:61], v3 offset:6208
    v_mfma_f32_16x16x32_bf16 v[84:87], v[32:35], v[12:15], v[84:87]
    ds_read_b64_tr_b16 v[62:63], v3 offset:6976
    v_mfma_f32_16x16x32_bf16 v[96:99], v[32:35], v[16:19], v[96:99]
    v_mfma_f32_16x16x32_bf16 v[108:111], v[32:35], v[20:23], v[108:111]
    s_waitcnt lgkmcnt(0)
    s_barrier
    v_mfma_f32_16x16x32_bf16 v[64:67], v[52:55], v[36:39], v[64:67]
    ds_read_b128 v[8:11], v1 offset:0
    v_mfma_f32_16x16x32_bf16 v[76:79], v[52:55], v[40:43], v[76:79]
    ds_read_b128 v[12:15], v1 offset:2048
    v_mfma_f32_16x16x32_bf16 v[88:91], v[52:55], v[44:47], v[88:91]
    ds_read_b128 v[16:19], v1 offset:4096
    v_mfma_f32_16x16x32_bf16 v[100:103], v[52:55], v[48:51], v[100:103]
    ds_read_b128 v[20:23], v1 offset:6144
    v_mfma_f32_16x16x32_bf16 v[68:71], v[56:59], v[36:39], v[68:71]
    ds_read_b64_tr_b16 v[24:25], v3 offset:12288
    v_mfma_f32_16x16x32_bf16 v[80:83], v[56:59], v[40:43], v[80:83]
    ds_read_b64_tr_b16 v[26:27], v3 offset:13056
    v_mfma_f32_16x16x32_bf16 v[92:95], v[56:59], v[44:47], v[92:95]
    ds_read_b64_tr_b16 v[28:29], v4 offset:12320
    v_mfma_f32_16x16x32_bf16 v[104:107], v[56:59], v[48:51], v[104:107]
    ds_read_b64_tr_b16 v[30:31], v4 offset:13088
    v_mfma_f32_16x16x32_bf16 v[72:75], v[60:63], v[36:39], v[72:75]
    ds_read_b64_tr_b16 v[32:33], v3 offset:12352
    v_mfma_f32_16x16x32_bf16 v[84:87], v[60:63], v[40:43], v[84:87]
    ds_read_b64_tr_b16 v[34:35], v3 offset:13120
    v_mfma_f32_16x16x32_bf16 v[96:99], v[60:63], v[44:47], v[96:99]
    v_mfma_f32_16x16x32_bf16 v[108:111], v[60:63], v[48:51], v[108:111]
    s_waitcnt lgkmcnt(0)
    v_mfma_f32_16x16x32_bf16 v[64:67], v[24:27], v[8:11], v[64:67]
    ds_read_b128 v[36:39], v2 offset:0
    v_mfma_f32_16x16x32_bf16 v[76:79], v[24:27], v[12:15], v[76:79]
    ds_read_b128 v[40:43], v2 offset:2048
    v_mfma_f32_16x16x32_bf16 v[88:91], v[24:27], v[16:19], v[88:91]
    ds_read_b128 v[44:47], v2 offset:4096
    v_mfma_f32_16x16x32_bf16 v[100:103], v[24:27], v[20:23], v[100:103]
    ds_read_b128 v[48:51], v2 offset:6144
    v_mfma_f32_16x16x32_bf16 v[68:71], v[28:31], v[8:11], v[68:71]
    ds_read_b64_tr_b16 v[52:53], v3 offset:18432
    v_mfma_f32_16x16x32_bf16 v[80:83], v[28:31], v[12:15], v[80:83]
    ds_read_b64_tr_b16 v[54:55], v3 offset:19200
    v_mfma_f32_16x16x32_bf16 v[92:95], v[28:31], v[16:19], v[92:95]
    ds_read_b64_tr_b16 v[56:57], v4 offset:18464
    v_mfma_f32_16x16x32_bf16 v[104:107], v[28:31], v[20:23], v[104:107]
    ds_read_b64_tr_b16 v[58:59], v4 offset:19232
    v_mfma_f32_16x16x32_bf16 v[72:75], v[32:35], v[8:11], v[72:75]
    ds_read_b64_tr_b16 v[60:61], v3 offset:18496
    v_mfma_f32_16x16x32_bf16 v[84:87], v[32:35], v[12:15], v[84:87]
    ds_read_b64_tr_b16 v[62:63], v3 offset:19264
    v_mfma_f32_16x16x32_bf16 v[96:99], v[32:35], v[16:19], v[96:99]
    v_mfma_f32_16x16x32_bf16 v[108:111], v[32:35], v[20:23], v[108:111]
    s_waitcnt lgkmcnt(0)
    s_barrier
    v_mfma_f32_16x16x32_bf16 v[64:67], v[52:55], v[36:39], v[64:67]
    ds_read_b128 v[8:11], v1 offset:16384
    v_mfma_f32_16x16x32_bf16 v[76:79], v[52:55], v[40:43], v[76:79]
    ds_read_b128 v[12:15], v1 offset:18432
    v_mfma_f32_16x16x32_bf16 v[88:91], v[52:55], v[44:47], v[88:91]
    ds_read_b128 v[16:19], v1 offset:20480
    v_mfma_f32_16x16x32_bf16 v[100:103], v[52:55], v[48:51], v[100:103]
    ds_read_b128 v[20:23], v1 offset:22528
    v_mfma_f32_16x16x32_bf16 v[68:71], v[56:59], v[36:39], v[68:71]
    ds_read_b64_tr_b16 v[24:25], v3 offset:0
    v_mfma_f32_16x16x32_bf16 v[80:83], v[56:59], v[40:43], v[80:83]
    ds_read_b64_tr_b16 v[26:27], v3 offset:768
    v_mfma_f32_16x16x32_bf16 v[92:95], v[56:59], v[44:47], v[92:95]
    ds_read_b64_tr_b16 v[28:29], v4 offset:32
    v_mfma_f32_16x16x32_bf16 v[104:107], v[56:59], v[48:51], v[104:107]
    ds_read_b64_tr_b16 v[30:31], v4 offset:800
    v_mfma_f32_16x16x32_bf16 v[72:75], v[60:63], v[36:39], v[72:75]
    ds_read_b64_tr_b16 v[32:33], v3 offset:64
    v_mfma_f32_16x16x32_bf16 v[84:87], v[60:63], v[40:43], v[84:87]
    ds_read_b64_tr_b16 v[34:35], v3 offset:832
    v_mfma_f32_16x16x32_bf16 v[96:99], v[60:63], v[44:47], v[96:99]
    v_mfma_f32_16x16x32_bf16 v[108:111], v[60:63], v[48:51], v[108:111]
    s_waitcnt lgkmcnt(0)
    v_mfma_f32_16x16x32_bf16 v[64:67], v[24:27], v[8:11], v[64:67]
    ds_read_b128 v[36:39], v2 offset:16384
    v_mfma_f32_16x16x32_bf16 v[76:79], v[24:27], v[12:15], v[76:79]
    ds_read_b128 v[40:43], v2 offset:18432
    v_mfma_f32_16x16x32_bf16 v[88:91], v[24:27], v[16:19], v[88:91]
    ds_read_b128 v[44:47], v2 offset:20480
    v_mfma_f32_16x16x32_bf16 v[100:103], v[24:27], v[20:23], v[100:103]
    ds_read_b128 v[48:51], v2 offset:22528
    v_mfma_f32_16x16x32_bf16 v[68:71], v[28:31], v[8:11], v[68:71]
    ds_read_b64_tr_b16 v[52:53], v3 offset:6144
    v_mfma_f32_16x16x32_bf16 v[80:83], v[28:31], v[12:15], v[80:83]
    ds_read_b64_tr_b16 v[54:55], v3 offset:6912
    v_mfma_f32_16x16x32_bf16 v[92:95], v[28:31], v[16:19], v[92:95]
    ds_read_b64_tr_b16 v[56:57], v4 offset:6176
    v_mfma_f32_16x16x32_bf16 v[104:107], v[28:31], v[20:23], v[104:107]
    ds_read_b64_tr_b16 v[58:59], v4 offset:6944
    v_mfma_f32_16x16x32_bf16 v[72:75], v[32:35], v[8:11], v[72:75]
    ds_read_b64_tr_b16 v[60:61], v3 offset:6208
    v_mfma_f32_16x16x32_bf16 v[84:87], v[32:35], v[12:15], v[84:87]
    ds_read_b64_tr_b16 v[62:63], v3 offset:6976
    v_mfma_f32_16x16x32_bf16 v[96:99], v[32:35], v[16:19], v[96:99]
    v_mfma_f32_16x16x32_bf16 v[108:111], v[32:35], v[20:23], v[108:111]
    s_waitcnt lgkmcnt(0)
    s_barrier
    v_mfma_f32_16x16x32_bf16 v[64:67], v[52:55], v[36:39], v[64:67]
    ds_read_b128 v[8:11], v1 offset:32768
    v_mfma_f32_16x16x32_bf16 v[76:79], v[52:55], v[40:43], v[76:79]
    ds_read_b128 v[12:15], v1 offset:34816
    v_mfma_f32_16x16x32_bf16 v[88:91], v[52:55], v[44:47], v[88:91]
    ds_read_b128 v[16:19], v1 offset:36864
    v_mfma_f32_16x16x32_bf16 v[100:103], v[52:55], v[48:51], v[100:103]
    ds_read_b128 v[20:23], v1 offset:38912
    v_mfma_f32_16x16x32_bf16 v[68:71], v[56:59], v[36:39], v[68:71]
    ds_read_b64_tr_b16 v[24:25], v3 offset:12288
    v_mfma_f32_16x16x32_bf16 v[80:83], v[56:59], v[40:43], v[80:83]
    ds_read_b64_tr_b16 v[26:27], v3 offset:13056
    v_mfma_f32_16x16x32_bf16 v[92:95], v[56:59], v[44:47], v[92:95]
    ds_read_b64_tr_b16 v[28:29], v4 offset:12320
    v_mfma_f32_16x16x32_bf16 v[104:107], v[56:59], v[48:51], v[104:107]
    ds_read_b64_tr_b16 v[30:31], v4 offset:13088
    v_mfma_f32_16x16x32_bf16 v[72:75], v[60:63], v[36:39], v[72:75]
    ds_read_b64_tr_b16 v[32:33], v3 offset:12352
    v_mfma_f32_16x16x32_bf16 v[84:87], v[60:63], v[40:43], v[84:87]
    ds_read_b64_tr_b16 v[34:35], v3 offset:13120
    v_mfma_f32_16x16x32_bf16 v[96:99], v[60:63], v[44:47], v[96:99]
    v_mfma_f32_16x16x32_bf16 v[108:111], v[60:63], v[48:51], v[108:111]
    s_waitcnt lgkmcnt(0)
    v_mfma_f32_16x16x32_bf16 v[64:67], v[24:27], v[8:11], v[64:67]
    ds_read_b128 v[36:39], v2 offset:32768
    v_mfma_f32_16x16x32_bf16 v[76:79], v[24:27], v[12:15], v[76:79]
    ds_read_b128 v[40:43], v2 offset:34816
    v_mfma_f32_16x16x32_bf16 v[88:91], v[24:27], v[16:19], v[88:91]
    ds_read_b128 v[44:47], v2 offset:36864
    v_mfma_f32_16x16x32_bf16 v[100:103], v[24:27], v[20:23], v[100:103]
    ds_read_b128 v[48:51], v2 offset:38912
    v_mfma_f32_16x16x32_bf16 v[68:71], v[28:31], v[8:11], v[68:71]
    ds_read_b64_tr_b16 v[52:53], v3 offset:18432
    v_mfma_f32_16x16x32_bf16 v[80:83], v[28:31], v[12:15], v[80:83]
    ds_read_b64_tr_b16 v[54:55], v3 offset:19200
    v_mfma_f32_16x16x32_bf16 v[92:95], v[28:31], v[16:19], v[92:95]
    ds_read_b64_tr_b16 v[56:57], v4 offset:18464
    v_mfma_f32_16x16x32_bf16 v[104:107], v[28:31], v[20:23], v[104:107]
    ds_read_b64_tr_b16 v[58:59], v4 offset:19232
    v_mfma_f32_16x16x32_bf16 v[72:75], v[32:35], v[8:11], v[72:75]
    ds_read_b64_tr_b16 v[60:61], v3 offset:18496
    v_mfma_f32_16x16x32_bf16 v[84:87], v[32:35], v[12:15], v[84:87]
    ds_read_b64_tr_b16 v[62:63], v3 offset:19264
    v_mfma_f32_16x16x32_bf16 v[96:99], v[32:35], v[16:19], v[96:99]
    v_mfma_f32_16x16x32_bf16 v[108:111], v[32:35], v[20:23], v[108:111]
    s_waitcnt lgkmcnt(0)
    s_barrier
    v_mfma_f32_16x16x32_bf16 v[64:67], v[52:55], v[36:39], v[64:67]
    ds_read_b128 v[8:11], v1 offset:0
    v_mfma_f32_16x16x32_bf16 v[76:79], v[52:55], v[40:43], v[76:79]
    ds_read_b128 v[12:15], v1 offset:2048
    v_mfma_f32_16x16x32_bf16 v[88:91], v[52:55], v[44:47], v[88:91]
    ds_read_b128 v[16:19], v1 offset:4096
    v_mfma_f32_16x16x32_bf16 v[100:103], v[52:55], v[48:51], v[100:103]
    ds_read_b128 v[20:23], v1 offset:6144
    v_mfma_f32_16x16x32_bf16 v[68:71], v[56:59], v[36:39], v[68:71]
    ds_read_b64_tr_b16 v[24:25], v3 offset:0
    v_mfma_f32_16x16x32_bf16 v[80:83], v[56:59], v[40:43], v[80:83]
    ds_read_b64_tr_b16 v[26:27], v3 offset:768
    v_mfma_f32_16x16x32_bf16 v[92:95], v[56:59], v[44:47], v[92:95]
    ds_read_b64_tr_b16 v[28:29], v4 offset:32
    v_mfma_f32_16x16x32_bf16 v[104:107], v[56:59], v[48:51], v[104:107]
    ds_read_b64_tr_b16 v[30:31], v4 offset:800
    v_mfma_f32_16x16x32_bf16 v[72:75], v[60:63], v[36:39], v[72:75]
    ds_read_b64_tr_b16 v[32:33], v3 offset:64
    v_mfma_f32_16x16x32_bf16 v[84:87], v[60:63], v[40:43], v[84:87]
    ds_read_b64_tr_b16 v[34:35], v3 offset:832
    v_mfma_f32_16x16x32_bf16 v[96:99], v[60:63], v[44:47], v[96:99]
    v_mfma_f32_16x16x32_bf16 v[108:111], v[60:63], v[48:51], v[108:111]
    s_waitcnt lgkmcnt(0)
    v_mfma_f32_16x16x32_bf16 v[64:67], v[24:27], v[8:11], v[64:67]
    ds_read_b128 v[36:39], v2 offset:0
    v_mfma_f32_16x16x32_bf16 v[76:79], v[24:27], v[12:15], v[76:79]
    ds_read_b128 v[40:43], v2 offset:2048
    v_mfma_f32_16x16x32_bf16 v[88:91], v[24:27], v[16:19], v[88:91]
    ds_read_b128 v[44:47], v2 offset:4096
    v_mfma_f32_16x16x32_bf16 v[100:103], v[24:27], v[20:23], v[100:103]
    ds_read_b128 v[48:51], v2 offset:6144
    v_mfma_f32_16x16x32_bf16 v[68:71], v[28:31], v[8:11], v[68:71]
    ds_read_b64_tr_b16 v[52:53], v3 offset:6144
    v_mfma_f32_16x16x32_bf16 v[80:83], v[28:31], v[12:15], v[80:83]
    ds_read_b64_tr_b16 v[54:55], v3 offset:6912
    v_mfma_f32_16x16x32_bf16 v[92:95], v[28:31], v[16:19], v[92:95]
    ds_read_b64_tr_b16 v[56:57], v4 offset:6176
    v_mfma_f32_16x16x32_bf16 v[104:107], v[28:31], v[20:23], v[104:107]
    ds_read_b64_tr_b16 v[58:59], v4 offset:6944
    v_mfma_f32_16x16x32_bf16 v[72:75], v[32:35], v[8:11], v[72:75]
    ds_read_b64_tr_b16 v[60:61], v3 offset:6208
    v_mfma_f32_16x16x32_bf16 v[84:87], v[32:35], v[12:15], v[84:87]
    ds_read_b64_tr_b16 v[62:63], v3 offset:6976
    v_mfma_f32_16x16x32_bf16 v[96:99], v[32:35], v[16:19], v[96:99]
    v_mfma_f32_16x16x32_bf16 v[108:111], v[32:35], v[20:23], v[108:111]
    s_waitcnt lgkmcnt(0)
    s_barrier
    v_mfma_f32_16x16x32_bf16 v[64:67], v[52:55], v[36:39], v[64:67]
    ds_read_b128 v[8:11], v1 offset:16384
    v_mfma_f32_16x16x32_bf16 v[76:79], v[52:55], v[40:43], v[76:79]
    ds_read_b128 v[12:15], v1 offset:18432
    v_mfma_f32_16x16x32_bf16 v[88:91], v[52:55], v[44:47], v[88:91]
    ds_read_b128 v[16:19], v1 offset:20480
    v_mfma_f32_16x16x32_bf16 v[100:103], v[52:55], v[48:51], v[100:103]
    ds_read_b128 v[20:23], v1 offset:22528
    v_mfma_f32_16x16x32_bf16 v[68:71], v[56:59], v[36:39], v[68:71]
    ds_read_b64_tr_b16 v[24:25], v3 offset:12288
    v_mfma_f32_16x16x32_bf16 v[80:83], v[56:59], v[40:43], v[80:83]
    ds_read_b64_tr_b16 v[26:27], v3 offset:13056
    v_mfma_f32_16x16x32_bf16 v[92:95], v[56:59], v[44:47], v[92:95]
    ds_read_b64_tr_b16 v[28:29], v4 offset:12320
    v_mfma_f32_16x16x32_bf16 v[104:107], v[56:59], v[48:51], v[104:107]
    ds_read_b64_tr_b16 v[30:31], v4 offset:13088
    v_mfma_f32_16x16x32_bf16 v[72:75], v[60:63], v[36:39], v[72:75]
    ds_read_b64_tr_b16 v[32:33], v3 offset:12352
    v_mfma_f32_16x16x32_bf16 v[84:87], v[60:63], v[40:43], v[84:87]
    ds_read_b64_tr_b16 v[34:35], v3 offset:13120
    v_mfma_f32_16x16x32_bf16 v[96:99], v[60:63], v[44:47], v[96:99]
    v_mfma_f32_16x16x32_bf16 v[108:111], v[60:63], v[48:51], v[108:111]
    s_waitcnt lgkmcnt(0)
    v_mfma_f32_16x16x32_bf16 v[64:67], v[24:27], v[8:11], v[64:67]
    ds_read_b128 v[36:39], v2 offset:16384
    v_mfma_f32_16x16x32_bf16 v[76:79], v[24:27], v[12:15], v[76:79]
    ds_read_b128 v[40:43], v2 offset:18432
    v_mfma_f32_16x16x32_bf16 v[88:91], v[24:27], v[16:19], v[88:91]
    ds_read_b128 v[44:47], v2 offset:20480
    v_mfma_f32_16x16x32_bf16 v[100:103], v[24:27], v[20:23], v[100:103]
    ds_read_b128 v[48:51], v2 offset:22528
    v_mfma_f32_16x16x32_bf16 v[68:71], v[28:31], v[8:11], v[68:71]
    ds_read_b64_tr_b16 v[52:53], v3 offset:18432
    v_mfma_f32_16x16x32_bf16 v[80:83], v[28:31], v[12:15], v[80:83]
    ds_read_b64_tr_b16 v[54:55], v3 offset:19200
    v_mfma_f32_16x16x32_bf16 v[92:95], v[28:31], v[16:19], v[92:95]
    ds_read_b64_tr_b16 v[56:57], v4 offset:18464
    v_mfma_f32_16x16x32_bf16 v[104:107], v[28:31], v[20:23], v[104:107]
    ds_read_b64_tr_b16 v[58:59], v4 offset:19232
    v_mfma_f32_16x16x32_bf16 v[72:75], v[32:35], v[8:11], v[72:75]
    ds_read_b64_tr_b16 v[60:61], v3 offset:18496
    v_mfma_f32_16x16x32_bf16 v[84:87], v[32:35], v[12:15], v[84:87]
    ds_read_b64_tr_b16 v[62:63], v3 offset:19264
    v_mfma_f32_16x16x32_bf16 v[96:99], v[32:35], v[16:19], v[96:99]
    v_mfma_f32_16x16x32_bf16 v[108:111], v[32:35], v[20:23], v[108:111]
    s_waitcnt lgkmcnt(0)
    s_barrier
    v_mfma_f32_16x16x32_bf16 v[64:67], v[52:55], v[36:39], v[64:67]
    ds_read_b128 v[8:11], v1 offset:32768
    v_mfma_f32_16x16x32_bf16 v[76:79], v[52:55], v[40:43], v[76:79]
    ds_read_b128 v[12:15], v1 offset:34816
    v_mfma_f32_16x16x32_bf16 v[88:91], v[52:55], v[44:47], v[88:91]
    ds_read_b128 v[16:19], v1 offset:36864
    v_mfma_f32_16x16x32_bf16 v[100:103], v[52:55], v[48:51], v[100:103]
    ds_read_b128 v[20:23], v1 offset:38912
    v_mfma_f32_16x16x32_bf16 v[68:71], v[56:59], v[36:39], v[68:71]
    ds_read_b64_tr_b16 v[24:25], v3 offset:0
    v_mfma_f32_16x16x32_bf16 v[80:83], v[56:59], v[40:43], v[80:83]
    ds_read_b64_tr_b16 v[26:27], v3 offset:768
    v_mfma_f32_16x16x32_bf16 v[92:95], v[56:59], v[44:47], v[92:95]
    ds_read_b64_tr_b16 v[28:29], v4 offset:32
    v_mfma_f32_16x16x32_bf16 v[104:107], v[56:59], v[48:51], v[104:107]
    ds_read_b64_tr_b16 v[30:31], v4 offset:800
    v_mfma_f32_16x16x32_bf16 v[72:75], v[60:63], v[36:39], v[72:75]
    ds_read_b64_tr_b16 v[32:33], v3 offset:64
    v_mfma_f32_16x16x32_bf16 v[84:87], v[60:63], v[40:43], v[84:87]
    ds_read_b64_tr_b16 v[34:35], v3 offset:832
    v_mfma_f32_16x16x32_bf16 v[96:99], v[60:63], v[44:47], v[96:99]
    v_mfma_f32_16x16x32_bf16 v[108:111], v[60:63], v[48:51], v[108:111]
    s_waitcnt lgkmcnt(0)
    v_mfma_f32_16x16x32_bf16 v[64:67], v[24:27], v[8:11], v[64:67]
    ds_read_b128 v[36:39], v2 offset:32768
    v_mfma_f32_16x16x32_bf16 v[76:79], v[24:27], v[12:15], v[76:79]
    ds_read_b128 v[40:43], v2 offset:34816
    v_mfma_f32_16x16x32_bf16 v[88:91], v[24:27], v[16:19], v[88:91]
    ds_read_b128 v[44:47], v2 offset:36864
    v_mfma_f32_16x16x32_bf16 v[100:103], v[24:27], v[20:23], v[100:103]
    ds_read_b128 v[48:51], v2 offset:38912
    v_mfma_f32_16x16x32_bf16 v[68:71], v[28:31], v[8:11], v[68:71]
    ds_read_b64_tr_b16 v[52:53], v3 offset:6144
    v_mfma_f32_16x16x32_bf16 v[80:83], v[28:31], v[12:15], v[80:83]
    ds_read_b64_tr_b16 v[54:55], v3 offset:6912
    v_mfma_f32_16x16x32_bf16 v[92:95], v[28:31], v[16:19], v[92:95]
    ds_read_b64_tr_b16 v[56:57], v4 offset:6176
    v_mfma_f32_16x16x32_bf16 v[104:107], v[28:31], v[20:23], v[104:107]
    ds_read_b64_tr_b16 v[58:59], v4 offset:6944
    v_mfma_f32_16x16x32_bf16 v[72:75], v[32:35], v[8:11], v[72:75]
    ds_read_b64_tr_b16 v[60:61], v3 offset:6208
    v_mfma_f32_16x16x32_bf16 v[84:87], v[32:35], v[12:15], v[84:87]
    ds_read_b64_tr_b16 v[62:63], v3 offset:6976
    v_mfma_f32_16x16x32_bf16 v[96:99], v[32:35], v[16:19], v[96:99]
    v_mfma_f32_16x16x32_bf16 v[108:111], v[32:35], v[20:23], v[108:111]
    s_waitcnt lgkmcnt(0)
    s_barrier
    v_mfma_f32_16x16x32_bf16 v[64:67], v[52:55], v[36:39], v[64:67]
    ds_read_b128 v[8:11], v1 offset:0
    v_mfma_f32_16x16x32_bf16 v[76:79], v[52:55], v[40:43], v[76:79]
    ds_read_b128 v[12:15], v1 offset:2048
    v_mfma_f32_16x16x32_bf16 v[88:91], v[52:55], v[44:47], v[88:91]
    ds_read_b128 v[16:19], v1 offset:4096
    v_mfma_f32_16x16x32_bf16 v[100:103], v[52:55], v[48:51], v[100:103]
    ds_read_b128 v[20:23], v1 offset:6144
    v_mfma_f32_16x16x32_bf16 v[68:71], v[56:59], v[36:39], v[68:71]
    ds_read_b64_tr_b16 v[24:25], v3 offset:12288
    v_mfma_f32_16x16x32_bf16 v[80:83], v[56:59], v[40:43], v[80:83]
    ds_read_b64_tr_b16 v[26:27], v3 offset:13056
    v_mfma_f32_16x16x32_bf16 v[92:95], v[56:59], v[44:47], v[92:95]
    ds_read_b64_tr_b16 v[28:29], v4 offset:12320
    v_mfma_f32_16x16x32_bf16 v[104:107], v[56:59], v[48:51], v[104:107]
    ds_read_b64_tr_b16 v[30:31], v4 offset:13088
    v_mfma_f32_16x16x32_bf16 v[72:75], v[60:63], v[36:39], v[72:75]
    ds_read_b64_tr_b16 v[32:33], v3 offset:12352
    v_mfma_f32_16x16x32_bf16 v[84:87], v[60:63], v[40:43], v[84:87]
    ds_read_b64_tr_b16 v[34:35], v3 offset:13120
    v_mfma_f32_16x16x32_bf16 v[96:99], v[60:63], v[44:47], v[96:99]
    v_mfma_f32_16x16x32_bf16 v[108:111], v[60:63], v[48:51], v[108:111]
    s_waitcnt lgkmcnt(0)
    v_mfma_f32_16x16x32_bf16 v[64:67], v[24:27], v[8:11], v[64:67]
    ds_read_b128 v[36:39], v2 offset:0
    v_mfma_f32_16x16x32_bf16 v[76:79], v[24:27], v[12:15], v[76:79]
    ds_read_b128 v[40:43], v2 offset:2048
    v_mfma_f32_16x16x32_bf16 v[88:91], v[24:27], v[16:19], v[88:91]
    ds_read_b128 v[44:47], v2 offset:4096
    v_mfma_f32_16x16x32_bf16 v[100:103], v[24:27], v[20:23], v[100:103]
    ds_read_b128 v[48:51], v2 offset:6144
    v_mfma_f32_16x16x32_bf16 v[68:71], v[28:31], v[8:11], v[68:71]
    ds_read_b64_tr_b16 v[52:53], v3 offset:18432
    v_mfma_f32_16x16x32_bf16 v[80:83], v[28:31], v[12:15], v[80:83]
    ds_read_b64_tr_b16 v[54:55], v3 offset:19200
    v_mfma_f32_16x16x32_bf16 v[92:95], v[28:31], v[16:19], v[92:95]
    ds_read_b64_tr_b16 v[56:57], v4 offset:18464
    v_mfma_f32_16x16x32_bf16 v[104:107], v[28:31], v[20:23], v[104:107]
    ds_read_b64_tr_b16 v[58:59], v4 offset:19232
    v_mfma_f32_16x16x32_bf16 v[72:75], v[32:35], v[8:11], v[72:75]
    ds_read_b64_tr_b16 v[60:61], v3 offset:18496
    v_mfma_f32_16x16x32_bf16 v[84:87], v[32:35], v[12:15], v[84:87]
    ds_read_b64_tr_b16 v[62:63], v3 offset:19264
    v_mfma_f32_16x16x32_bf16 v[96:99], v[32:35], v[16:19], v[96:99]
    v_mfma_f32_16x16x32_bf16 v[108:111], v[32:35], v[20:23], v[108:111]
    s_waitcnt lgkmcnt(0)
    s_barrier
    v_mfma_f32_16x16x32_bf16 v[64:67], v[52:55], v[36:39], v[64:67]
    ds_read_b128 v[8:11], v1 offset:16384
    v_mfma_f32_16x16x32_bf16 v[76:79], v[52:55], v[40:43], v[76:79]
    ds_read_b128 v[12:15], v1 offset:18432
    v_mfma_f32_16x16x32_bf16 v[88:91], v[52:55], v[44:47], v[88:91]
    ds_read_b128 v[16:19], v1 offset:20480
    v_mfma_f32_16x16x32_bf16 v[100:103], v[52:55], v[48:51], v[100:103]
    ds_read_b128 v[20:23], v1 offset:22528
    v_mfma_f32_16x16x32_bf16 v[68:71], v[56:59], v[36:39], v[68:71]
    ds_read_b64_tr_b16 v[24:25], v3 offset:0
    v_mfma_f32_16x16x32_bf16 v[80:83], v[56:59], v[40:43], v[80:83]
    ds_read_b64_tr_b16 v[26:27], v3 offset:768
    v_mfma_f32_16x16x32_bf16 v[92:95], v[56:59], v[44:47], v[92:95]
    ds_read_b64_tr_b16 v[28:29], v4 offset:32
    v_mfma_f32_16x16x32_bf16 v[104:107], v[56:59], v[48:51], v[104:107]
    ds_read_b64_tr_b16 v[30:31], v4 offset:800
    v_mfma_f32_16x16x32_bf16 v[72:75], v[60:63], v[36:39], v[72:75]
    ds_read_b64_tr_b16 v[32:33], v3 offset:64
    v_mfma_f32_16x16x32_bf16 v[84:87], v[60:63], v[40:43], v[84:87]
    ds_read_b64_tr_b16 v[34:35], v3 offset:832
    v_mfma_f32_16x16x32_bf16 v[96:99], v[60:63], v[44:47], v[96:99]
    v_mfma_f32_16x16x32_bf16 v[108:111], v[60:63], v[48:51], v[108:111]
    s_setprio 2
    s_waitcnt lgkmcnt(0)
    s_nop 7
    v_and_b32 v5, 15, v0
    v_lshrrev_b32 v6, 4, v0
    s_lshl_b32 s30, s28, 6
    v_add_u32 v7, s30, v5
    v_lshlrev_b32 v41, 3, v7
    v_add_u32 v41, 73728, v41
    ds_read_b64 v[8:9], v41 offset:0
    ds_read_b64 v[10:11], v41 offset:128
    ds_read_b64 v[12:13], v41 offset:256
    ds_read_b64 v[14:15], v41 offset:384
    s_mul_i32 s30, s29, 192
    s_add_u32 s30, s30, 74752
    v_lshlrev_b32 v41, 4, v6
    v_add_u32 v41, s30, v41
    ds_read_b128 v[112:115], v41 offset:0
    ds_read_b128 v[116:119], v41 offset:64
    ds_read_b128 v[120:123], v41 offset:128
    s_mul_i32 s36, s28, 12288
    s_mul_i32 s30, s29, 96
    s_add_u32 s36, s36, s30
    v_mul_u32_u24 v40, 192, v5
    v_lshl_add_u32 v40, v6, 3, v40
    v_add_u32 v40, s36, v40
    v_mov_b32 v32, 0xc0135761
    v_mov_b32 v33, 0xc0135761
    s_mov_b32 s46, 0xbdd2d3e8
    s_mov_b32 s47, 0xbdd2d3e8
    s_waitcnt lgkmcnt(0)
    v_pk_fma_f32 v[64:65], v[112:113], v[8:9], v[64:65] op_sel_hi:[1,0,1] neg_lo:[0,1,0] neg_hi:[0,1,0]
    v_pk_mul_f32 v[64:65], v[64:65], v[8:9] op_sel:[0,1] op_sel_hi:[1,1]
    v_pk_fma_f32 v[66:67], v[114:115], v[8:9], v[66:67] op_sel_hi:[1,0,1] neg_lo:[0,1,0] neg_hi:[0,1,0]
    v_pk_mul_f32 v[66:67], v[66:67], v[8:9] op_sel:[0,1] op_sel_hi:[1,1]
    v_pk_fma_f32 v[68:69], v[116:117], v[8:9], v[68:69] op_sel_hi:[1,0,1] neg_lo:[0,1,0] neg_hi:[0,1,0]
    v_pk_mul_f32 v[68:69], v[68:69], v[8:9] op_sel:[0,1] op_sel_hi:[1,1]
    v_pk_fma_f32 v[70:71], v[118:119], v[8:9], v[70:71] op_sel_hi:[1,0,1] neg_lo:[0,1,0] neg_hi:[0,1,0]
    v_pk_mul_f32 v[70:71], v[70:71], v[8:9] op_sel:[0,1] op_sel_hi:[1,1]
    v_pk_fma_f32 v[72:73], v[120:121], v[8:9], v[72:73] op_sel_hi:[1,0,1] neg_lo:[0,1,0] neg_hi:[0,1,0]
    v_pk_mul_f32 v[72:73], v[72:73], v[8:9] op_sel:[0,1] op_sel_hi:[1,1]
    v_pk_fma_f32 v[74:75], v[122:123], v[8:9], v[74:75] op_sel_hi:[1,0,1] neg_lo:[0,1,0] neg_hi:[0,1,0]
    v_pk_mul_f32 v[74:75], v[74:75], v[8:9] op_sel:[0,1] op_sel_hi:[1,1]
    v_pk_mul_f32 v[16:17], v[64:65], v[64:65]
    v_pk_mul_f32 v[18:19], v[66:67], v[66:67]
    v_pk_mul_f32 v[20:21], v[68:69], v[68:69]
    v_pk_mul_f32 v[22:23], v[70:71], v[70:71]
    v_pk_mul_f32 v[24:25], v[72:73], v[72:73]
    v_pk_mul_f32 v[26:27], v[74:75], v[74:75]
    v_pk_fma_f32 v[16:17], v[16:17], s[46:47], v[32:33]
    v_pk_fma_f32 v[18:19], v[18:19], s[46:47], v[32:33]
    v_pk_fma_f32 v[20:21], v[20:21], s[46:47], v[32:33]
    v_pk_fma_f32 v[22:23], v[22:23], s[46:47], v[32:33]
    v_pk_fma_f32 v[24:25], v[24:25], s[46:47], v[32:33]
    v_pk_fma_f32 v[26:27], v[26:27], s[46:47], v[32:33]
    v_pk_mul_f32 v[16:17], v[16:17], v[64:65]
    v_pk_mul_f32 v[18:19], v[18:19], v[66:67]
    v_pk_mul_f32 v[20:21], v[20:21], v[68:69]
    v_pk_mul_f32 v[22:23], v[22:23], v[70:71]
    v_pk_mul_f32 v[24:25], v[24:25], v[72:73]
    v_pk_mul_f32 v[26:27], v[26:27], v[74:75]
    v_exp_f32 v16, v16
    v_exp_f32 v17, v17
    v_exp_f32 v18, v18
    v_exp_f32 v19, v19
    v_exp_f32 v20, v20
    v_exp_f32 v21, v21
    v_exp_f32 v22, v22
    v_exp_f32 v23, v23
    v_exp_f32 v24, v24
    v_exp_f32 v25, v25
    v_exp_f32 v26, v26
    v_exp_f32 v27, v27
    v_pk_add_f32 v[16:17], v[16:17], 1.0 op_sel_hi:[1,0]
    v_pk_add_f32 v[18:19], v[18:19], 1.0 op_sel_hi:[1,0]
    v_pk_add_f32 v[20:21], v[20:21], 1.0 op_sel_hi:[1,0]
    v_pk_add_f32 v[22:23], v[22:23], 1.0 op_sel_hi:[1,0]
    v_pk_add_f32 v[24:25], v[24:25], 1.0 op_sel_hi:[1,0]
    v_pk_add_f32 v[26:27], v[26:27], 1.0 op_sel_hi:[1,0]
    v_rcp_f32 v16, v16
    v_rcp_f32 v17, v17
    v_rcp_f32 v18, v18
    v_rcp_f32 v19, v19
    v_rcp_f32 v20, v20
    v_rcp_f32 v21, v21
    v_rcp_f32 v22, v22
    v_rcp_f32 v23, v23
    v_rcp_f32 v24, v24
    v_rcp_f32 v25, v25
    v_rcp_f32 v26, v26
    v_rcp_f32 v27, v27
    v_pk_mul_f32 v[64:65], v[16:17], v[64:65]
    v_pk_mul_f32 v[66:67], v[18:19], v[66:67]
    v_pk_mul_f32 v[68:69], v[20:21], v[68:69]
    v_pk_mul_f32 v[70:71], v[22:23], v[70:71]
    v_pk_mul_f32 v[72:73], v[24:25], v[72:73]
    v_pk_mul_f32 v[74:75], v[26:27], v[74:75]
    v_cvt_pk_bf16_f32 v64, v64, v65
    v_cvt_pk_bf16_f32 v65, v66, v67
    ds_write_b64 v40, v[64:65] offset:0
    v_cvt_pk_bf16_f32 v68, v68, v69
    v_cvt_pk_bf16_f32 v69, v70, v71
    ds_write_b64 v40, v[68:69] offset:32
    v_cvt_pk_bf16_f32 v72, v72, v73
    v_cvt_pk_bf16_f32 v73, v74, v75
    ds_write_b64 v40, v[72:73] offset:64
    v_pk_fma_f32 v[76:77], v[112:113], v[10:11], v[76:77] op_sel_hi:[1,0,1] neg_lo:[0,1,0] neg_hi:[0,1,0]
    v_pk_mul_f32 v[76:77], v[76:77], v[10:11] op_sel:[0,1] op_sel_hi:[1,1]
    v_pk_fma_f32 v[78:79], v[114:115], v[10:11], v[78:79] op_sel_hi:[1,0,1] neg_lo:[0,1,0] neg_hi:[0,1,0]
    v_pk_mul_f32 v[78:79], v[78:79], v[10:11] op_sel:[0,1] op_sel_hi:[1,1]
    v_pk_fma_f32 v[80:81], v[116:117], v[10:11], v[80:81] op_sel_hi:[1,0,1] neg_lo:[0,1,0] neg_hi:[0,1,0]
    v_pk_mul_f32 v[80:81], v[80:81], v[10:11] op_sel:[0,1] op_sel_hi:[1,1]
    v_pk_fma_f32 v[82:83], v[118:119], v[10:11], v[82:83] op_sel_hi:[1,0,1] neg_lo:[0,1,0] neg_hi:[0,1,0]
    v_pk_mul_f32 v[82:83], v[82:83], v[10:11] op_sel:[0,1] op_sel_hi:[1,1]
    v_pk_fma_f32 v[84:85], v[120:121], v[10:11], v[84:85] op_sel_hi:[1,0,1] neg_lo:[0,1,0] neg_hi:[0,1,0]
    v_pk_mul_f32 v[84:85], v[84:85], v[10:11] op_sel:[0,1] op_sel_hi:[1,1]
    v_pk_fma_f32 v[86:87], v[122:123], v[10:11], v[86:87] op_sel_hi:[1,0,1] neg_lo:[0,1,0] neg_hi:[0,1,0]
    v_pk_mul_f32 v[86:87], v[86:87], v[10:11] op_sel:[0,1] op_sel_hi:[1,1]
    v_pk_mul_f32 v[16:17], v[76:77], v[76:77]
    v_pk_mul_f32 v[18:19], v[78:79], v[78:79]
    v_pk_mul_f32 v[20:21], v[80:81], v[80:81]
    v_pk_mul_f32 v[22:23], v[82:83], v[82:83]
    v_pk_mul_f32 v[24:25], v[84:85], v[84:85]
    v_pk_mul_f32 v[26:27], v[86:87], v[86:87]
    v_pk_fma_f32 v[16:17], v[16:17], s[46:47], v[32:33]
    v_pk_fma_f32 v[18:19], v[18:19], s[46:47], v[32:33]
    v_pk_fma_f32 v[20:21], v[20:21], s[46:47], v[32:33]
    v_pk_fma_f32 v[22:23], v[22:23], s[46:47], v[32:33]
    v_pk_fma_f32 v[24:25], v[24:25], s[46:47], v[32:33]
    v_pk_fma_f32 v[26:27], v[26:27], s[46:47], v[32:33]
    v_pk_mul_f32 v[16:17], v[16:17], v[76:77]
    v_pk_mul_f32 v[18:19], v[18:19], v[78:79]
    v_pk_mul_f32 v[20:21], v[20:21], v[80:81]
    v_pk_mul_f32 v[22:23], v[22:23], v[82:83]
    v_pk_mul_f32 v[24:25], v[24:25], v[84:85]
    v_pk_mul_f32 v[26:27], v[26:27], v[86:87]
    v_exp_f32 v16, v16
    v_exp_f32 v17, v17
    v_exp_f32 v18, v18
    v_exp_f32 v19, v19
    v_exp_f32 v20, v20
    v_exp_f32 v21, v21
    v_exp_f32 v22, v22
    v_exp_f32 v23, v23
    v_exp_f32 v24, v24
    v_exp_f32 v25, v25
    v_exp_f32 v26, v26
    v_exp_f32 v27, v27
    v_pk_add_f32 v[16:17], v[16:17], 1.0 op_sel_hi:[1,0]
    v_pk_add_f32 v[18:19], v[18:19], 1.0 op_sel_hi:[1,0]
    v_pk_add_f32 v[20:21], v[20:21], 1.0 op_sel_hi:[1,0]
    v_pk_add_f32 v[22:23], v[22:23], 1.0 op_sel_hi:[1,0]
    v_pk_add_f32 v[24:25], v[24:25], 1.0 op_sel_hi:[1,0]
    v_pk_add_f32 v[26:27], v[26:27], 1.0 op_sel_hi:[1,0]
    v_rcp_f32 v16, v16
    v_rcp_f32 v17, v17
    v_rcp_f32 v18, v18
    v_rcp_f32 v19, v19
    v_rcp_f32 v20, v20
    v_rcp_f32 v21, v21
    v_rcp_f32 v22, v22
    v_rcp_f32 v23, v23
    v_rcp_f32 v24, v24
    v_rcp_f32 v25, v25
    v_rcp_f32 v26, v26
    v_rcp_f32 v27, v27
    v_pk_mul_f32 v[76:77], v[16:17], v[76:77]
    v_pk_mul_f32 v[78:79], v[18:19], v[78:79]
    v_pk_mul_f32 v[80:81], v[20:21], v[80:81]
    v_pk_mul_f32 v[82:83], v[22:23], v[82:83]
    v_pk_mul_f32 v[84:85], v[24:25], v[84:85]
    v_pk_mul_f32 v[86:87], v[26:27], v[86:87]
    v_cvt_pk_bf16_f32 v76, v76, v77
    v_cvt_pk_bf16_f32 v77, v78, v79
    ds_write_b64 v40, v[76:77] offset:3072
    v_cvt_pk_bf16_f32 v80, v80, v81
    v_cvt_pk_bf16_f32 v81, v82, v83
    ds_write_b64 v40, v[80:81] offset:3104
    v_cvt_pk_bf16_f32 v84, v84, v85
    v_cvt_pk_bf16_f32 v85, v86, v87
    ds_write_b64 v40, v[84:85] offset:3136
    v_pk_fma_f32 v[88:89], v[112:113], v[12:13], v[88:89] op_sel_hi:[1,0,1] neg_lo:[0,1,0] neg_hi:[0,1,0]
    v_pk_mul_f32 v[88:89], v[88:89], v[12:13] op_sel:[0,1] op_sel_hi:[1,1]
    v_pk_fma_f32 v[90:91], v[114:115], v[12:13], v[90:91] op_sel_hi:[1,0,1] neg_lo:[0,1,0] neg_hi:[0,1,0]
    v_pk_mul_f32 v[90:91], v[90:91], v[12:13] op_sel:[0,1] op_sel_hi:[1,1]
    v_pk_fma_f32 v[92:93], v[116:117], v[12:13], v[92:93] op_sel_hi:[1,0,1] neg_lo:[0,1,0] neg_hi:[0,1,0]
    v_pk_mul_f32 v[92:93], v[92:93], v[12:13] op_sel:[0,1] op_sel_hi:[1,1]
    v_pk_fma_f32 v[94:95], v[118:119], v[12:13], v[94:95] op_sel_hi:[1,0,1] neg_lo:[0,1,0] neg_hi:[0,1,0]
    v_pk_mul_f32 v[94:95], v[94:95], v[12:13] op_sel:[0,1] op_sel_hi:[1,1]
    v_pk_fma_f32 v[96:97], v[120:121], v[12:13], v[96:97] op_sel_hi:[1,0,1] neg_lo:[0,1,0] neg_hi:[0,1,0]
    v_pk_mul_f32 v[96:97], v[96:97], v[12:13] op_sel:[0,1] op_sel_hi:[1,1]
    v_pk_fma_f32 v[98:99], v[122:123], v[12:13], v[98:99] op_sel_hi:[1,0,1] neg_lo:[0,1,0] neg_hi:[0,1,0]
    v_pk_mul_f32 v[98:99], v[98:99], v[12:13] op_sel:[0,1] op_sel_hi:[1,1]
    v_pk_mul_f32 v[16:17], v[88:89], v[88:89]
    v_pk_mul_f32 v[18:19], v[90:91], v[90:91]
    v_pk_mul_f32 v[20:21], v[92:93], v[92:93]
    v_pk_mul_f32 v[22:23], v[94:95], v[94:95]
    v_pk_mul_f32 v[24:25], v[96:97], v[96:97]
    v_pk_mul_f32 v[26:27], v[98:99], v[98:99]
    v_pk_fma_f32 v[16:17], v[16:17], s[46:47], v[32:33]
    v_pk_fma_f32 v[18:19], v[18:19], s[46:47], v[32:33]
    v_pk_fma_f32 v[20:21], v[20:21], s[46:47], v[32:33]
    v_pk_fma_f32 v[22:23], v[22:23], s[46:47], v[32:33]
    v_pk_fma_f32 v[24:25], v[24:25], s[46:47], v[32:33]
    v_pk_fma_f32 v[26:27], v[26:27], s[46:47], v[32:33]
    v_pk_mul_f32 v[16:17], v[16:17], v[88:89]
    v_pk_mul_f32 v[18:19], v[18:19], v[90:91]
    v_pk_mul_f32 v[20:21], v[20:21], v[92:93]
    v_pk_mul_f32 v[22:23], v[22:23], v[94:95]
    v_pk_mul_f32 v[24:25], v[24:25], v[96:97]
    v_pk_mul_f32 v[26:27], v[26:27], v[98:99]
    v_exp_f32 v16, v16
    v_exp_f32 v17, v17
    v_exp_f32 v18, v18
    v_exp_f32 v19, v19
    v_exp_f32 v20, v20
    v_exp_f32 v21, v21
    v_exp_f32 v22, v22
    v_exp_f32 v23, v23
    v_exp_f32 v24, v24
    v_exp_f32 v25, v25
    v_exp_f32 v26, v26
    v_exp_f32 v27, v27
    v_pk_add_f32 v[16:17], v[16:17], 1.0 op_sel_hi:[1,0]
    v_pk_add_f32 v[18:19], v[18:19], 1.0 op_sel_hi:[1,0]
    v_pk_add_f32 v[20:21], v[20:21], 1.0 op_sel_hi:[1,0]
    v_pk_add_f32 v[22:23], v[22:23], 1.0 op_sel_hi:[1,0]
    v_pk_add_f32 v[24:25], v[24:25], 1.0 op_sel_hi:[1,0]
    v_pk_add_f32 v[26:27], v[26:27], 1.0 op_sel_hi:[1,0]
    v_rcp_f32 v16, v16
    v_rcp_f32 v17, v17
    v_rcp_f32 v18, v18
    v_rcp_f32 v19, v19
    v_rcp_f32 v20, v20
    v_rcp_f32 v21, v21
    v_rcp_f32 v22, v22
    v_rcp_f32 v23, v23
    v_rcp_f32 v24, v24
    v_rcp_f32 v25, v25
    v_rcp_f32 v26, v26
    v_rcp_f32 v27, v27
    v_pk_mul_f32 v[88:89], v[16:17], v[88:89]
    v_pk_mul_f32 v[90:91], v[18:19], v[90:91]
    v_pk_mul_f32 v[92:93], v[20:21], v[92:93]
    v_pk_mul_f32 v[94:95], v[22:23], v[94:95]
    v_pk_mul_f32 v[96:97], v[24:25], v[96:97]
    v_pk_mul_f32 v[98:99], v[26:27], v[98:99]
    v_cvt_pk_bf16_f32 v88, v88, v89
    v_cvt_pk_bf16_f32 v89, v90, v91
    ds_write_b64 v40, v[88:89] offset:6144
    v_cvt_pk_bf16_f32 v92, v92, v93
    v_cvt_pk_bf16_f32 v93, v94, v95
    ds_write_b64 v40, v[92:93] offset:6176
    v_cvt_pk_bf16_f32 v96, v96, v97
    v_cvt_pk_bf16_f32 v97, v98, v99
    ds_write_b64 v40, v[96:97] offset:6208
    v_pk_fma_f32 v[100:101], v[112:113], v[14:15], v[100:101] op_sel_hi:[1,0,1] neg_lo:[0,1,0] neg_hi:[0,1,0]
    v_pk_mul_f32 v[100:101], v[100:101], v[14:15] op_sel:[0,1] op_sel_hi:[1,1]
    v_pk_fma_f32 v[102:103], v[114:115], v[14:15], v[102:103] op_sel_hi:[1,0,1] neg_lo:[0,1,0] neg_hi:[0,1,0]
    v_pk_mul_f32 v[102:103], v[102:103], v[14:15] op_sel:[0,1] op_sel_hi:[1,1]
    v_pk_fma_f32 v[104:105], v[116:117], v[14:15], v[104:105] op_sel_hi:[1,0,1] neg_lo:[0,1,0] neg_hi:[0,1,0]
    v_pk_mul_f32 v[104:105], v[104:105], v[14:15] op_sel:[0,1] op_sel_hi:[1,1]
    v_pk_fma_f32 v[106:107], v[118:119], v[14:15], v[106:107] op_sel_hi:[1,0,1] neg_lo:[0,1,0] neg_hi:[0,1,0]
    v_pk_mul_f32 v[106:107], v[106:107], v[14:15] op_sel:[0,1] op_sel_hi:[1,1]
    v_pk_fma_f32 v[108:109], v[120:121], v[14:15], v[108:109] op_sel_hi:[1,0,1] neg_lo:[0,1,0] neg_hi:[0,1,0]
    v_pk_mul_f32 v[108:109], v[108:109], v[14:15] op_sel:[0,1] op_sel_hi:[1,1]
    v_pk_fma_f32 v[110:111], v[122:123], v[14:15], v[110:111] op_sel_hi:[1,0,1] neg_lo:[0,1,0] neg_hi:[0,1,0]
    v_pk_mul_f32 v[110:111], v[110:111], v[14:15] op_sel:[0,1] op_sel_hi:[1,1]
    v_pk_mul_f32 v[16:17], v[100:101], v[100:101]
    v_pk_mul_f32 v[18:19], v[102:103], v[102:103]
    v_pk_mul_f32 v[20:21], v[104:105], v[104:105]
    v_pk_mul_f32 v[22:23], v[106:107], v[106:107]
    v_pk_mul_f32 v[24:25], v[108:109], v[108:109]
    v_pk_mul_f32 v[26:27], v[110:111], v[110:111]
    v_pk_fma_f32 v[16:17], v[16:17], s[46:47], v[32:33]
    v_pk_fma_f32 v[18:19], v[18:19], s[46:47], v[32:33]
    v_pk_fma_f32 v[20:21], v[20:21], s[46:47], v[32:33]
    v_pk_fma_f32 v[22:23], v[22:23], s[46:47], v[32:33]
    v_pk_fma_f32 v[24:25], v[24:25], s[46:47], v[32:33]
    v_pk_fma_f32 v[26:27], v[26:27], s[46:47], v[32:33]
    v_pk_mul_f32 v[16:17], v[16:17], v[100:101]
    v_pk_mul_f32 v[18:19], v[18:19], v[102:103]
    v_pk_mul_f32 v[20:21], v[20:21], v[104:105]
    v_pk_mul_f32 v[22:23], v[22:23], v[106:107]
    v_pk_mul_f32 v[24:25], v[24:25], v[108:109]
    v_pk_mul_f32 v[26:27], v[26:27], v[110:111]
    v_exp_f32 v16, v16
    v_exp_f32 v17, v17
    v_exp_f32 v18, v18
    v_exp_f32 v19, v19
    v_exp_f32 v20, v20
    v_exp_f32 v21, v21
    v_exp_f32 v22, v22
    v_exp_f32 v23, v23
    v_exp_f32 v24, v24
    v_exp_f32 v25, v25
    v_exp_f32 v26, v26
    v_exp_f32 v27, v27
    v_pk_add_f32 v[16:17], v[16:17], 1.0 op_sel_hi:[1,0]
    v_pk_add_f32 v[18:19], v[18:19], 1.0 op_sel_hi:[1,0]
    v_pk_add_f32 v[20:21], v[20:21], 1.0 op_sel_hi:[1,0]
    v_pk_add_f32 v[22:23], v[22:23], 1.0 op_sel_hi:[1,0]
    v_pk_add_f32 v[24:25], v[24:25], 1.0 op_sel_hi:[1,0]
    v_pk_add_f32 v[26:27], v[26:27], 1.0 op_sel_hi:[1,0]
    v_rcp_f32 v16, v16
    v_rcp_f32 v17, v17
    v_rcp_f32 v18, v18
    v_rcp_f32 v19, v19
    v_rcp_f32 v20, v20
    v_rcp_f32 v21, v21
    v_rcp_f32 v22, v22
    v_rcp_f32 v23, v23
    v_rcp_f32 v24, v24
    v_rcp_f32 v25, v25
    v_rcp_f32 v26, v26
    v_rcp_f32 v27, v27
    v_pk_mul_f32 v[100:101], v[16:17], v[100:101]
    v_pk_mul_f32 v[102:103], v[18:19], v[102:103]
    v_pk_mul_f32 v[104:105], v[20:21], v[104:105]
    v_pk_mul_f32 v[106:107], v[22:23], v[106:107]
    v_pk_mul_f32 v[108:109], v[24:25], v[108:109]
    v_pk_mul_f32 v[110:111], v[26:27], v[110:111]
    v_cvt_pk_bf16_f32 v100, v100, v101
    v_cvt_pk_bf16_f32 v101, v102, v103
    ds_write_b64 v40, v[100:101] offset:9216
    v_cvt_pk_bf16_f32 v104, v104, v105
    v_cvt_pk_bf16_f32 v105, v106, v107
    ds_write_b64 v40, v[104:105] offset:9248
    v_cvt_pk_bf16_f32 v108, v108, v109
    v_cvt_pk_bf16_f32 v109, v110, v111
    ds_write_b64 v40, v[108:109] offset:9280
    s_add_u32 s12, s32, 0xf00000
    s_addc_u32 s13, s33, 0
    s_mov_b32 s14, 0x600000
    s_mov_b32 s15, 0x00020000
    s_mul_i32 s36, s26, 6144
    v_lshlrev_b32 v5, 4, v0
    v_add_u32 v6, s36, v5
    s_waitcnt lgkmcnt(0)
    s_barrier
    ds_read_b128 v[64:67], v6 offset:0
    ds_read_b128 v[68:71], v6 offset:960
    ds_read_b128 v[72:75], v6 offset:1920
    ds_read_b128 v[76:79], v6 offset:2880
    ds_read_b128 v[80:83], v6 offset:3840
    ds_read_b128 v[84:87], v6 offset:4800
    ds_read_b128 v[88:91], v6 offset:5760
    v_mul_u32_u24 v7, 43, v0
    v_lshrrev_b32 v7, 9, v7
    v_mul_u32_u24 v41, 12, v7
    v_sub_u32 v41, v0, v41
    v_mul_u32_u24 v16, 3072, v7
    v_lshl_add_u32 v16, v41, 4, v16
    v_mov_b32 v17, 0x7ff00000
    v_cmp_gt_u32 vcc, 5, v7
    s_nop 1
    v_cndmask_b32 v18, v17, v16, vcc
    v_cmp_gt_u32 vcc, 2, v7
    s_nop 1
    v_cndmask_b32 v19, v17, v16, vcc
    s_lshl_b32 s47, s26, 5
    s_add_u32 s47, s47, s42
    s_mul_i32 s47, s47, 3072
    s_mul_i32 s46, s55, 192
    s_add_u32 s47, s47, s46
    s_add_u32 s48, s47, 0
    s_waitcnt lgkmcnt(6)
    buffer_store_dwordx4 v[64:67], v18, s[12:15], s48 offen sc1
    s_add_u32 s49, s47, 15360
    s_waitcnt lgkmcnt(5)
    buffer_store_dwordx4 v[68:71], v18, s[12:15], s49 offen sc1
    s_add_u32 s50, s47, 30720
    s_waitcnt lgkmcnt(4)
    buffer_store_dwordx4 v[72:75], v18, s[12:15], s50 offen sc1
    s_add_u32 s51, s47, 46080
    s_waitcnt lgkmcnt(3)
    buffer_store_dwordx4 v[76:79], v18, s[12:15], s51 offen sc1
    s_add_u32 s48, s47, 61440
    s_waitcnt lgkmcnt(2)
    buffer_store_dwordx4 v[80:83], v18, s[12:15], s48 offen sc1
    s_add_u32 s49, s47, 76800
    s_waitcnt lgkmcnt(1)
    buffer_store_dwordx4 v[84:87], v18, s[12:15], s49 offen sc1
    s_add_u32 s50, s47, 92160
    s_waitcnt lgkmcnt(0)
    buffer_store_dwordx4 v[88:91], v19, s[12:15], s50 offen sc1
    s_waitcnt vmcnt(0)
    s_barrier
    s_cmp_lg_u32 s26, 0
    s_cbranch_scc1 k2_kernel_noflag2
    s_add_u32 s30, s54, 16
    s_lshl_b32 s30, s30, 8
    s_add_u32 s30, s30, 0x1a70000
    v_mov_b32 v5, s30
    v_mov_b32 v6, 1
    s_mov_b32 exec_lo, 1
    s_mov_b32 exec_hi, 0
    global_atomic_add v5, v6, s[32:33] sc1
    s_mov_b64 exec, -1
k2_kernel_noflag2:
    s_and_b32 s3, s2, 7
    s_lshr_b32 s16, s2, 3
    s_and_b32 s52, s16, 7
    s_lshr_b32 s53, s16, 3
    s_lshr_b32 s17, s3, 1
    s_lshl_b32 s17, s17, 3
    s_add_u32 s40, s17, s52
    s_and_b32 s17, s3, 1
    s_lshl_b32 s17, s17, 2
    s_add_u32 s41, s17, s53
    s_lshl_b32 s42, s40, 6
    v_and_b32 v4, 15, v0
    v_lshrrev_b32 v5, 4, v0
    v_lshrrev_b32 v6, 1, v4
    v_xor_b32 v6, v6, v5
    s_lshl_b32 s30, s26, 4
    v_add_u32 v4, s30, v4
    v_lshlrev_b32 v4, 7, v4
    v_lshl_add_u32 v1, v6, 4, v4
    v_xor_b32 v2, 64, v1
    v_lshlrev_b32 v3, 4, v0
    v_add_u32 v3, 32768, v3
    v_and_b32 v4, 15, v0
    v_lshrrev_b32 v5, 4, v0
    s_lshl_b32 s30, s26, 4
    s_add_u32 s30, s30, s42
    v_add_u32 v4, s30, v4
    v_mul_u32_u24 v120, 0x500, v4
    s_mul_i32 s44, s41, 160
    v_lshl_add_u32 v120, v5, 3, v120
    v_add_u32 v120, s44, v120
    s_mov_b32 s12, s64
    s_mov_b32 s13, s65
    s_mov_b32 s14, 0x280000
    s_mov_b32 s15, 0x00020000
    buffer_load_dwordx2 v[100:101], v120, s[12:15], 0 offen offset:0
    buffer_load_dwordx2 v[102:103], v120, s[12:15], 0 offen offset:32
    buffer_load_dwordx2 v[104:105], v120, s[12:15], 0 offen offset:64
    buffer_load_dwordx2 v[106:107], v120, s[12:15], 0 offen offset:96
    buffer_load_dwordx2 v[108:109], v120, s[12:15], 0 offen offset:128
    s_barrier
    s_add_u32 s12, s32, 0xa00000
    s_addc_u32 s13, s33, 0
    s_mov_b32 s14, 0x280000
    s_mov_b32 s15, 0x00020000
    buffer_load_dwordx2 v[110:111], v120, s[12:15], 0 offen offset:0 sc1
    buffer_load_dwordx2 v[112:113], v120, s[12:15], 0 offen offset:32 sc1
    buffer_load_dwordx2 v[114:115], v120, s[12:15], 0 offen offset:64 sc1
    buffer_load_dwordx2 v[116:117], v120, s[12:15], 0 offen offset:96 sc1
    buffer_load_dwordx2 v[118:119], v120, s[12:15], 0 offen offset:128 sc1
    s_barrier
    ds_read_b128 v[8:11], v1 offset:0
    ds_read_b128 v[12:15], v3 offset:0
    ds_read_b128 v[16:19], v3 offset:1024
    ds_read_b128 v[20:23], v3 offset:2048
    ds_read_b128 v[24:27], v3 offset:3072
    ds_read_b128 v[28:31], v3 offset:4096
    s_setprio 0
    s_waitcnt lgkmcnt(0)
    v_mfma_f32_16x16x32_bf16 v[64:67], v[12:15], v[8:11], 0
    ds_read_b128 v[32:35], v2 offset:0
    v_mfma_f32_16x16x32_bf16 v[68:71], v[16:19], v[8:11], 0
    ds_read_b128 v[36:39], v3 offset:5120
    v_mfma_f32_16x16x32_bf16 v[72:75], v[20:23], v[8:11], 0
    ds_read_b128 v[40:43], v3 offset:6144
    v_mfma_f32_16x16x32_bf16 v[76:79], v[24:27], v[8:11], 0
    ds_read_b128 v[44:47], v3 offset:7168
    v_mfma_f32_16x16x32_bf16 v[80:83], v[28:31], v[8:11], 0
    ds_read_b128 v[48:51], v3 offset:8192
    ds_read_b128 v[52:55], v3 offset:9216
    s_waitcnt lgkmcnt(0)
    s_barrier
    v_mfma_f32_16x16x32_bf16 v[64:67], v[36:39], v[32:35], v[64:67]
    ds_read_b128 v[8:11], v1 offset:8192
    v_mfma_f32_16x16x32_bf16 v[68:71], v[40:43], v[32:35], v[68:71]
    ds_read_b128 v[12:15], v3 offset:10240
    v_mfma_f32_16x16x32_bf16 v[72:75], v[44:47], v[32:35], v[72:75]
    ds_read_b128 v[16:19], v3 offset:11264
    v_mfma_f32_16x16x32_bf16 v[76:79], v[48:51], v[32:35], v[76:79]
    ds_read_b128 v[20:23], v3 offset:12288
    v_mfma_f32_16x16x32_bf16 v[80:83], v[52:55], v[32:35], v[80:83]
    ds_read_b128 v[24:27], v3 offset:13312
    ds_read_b128 v[28:31], v3 offset:14336
    s_waitcnt lgkmcnt(0)
    v_mfma_f32_16x16x32_bf16 v[64:67], v[12:15], v[8:11], v[64:67]
    ds_read_b128 v[32:35], v2 offset:8192
    v_mfma_f32_16x16x32_bf16 v[68:71], v[16:19], v[8:11], v[68:71]
    ds_read_b128 v[36:39], v3 offset:15360
    v_mfma_f32_16x16x32_bf16 v[72:75], v[20:23], v[8:11], v[72:75]
    ds_read_b128 v[40:43], v3 offset:16384
    v_mfma_f32_16x16x32_bf16 v[76:79], v[24:27], v[8:11], v[76:79]
    ds_read_b128 v[44:47], v3 offset:17408
    v_mfma_f32_16x16x32_bf16 v[80:83], v[28:31], v[8:11], v[80:83]
    ds_read_b128 v[48:51], v3 offset:18432
    ds_read_b128 v[52:55], v3 offset:19456
    s_waitcnt lgkmcnt(0)
    s_barrier
    v_mfma_f32_16x16x32_bf16 v[64:67], v[36:39], v[32:35], v[64:67]
    ds_read_b128 v[8:11], v1 offset:16384
    v_mfma_f32_16x16x32_bf16 v[68:71], v[40:43], v[32:35], v[68:71]
    ds_read_b128 v[12:15], v3 offset:20480
    v_mfma_f32_16x16x32_bf16 v[72:75], v[44:47], v[32:35], v[72:75]
    ds_read_b128 v[16:19], v3 offset:21504
    v_mfma_f32_16x16x32_bf16 v[76:79], v[48:51], v[32:35], v[76:79]
    ds_read_b128 v[20:23], v3 offset:22528
    v_mfma_f32_16x16x32_bf16 v[80:83], v[52:55], v[32:35], v[80:83]
    ds_read_b128 v[24:27], v3 offset:23552
    ds_read_b128 v[28:31], v3 offset:24576
    s_waitcnt lgkmcnt(0)
    v_mfma_f32_16x16x32_bf16 v[64:67], v[12:15], v[8:11], v[64:67]
    ds_read_b128 v[32:35], v2 offset:16384
    v_mfma_f32_16x16x32_bf16 v[68:71], v[16:19], v[8:11], v[68:71]
    ds_read_b128 v[36:39], v3 offset:25600
    v_mfma_f32_16x16x32_bf16 v[72:75], v[20:23], v[8:11], v[72:75]
    ds_read_b128 v[40:43], v3 offset:26624
    v_mfma_f32_16x16x32_bf16 v[76:79], v[24:27], v[8:11], v[76:79]
    ds_read_b128 v[44:47], v3 offset:27648
    v_mfma_f32_16x16x32_bf16 v[80:83], v[28:31], v[8:11], v[80:83]
    ds_read_b128 v[48:51], v3 offset:28672
    ds_read_b128 v[52:55], v3 offset:29696
    s_waitcnt lgkmcnt(0)
    s_barrier
    v_mfma_f32_16x16x32_bf16 v[64:67], v[36:39], v[32:35], v[64:67]
    ds_read_b128 v[8:11], v1 offset:24576
    v_mfma_f32_16x16x32_bf16 v[68:71], v[40:43], v[32:35], v[68:71]
    ds_read_b128 v[12:15], v3 offset:30720
    v_mfma_f32_16x16x32_bf16 v[72:75], v[44:47], v[32:35], v[72:75]
    ds_read_b128 v[16:19], v3 offset:31744
    v_mfma_f32_16x16x32_bf16 v[76:79], v[48:51], v[32:35], v[76:79]
    ds_read_b128 v[20:23], v3 offset:32768
    v_mfma_f32_16x16x32_bf16 v[80:83], v[52:55], v[32:35], v[80:83]
    ds_read_b128 v[24:27], v3 offset:33792
    ds_read_b128 v[28:31], v3 offset:34816
    s_waitcnt lgkmcnt(0)
    v_mfma_f32_16x16x32_bf16 v[64:67], v[12:15], v[8:11], v[64:67]
    ds_read_b128 v[32:35], v2 offset:24576
    v_mfma_f32_16x16x32_bf16 v[68:71], v[16:19], v[8:11], v[68:71]
    ds_read_b128 v[36:39], v3 offset:35840
    v_mfma_f32_16x16x32_bf16 v[72:75], v[20:23], v[8:11], v[72:75]
    ds_read_b128 v[40:43], v3 offset:36864
    v_mfma_f32_16x16x32_bf16 v[76:79], v[24:27], v[8:11], v[76:79]
    ds_read_b128 v[44:47], v3 offset:37888
    v_mfma_f32_16x16x32_bf16 v[80:83], v[28:31], v[8:11], v[80:83]
    ds_read_b128 v[48:51], v3 offset:38912
    ds_read_b128 v[52:55], v3 offset:39936
    s_waitcnt lgkmcnt(0)
    s_barrier
    v_mfma_f32_16x16x32_bf16 v[64:67], v[36:39], v[32:35], v[64:67]
    ds_read_b128 v[8:11], v1 offset:0
    v_mfma_f32_16x16x32_bf16 v[68:71], v[40:43], v[32:35], v[68:71]
    ds_read_b128 v[12:15], v3 offset:0
    v_mfma_f32_16x16x32_bf16 v[72:75], v[44:47], v[32:35], v[72:75]
    ds_read_b128 v[16:19], v3 offset:1024
    v_mfma_f32_16x16x32_bf16 v[76:79], v[48:51], v[32:35], v[76:79]
    ds_read_b128 v[20:23], v3 offset:2048
    v_mfma_f32_16x16x32_bf16 v[80:83], v[52:55], v[32:35], v[80:83]
    ds_read_b128 v[24:27], v3 offset:3072
    ds_read_b128 v[28:31], v3 offset:4096
    s_mov_b32 s19, 8
k2_kernel_g4_loop:
    s_waitcnt lgkmcnt(0)
    v_mfma_f32_16x16x32_bf16 v[64:67], v[12:15], v[8:11], v[64:67]
    ds_read_b128 v[32:35], v2 offset:0
    v_mfma_f32_16x16x32_bf16 v[68:71], v[16:19], v[8:11], v[68:71]
    ds_read_b128 v[36:39], v3 offset:5120
    v_mfma_f32_16x16x32_bf16 v[72:75], v[20:23], v[8:11], v[72:75]
    ds_read_b128 v[40:43], v3 offset:6144
    v_mfma_f32_16x16x32_bf16 v[76:79], v[24:27], v[8:11], v[76:79]
    ds_read_b128 v[44:47], v3 offset:7168
    v_mfma_f32_16x16x32_bf16 v[80:83], v[28:31], v[8:11], v[80:83]
    ds_read_b128 v[48:51], v3 offset:8192
    ds_read_b128 v[52:55], v3 offset:9216
    s_waitcnt lgkmcnt(0)
    s_barrier
    v_mfma_f32_16x16x32_bf16 v[64:67], v[36:39], v[32:35], v[64:67]
    ds_read_b128 v[8:11], v1 offset:8192
    v_mfma_f32_16x16x32_bf16 v[68:71], v[40:43], v[32:35], v[68:71]
    ds_read_b128 v[12:15], v3 offset:10240
    v_mfma_f32_16x16x32_bf16 v[72:75], v[44:47], v[32:35], v[72:75]
    ds_read_b128 v[16:19], v3 offset:11264
    v_mfma_f32_16x16x32_bf16 v[76:79], v[48:51], v[32:35], v[76:79]
    ds_read_b128 v[20:23], v3 offset:12288
    v_mfma_f32_16x16x32_bf16 v[80:83], v[52:55], v[32:35], v[80:83]
    ds_read_b128 v[24:27], v3 offset:13312
    ds_read_b128 v[28:31], v3 offset:14336
    s_waitcnt lgkmcnt(0)
    v_mfma_f32_16x16x32_bf16 v[64:67], v[12:15], v[8:11], v[64:67]
    ds_read_b128 v[32:35], v2 offset:8192
    v_mfma_f32_16x16x32_bf16 v[68:71], v[16:19], v[8:11], v[68:71]
    ds_read_b128 v[36:39], v3 offset:15360
    v_mfma_f32_16x16x32_bf16 v[72:75], v[20:23], v[8:11], v[72:75]
    ds_read_b128 v[40:43], v3 offset:16384
    v_mfma_f32_16x16x32_bf16 v[76:79], v[24:27], v[8:11], v[76:79]
    ds_read_b128 v[44:47], v3 offset:17408
    v_mfma_f32_16x16x32_bf16 v[80:83], v[28:31], v[8:11], v[80:83]
    ds_read_b128 v[48:51], v3 offset:18432
    ds_read_b128 v[52:55], v3 offset:19456
    s_waitcnt lgkmcnt(0)
    s_barrier
    v_mfma_f32_16x16x32_bf16 v[64:67], v[36:39], v[32:35], v[64:67]
    ds_read_b128 v[8:11], v1 offset:16384
    v_mfma_f32_16x16x32_bf16 v[68:71], v[40:43], v[32:35], v[68:71]
    ds_read_b128 v[12:15], v3 offset:20480
    v_mfma_f32_16x16x32_bf16 v[72:75], v[44:47], v[32:35], v[72:75]
    ds_read_b128 v[16:19], v3 offset:21504
    v_mfma_f32_16x16x32_bf16 v[76:79], v[48:51], v[32:35], v[76:79]
    ds_read_b128 v[20:23], v3 offset:22528
    v_mfma_f32_16x16x32_bf16 v[80:83], v[52:55], v[32:35], v[80:83]
    ds_read_b128 v[24:27], v3 offset:23552
    ds_read_b128 v[28:31], v3 offset:24576
    s_waitcnt lgkmcnt(0)
    v_mfma_f32_16x16x32_bf16 v[64:67], v[12:15], v[8:11], v[64:67]
    ds_read_b128 v[32:35], v2 offset:16384
    v_mfma_f32_16x16x32_bf16 v[68:71], v[16:19], v[8:11], v[68:71]
    ds_read_b128 v[36:39], v3 offset:25600
    v_mfma_f32_16x16x32_bf16 v[72:75], v[20:23], v[8:11], v[72:75]
    ds_read_b128 v[40:43], v3 offset:26624
    v_mfma_f32_16x16x32_bf16 v[76:79], v[24:27], v[8:11], v[76:79]
    ds_read_b128 v[44:47], v3 offset:27648
    v_mfma_f32_16x16x32_bf16 v[80:83], v[28:31], v[8:11], v[80:83]
    ds_read_b128 v[48:51], v3 offset:28672
    ds_read_b128 v[52:55], v3 offset:29696
    s_waitcnt lgkmcnt(0)
    s_barrier
    v_mfma_f32_16x16x32_bf16 v[64:67], v[36:39], v[32:35], v[64:67]
    ds_read_b128 v[8:11], v1 offset:24576
    v_mfma_f32_16x16x32_bf16 v[68:71], v[40:43], v[32:35], v[68:71]
    ds_read_b128 v[12:15], v3 offset:30720
    v_mfma_f32_16x16x32_bf16 v[72:75], v[44:47], v[32:35], v[72:75]
    ds_read_b128 v[16:19], v3 offset:31744
    v_mfma_f32_16x16x32_bf16 v[76:79], v[48:51], v[32:35], v[76:79]
    ds_read_b128 v[20:23], v3 offset:32768
    v_mfma_f32_16x16x32_bf16 v[80:83], v[52:55], v[32:35], v[80:83]
    ds_read_b128 v[24:27], v3 offset:33792
    ds_read_b128 v[28:31], v3 offset:34816
    s_waitcnt lgkmcnt(0)
    v_mfma_f32_16x16x32_bf16 v[64:67], v[12:15], v[8:11], v[64:67]
    ds_read_b128 v[32:35], v2 offset:24576
    v_mfma_f32_16x16x32_bf16 v[68:71], v[16:19], v[8:11], v[68:71]
    ds_read_b128 v[36:39], v3 offset:35840
    v_mfma_f32_16x16x32_bf16 v[72:75], v[20:23], v[8:11], v[72:75]
    ds_read_b128 v[40:43], v3 offset:36864
    v_mfma_f32_16x16x32_bf16 v[76:79], v[24:27], v[8:11], v[76:79]
    ds_read_b128 v[44:47], v3 offset:37888
    v_mfma_f32_16x16x32_bf16 v[80:83], v[28:31], v[8:11], v[80:83]
    ds_read_b128 v[48:51], v3 offset:38912
    ds_read_b128 v[52:55], v3 offset:39936
    s_waitcnt lgkmcnt(0)
    s_barrier
    v_mfma_f32_16x16x32_bf16 v[64:67], v[36:39], v[32:35], v[64:67]
    ds_read_b128 v[8:11], v1 offset:0
    v_mfma_f32_16x16x32_bf16 v[68:71], v[40:43], v[32:35], v[68:71]
    ds_read_b128 v[12:15], v3 offset:0
    v_mfma_f32_16x16x32_bf16 v[72:75], v[44:47], v[32:35], v[72:75]
    ds_read_b128 v[16:19], v3 offset:1024
    v_mfma_f32_16x16x32_bf16 v[76:79], v[48:51], v[32:35], v[76:79]
    ds_read_b128 v[20:23], v3 offset:2048
    v_mfma_f32_16x16x32_bf16 v[80:83], v[52:55], v[32:35], v[80:83]
    ds_read_b128 v[24:27], v3 offset:3072
    ds_read_b128 v[28:31], v3 offset:4096
    s_sub_u32 s19, s19, 1
    s_cmp_lg_u32 s19, 0
    s_cbranch_scc1 k2_kernel_g4_loop
    s_setprio 2
    s_waitcnt lgkmcnt(0)
    s_waitcnt vmcnt(0)
    s_nop 3
    s_mov_b32 s12, s80
    s_mov_b32 s13, s81
    s_mov_b32 s14, 0x280000
    s_mov_b32 s15, 0x00020000
    s_mul_i32 s36, s26, 2560
    v_and_b32 v24, 15, v0
    v_mul_u32_u24 v24, 160, v24
    v_lshrrev_b32 v25, 4, v0
    v_lshl_add_u32 v24, v25, 3, v24
    v_add_u32 v24, s36, v24
    v_lshlrev_b32 v32, 16, v100
    v_and_b32 v33, 0xffff0000, v100
    v_lshlrev_b32 v34, 16, v101
    v_and_b32 v35, 0xffff0000, v101
    v_pk_add_f32 v[64:65], v[64:65], v[32:33]
    v_pk_add_f32 v[66:67], v[66:67], v[34:35]
    v_lshlrev_b32 v32, 16, v110
    v_and_b32 v33, 0xffff0000, v110
    v_lshlrev_b32 v34, 16, v111
    v_and_b32 v35, 0xffff0000, v111
    v_pk_add_f32 v[64:65], v[64:65], v[32:33]
    v_pk_add_f32 v[66:67], v[66:67], v[34:35]
    v_cvt_pk_bf16_f32 v64, v64, v65
    v_cvt_pk_bf16_f32 v65, v66, v67
    ds_write_b64 v24, v[64:65] offset:0
    v_lshlrev_b32 v32, 16, v102
    v_and_b32 v33, 0xffff0000, v102
    v_lshlrev_b32 v34, 16, v103
    v_and_b32 v35, 0xffff0000, v103
    v_pk_add_f32 v[68:69], v[68:69], v[32:33]
    v_pk_add_f32 v[70:71], v[70:71], v[34:35]
    v_lshlrev_b32 v32, 16, v112
    v_and_b32 v33, 0xffff0000, v112
    v_lshlrev_b32 v34, 16, v113
    v_and_b32 v35, 0xffff0000, v113
    v_pk_add_f32 v[68:69], v[68:69], v[32:33]
    v_pk_add_f32 v[70:71], v[70:71], v[34:35]
    v_cvt_pk_bf16_f32 v68, v68, v69
    v_cvt_pk_bf16_f32 v69, v70, v71
    ds_write_b64 v24, v[68:69] offset:32
    v_lshlrev_b32 v32, 16, v104
    v_and_b32 v33, 0xffff0000, v104
    v_lshlrev_b32 v34, 16, v105
    v_and_b32 v35, 0xffff0000, v105
    v_pk_add_f32 v[72:73], v[72:73], v[32:33]
    v_pk_add_f32 v[74:75], v[74:75], v[34:35]
    v_lshlrev_b32 v32, 16, v114
    v_and_b32 v33, 0xffff0000, v114
    v_lshlrev_b32 v34, 16, v115
    v_and_b32 v35, 0xffff0000, v115
    v_pk_add_f32 v[72:73], v[72:73], v[32:33]
    v_pk_add_f32 v[74:75], v[74:75], v[34:35]
    v_cvt_pk_bf16_f32 v72, v72, v73
    v_cvt_pk_bf16_f32 v73, v74, v75
    ds_write_b64 v24, v[72:73] offset:64
    v_lshlrev_b32 v32, 16, v106
    v_and_b32 v33, 0xffff0000, v106
    v_lshlrev_b32 v34, 16, v107
    v_and_b32 v35, 0xffff0000, v107
    v_pk_add_f32 v[76:77], v[76:77], v[32:33]
    v_pk_add_f32 v[78:79], v[78:79], v[34:35]
    v_lshlrev_b32 v32, 16, v116
    v_and_b32 v33, 0xffff0000, v116
    v_lshlrev_b32 v34, 16, v117
    v_and_b32 v35, 0xffff0000, v117
    v_pk_add_f32 v[76:77], v[76:77], v[32:33]
    v_pk_add_f32 v[78:79], v[78:79], v[34:35]
    v_cvt_pk_bf16_f32 v76, v76, v77
    v_cvt_pk_bf16_f32 v77, v78, v79
    ds_write_b64 v24, v[76:77] offset:96
    v_lshlrev_b32 v32, 16, v108
    v_and_b32 v33, 0xffff0000, v108
    v_lshlrev_b32 v34, 16, v109
    v_and_b32 v35, 0xffff0000, v109
    v_pk_add_f32 v[80:81], v[80:81], v[32:33]
    v_pk_add_f32 v[82:83], v[82:83], v[34:35]
    v_lshlrev_b32 v32, 16, v118
    v_and_b32 v33, 0xffff0000, v118
    v_lshlrev_b32 v34, 16, v119
    v_and_b32 v35, 0xffff0000, v119
    v_pk_add_f32 v[80:81], v[80:81], v[32:33]
    v_pk_add_f32 v[82:83], v[82:83], v[34:35]
    v_cvt_pk_bf16_f32 v80, v80, v81
    v_cvt_pk_bf16_f32 v81, v82, v83
    ds_write_b64 v24, v[80:81] offset:128
    v_lshlrev_b32 v32, 4, v0
    v_add_u32 v32, s36, v32
    v_mul_u32_u24 v33, 205, v0
    v_lshrrev_b32 v33, 11, v33
    v_mul_u32_u24 v34, 10, v33
    v_sub_u32 v34, v0, v34
    v_mul_u32_u24 v35, 1280, v33
    v_lshl_add_u32 v35, v34, 4, v35
    s_waitcnt lgkmcnt(0)
    ds_read_b128 v[8:11], v32 offset:0
    ds_read_b128 v[12:15], v32 offset:960
    ds_read_b128 v[16:19], v32 offset:1920
    v_mov_b32 v34, 0x7ff00000
    v_cmp_gt_u32 vcc, 6, v33
    s_nop 1
    v_cndmask_b32 v36, v34, v35, vcc
    v_cmp_gt_u32 vcc, 4, v33
    s_nop 1
    v_cndmask_b32 v37, v34, v35, vcc
    s_lshl_b32 s47, s26, 4
    s_add_u32 s47, s47, s42
    s_mul_i32 s47, s47, 1280
    s_add_u32 s47, s47, s44
    s_add_u32 s48, s47, 0
    s_waitcnt lgkmcnt(2)
    buffer_store_dwordx4 v[8:11], v36, s[12:15], s48 offen
    s_add_u32 s49, s47, 7680
    s_waitcnt lgkmcnt(1)
    buffer_store_dwordx4 v[12:15], v36, s[12:15], s49 offen
    s_add_u32 s50, s47, 15360
    s_waitcnt lgkmcnt(0)
    buffer_store_dwordx4 v[16:19], v37, s[12:15], s50 offen
    s_endpgm
k2_kernel_bl:
    s_sub_u32 s26, s26, 4
    s_setprio 2
    s_mul_i32 s30, s26, 16
    v_lshrrev_b32 v20, 3, v0
    v_add_u32 v20, s30, v20
    v_lshrrev_b32 v21, 1, v20
    v_xor_b32 v21, v21, v0
    v_and_b32 v21, 7, v21
    v_mov_b32 v24, v20
    v_lshlrev_b32 v25, 4, v21
    s_mul_i32 s30, s26, 16
    v_lshrrev_b32 v20, 3, v0
    v_add_u32 v20, s30, v20
    v_add_u32 v20, 8, v20
    v_lshrrev_b32 v21, 1, v20
    v_xor_b32 v21, v21, v0
    v_and_b32 v21, 7, v21
    v_mov_b32 v26, v20
    v_lshlrev_b32 v27, 4, v21
    v_subrev_u32 v27, 1024, v27
    v_mul_u32_u24 v8, 1280, v24
    v_add_u32 v8, v8, v25
    v_mov_b32 v16, v25
    v_lshrrev_b32 v16, 6, v16
    v_mul_u32_u24 v9, 1280, v26
    v_add_u32 v9, v9, v27
    v_add_u32 v17, 1024, v27
    v_lshrrev_b32 v17, 6, v17
    s_mul_i32 s30, s26, 3072
    v_lshlrev_b32 v20, 4, v0
    v_add_u32 v10, s30, v20
    s_cmp_le_u32 s26, 2
    s_cselect_b32 s30, 0, 0x7ff00000
    v_add_u32 v11, s30, v10
    s_cmp_le_u32 s26, 2
    s_cselect_b64 s[14:15], -1, 0
    s_cmp_le_u32 s26, 2
    s_cselect_b32 s30, 0, 0x7ff00000
    v_add_u32 v12, s30, v10
    s_mul_i32 s24, s26, 2048
    s_mul_i32 s20, s26, 3072
    s_add_u32 s20, s20, 32768
    s_and_b32 s3, s2, 7
    s_lshr_b32 s16, s2, 3
    s_and_b32 s52, s16, 3
    s_lshr_b32 s53, s16, 2
    s_lshl_b32 s17, s3, 2
    s_add_u32 s40, s17, s52
    s_mov_b32 s41, s53
    s_and_b32 s34, s16, 1
    s_lshr_b32 s55, s16, 1
    s_lshl_b32 s17, s3, 1
    s_add_u32 s54, s17, s34
    s_lshl_b32 s42, s40, 6
    s_mov_b32 s43, 1280
    s_mul_i32 s44, s41, 160
    s_mov_b32 s23, 81920
    s_mul_i32 s45, s53, 40
    s_mul_i32 s30, s52, 80
    s_add_u32 s45, s45, s30
    s_lshr_b32 s45, s45, 5
    s_cmp_ge_u32 s45, 10
    s_cselect_b32 s30, 10, 0
    s_sub_u32 s45, s45, s30
    s_mov_b32 s46, s45
    s_mul_i32 s30, s42, 1280
    v_add_u32 v8, s30, v8
    v_add_u32 v9, s30, v9
    s_mul_i32 s44, s41, 10
    s_mul_i32 s44, s44, 10240
    s_mov_b32 s23, 10240
    s_mul_i32 s22, s45, s23
    s_add_u32 s22, s22, s44
    s_mov_b32 s36, 0x33111
    s_mov_b32 s37, 0x44
    s_mov_b32 s38, 0x40000200
    s_mov_b32 s39, 0x0
    s_lshl_b32 s49, s45, 2
    s_lshr_b64 s[50:51], s[36:37], s49
    s_and_b32 s50, s50, 15
    s_sub_u32 s50, s50, 2
    s_mul_i32 s47, s50, 1280
    s_lshl_b32 s50, s45, 7
    s_add_u32 s47, s47, s50
    s_lshr_b64 s[50:51], s[38:39], s49
    s_and_b32 s50, s50, 15
    s_mul_i32 s48, s50, 1280
    s_waitcnt lgkmcnt(0)
    s_add_u32 s4, s32, 0x780000
    s_addc_u32 s5, s33, 0
    s_mov_b32 s6, 0x280000
    s_mov_b32 s7, 0x00020000
    s_add_u32 s8, s32, 0x2000000
    s_addc_u32 s9, s33, 0
    s_mov_b32 s10, 0xc8000
    s_mov_b32 s11, 0x00020000
    s_add_u32 m0, s24, 0
    v_mad_i32_i24 v18, v16, s48, v8
    v_add_u32 v18, s47, v18
    v_mad_i32_i24 v19, v17, s48, v9
    v_add_u32 v19, s47, v19
    buffer_load_dwordx4 v18, s[4:7], 0 offen offset:0  lds
    buffer_load_dwordx4 v19, s[4:7], 0 offen offset:1024  lds
    s_add_u32 s45, s45, 1
    s_cmp_eq_u32 s45, 10
    s_cselect_b32 s45, 0, s45
    s_lshl_b32 s49, s45, 2
    s_lshr_b64 s[50:51], s[36:37], s49
    s_and_b32 s50, s50, 15
    s_sub_u32 s50, s50, 2
    s_mul_i32 s47, s50, 1280
    s_lshl_b32 s50, s45, 7
    s_add_u32 s47, s47, s50
    s_lshr_b64 s[50:51], s[38:39], s49
    s_and_b32 s50, s50, 15
    s_mul_i32 s48, s50, 1280
    s_add_u32 m0, s20, 0
    s_nop 0
    buffer_load_dwordx4 v10, s[8:11], s22 offen offset:0 lds
    s_mov_b64 exec, s[14:15]
    buffer_load_dwordx4 v11, s[8:11], s22 offen offset:1024 lds
    buffer_load_dwordx4 v12, s[8:11], s22 offen offset:2048 lds
    s_mov_b64 exec, -1
    s_add_u32 s22, s22, s23
    s_add_u32 s46, s46, 1
    s_cmp_lg_u32 s46, 10
    s_cbranch_scc1 k2_kernel_g2_u21_done
    s_mov_b32 s22, s44
    s_mov_b32 s46, 0
k2_kernel_g2_u21_done:
    s_waitcnt vmcnt(0)
    s_barrier
    s_add_u32 m0, s24, 8192
    v_mad_i32_i24 v18, v16, s48, v8
    v_add_u32 v18, s47, v18
    v_mad_i32_i24 v19, v17, s48, v9
    v_add_u32 v19, s47, v19
    buffer_load_dwordx4 v18, s[4:7], 0 offen offset:0  lds
    buffer_load_dwordx4 v19, s[4:7], 0 offen offset:1024  lds
    s_add_u32 s45, s45, 1
    s_cmp_eq_u32 s45, 10
    s_cselect_b32 s45, 0, s45
    s_lshl_b32 s49, s45, 2
    s_lshr_b64 s[50:51], s[36:37], s49
    s_and_b32 s50, s50, 15
    s_sub_u32 s50, s50, 2
    s_mul_i32 s47, s50, 1280
    s_lshl_b32 s50, s45, 7
    s_add_u32 s47, s47, s50
    s_lshr_b64 s[50:51], s[38:39], s49
    s_and_b32 s50, s50, 15
    s_mul_i32 s48, s50, 1280
    s_add_u32 m0, s20, 10240
    s_nop 0
    buffer_load_dwordx4 v10, s[8:11], s22 offen offset:0 lds
    s_mov_b64 exec, s[14:15]
    buffer_load_dwordx4 v11, s[8:11], s22 offen offset:1024 lds
    buffer_load_dwordx4 v12, s[8:11], s22 offen offset:2048 lds
    s_mov_b64 exec, -1
    s_add_u32 s22, s22, s23
    s_add_u32 s46, s46, 1
    s_cmp_lg_u32 s46, 10
    s_cbranch_scc1 k2_kernel_g2_u22_done
    s_mov_b32 s22, s44
    s_mov_b32 s46, 0
k2_kernel_g2_u22_done:
    s_add_u32 m0, s24, 16384
    v_mad_i32_i24 v18, v16, s48, v8
    v_add_u32 v18, s47, v18
    v_mad_i32_i24 v19, v17, s48, v9
    v_add_u32 v19, s47, v19
    buffer_load_dwordx4 v18, s[4:7], 0 offen offset:0  lds
    buffer_load_dwordx4 v19, s[4:7], 0 offen offset:1024  lds
    s_add_u32 s45, s45, 1
    s_cmp_eq_u32 s45, 10
    s_cselect_b32 s45, 0, s45
    s_lshl_b32 s49, s45, 2
    s_lshr_b64 s[50:51], s[36:37], s49
    s_and_b32 s50, s50, 15
    s_sub_u32 s50, s50, 2
    s_mul_i32 s47, s50, 1280
    s_lshl_b32 s50, s45, 7
    s_add_u32 s47, s47, s50
    s_lshr_b64 s[50:51], s[38:39], s49
    s_and_b32 s50, s50, 15
    s_mul_i32 s48, s50, 1280
    s_add_u32 m0, s20, 20480
    s_nop 0
    buffer_load_dwordx4 v10, s[8:11], s22 offen offset:0 lds
    s_mov_b64 exec, s[14:15]
    buffer_load_dwordx4 v11, s[8:11], s22 offen offset:1024 lds
    buffer_load_dwordx4 v12, s[8:11], s22 offen offset:2048 lds
    s_mov_b64 exec, -1
    s_add_u32 s22, s22, s23
    s_add_u32 s46, s46, 1
    s_cmp_lg_u32 s46, 10
    s_cbranch_scc1 k2_kernel_g2_u23_done
    s_mov_b32 s22, s44
    s_mov_b32 s46, 0
k2_kernel_g2_u23_done:
    s_add_u32 m0, s24, 24576
    v_mad_i32_i24 v18, v16, s48, v8
    v_add_u32 v18, s47, v18
    v_mad_i32_i24 v19, v17, s48, v9
    v_add_u32 v19, s47, v19
    buffer_load_dwordx4 v18, s[4:7], 0 offen offset:0  lds
    buffer_load_dwordx4 v19, s[4:7], 0 offen offset:1024  lds
    s_add_u32 s45, s45, 1
    s_cmp_eq_u32 s45, 10
    s_cselect_b32 s45, 0, s45
    s_lshl_b32 s49, s45, 2
    s_lshr_b64 s[50:51], s[36:37], s49
    s_and_b32 s50, s50, 15
    s_sub_u32 s50, s50, 2
    s_mul_i32 s47, s50, 1280
    s_lshl_b32 s50, s45, 7
    s_add_u32 s47, s47, s50
    s_lshr_b64 s[50:51], s[38:39], s49
    s_and_b32 s50, s50, 15
    s_mul_i32 s48, s50, 1280
    s_add_u32 m0, s20, 30720
    s_nop 0
    buffer_load_dwordx4 v10, s[8:11], s22 offen offset:0 lds
    s_mov_b64 exec, s[14:15]
    buffer_load_dwordx4 v11, s[8:11], s22 offen offset:1024 lds
    buffer_load_dwordx4 v12, s[8:11], s22 offen offset:2048 lds
    s_mov_b64 exec, -1
    s_add_u32 s22, s22, s23
    s_add_u32 s46, s46, 1
    s_cmp_lg_u32 s46, 10
    s_cbranch_scc1 k2_kernel_g2_u24_done
    s_mov_b32 s22, s44
    s_mov_b32 s46, 0
k2_kernel_g2_u24_done:
    s_waitcnt vmcnt(10)
    s_barrier
    s_add_u32 m0, s20, 0
    s_nop 0
    buffer_load_dwordx4 v10, s[8:11], s22 offen offset:0 lds
    s_mov_b64 exec, s[14:15]
    buffer_load_dwordx4 v11, s[8:11], s22 offen offset:1024 lds
    buffer_load_dwordx4 v12, s[8:11], s22 offen offset:2048 lds
    s_mov_b64 exec, -1
    s_add_u32 s22, s22, s23
    s_add_u32 s46, s46, 1
    s_cmp_lg_u32 s46, 10
    s_cbranch_scc1 k2_kernel_g2_u25_done
    s_mov_b32 s22, s44
    s_mov_b32 s46, 0
k2_kernel_g2_u25_done:
    s_add_u32 m0, s24, 0
    v_mad_i32_i24 v18, v16, s48, v8
    v_add_u32 v18, s47, v18
    v_mad_i32_i24 v19, v17, s48, v9
    v_add_u32 v19, s47, v19
    buffer_load_dwordx4 v18, s[4:7], 0 offen offset:0  lds
    buffer_load_dwordx4 v19, s[4:7], 0 offen offset:1024  lds
    s_add_u32 s45, s45, 1
    s_cmp_eq_u32 s45, 10
    s_cselect_b32 s45, 0, s45
    s_lshl_b32 s49, s45, 2
    s_lshr_b64 s[50:51], s[36:37], s49
    s_and_b32 s50, s50, 15
    s_sub_u32 s50, s50, 2
    s_mul_i32 s47, s50, 1280
    s_lshl_b32 s50, s45, 7
    s_add_u32 s47, s47, s50
    s_lshr_b64 s[50:51], s[38:39], s49
    s_and_b32 s50, s50, 15
    s_mul_i32 s48, s50, 1280
    s_waitcnt vmcnt(10)
    s_barrier
    s_add_u32 m0, s20, 10240
    s_nop 0
    buffer_load_dwordx4 v10, s[8:11], s22 offen offset:0 lds
    s_mov_b64 exec, s[14:15]
    buffer_load_dwordx4 v11, s[8:11], s22 offen offset:1024 lds
    buffer_load_dwordx4 v12, s[8:11], s22 offen offset:2048 lds
    s_mov_b64 exec, -1
    s_add_u32 s22, s22, s23
    s_add_u32 s46, s46, 1
    s_cmp_lg_u32 s46, 10
    s_cbranch_scc1 k2_kernel_g2_u26_done
    s_mov_b32 s22, s44
    s_mov_b32 s46, 0
k2_kernel_g2_u26_done:
    s_add_u32 m0, s24, 8192
    v_mad_i32_i24 v18, v16, s48, v8
    v_add_u32 v18, s47, v18
    v_mad_i32_i24 v19, v17, s48, v9
    v_add_u32 v19, s47, v19
    buffer_load_dwordx4 v18, s[4:7], 0 offen offset:0  lds
    buffer_load_dwordx4 v19, s[4:7], 0 offen offset:1024  lds
    s_add_u32 s45, s45, 1
    s_cmp_eq_u32 s45, 10
    s_cselect_b32 s45, 0, s45
    s_lshl_b32 s49, s45, 2
    s_lshr_b64 s[50:51], s[36:37], s49
    s_and_b32 s50, s50, 15
    s_sub_u32 s50, s50, 2
    s_mul_i32 s47, s50, 1280
    s_lshl_b32 s50, s45, 7
    s_add_u32 s47, s47, s50
    s_lshr_b64 s[50:51], s[38:39], s49
    s_and_b32 s50, s50, 15
    s_mul_i32 s48, s50, 1280
    s_waitcnt vmcnt(10)
    s_barrier
    s_add_u32 m0, s20, 20480
    s_nop 0
    buffer_load_dwordx4 v10, s[8:11], s22 offen offset:0 lds
    s_mov_b64 exec, s[14:15]
    buffer_load_dwordx4 v11, s[8:11], s22 offen offset:1024 lds
    buffer_load_dwordx4 v12, s[8:11], s22 offen offset:2048 lds
    s_mov_b64 exec, -1
    s_add_u32 s22, s22, s23
    s_add_u32 s46, s46, 1
    s_cmp_lg_u32 s46, 10
    s_cbranch_scc1 k2_kernel_g2_u27_done
    s_mov_b32 s22, s44
    s_mov_b32 s46, 0
k2_kernel_g2_u27_done:
    s_add_u32 m0, s24, 16384
    v_mad_i32_i24 v18, v16, s48, v8
    v_add_u32 v18, s47, v18
    v_mad_i32_i24 v19, v17, s48, v9
    v_add_u32 v19, s47, v19
    buffer_load_dwordx4 v18, s[4:7], 0 offen offset:0  lds
    buffer_load_dwordx4 v19, s[4:7], 0 offen offset:1024  lds
    s_add_u32 s45, s45, 1
    s_cmp_eq_u32 s45, 10
    s_cselect_b32 s45, 0, s45
    s_lshl_b32 s49, s45, 2
    s_lshr_b64 s[50:51], s[36:37], s49
    s_and_b32 s50, s50, 15
    s_sub_u32 s50, s50, 2
    s_mul_i32 s47, s50, 1280
    s_lshl_b32 s50, s45, 7
    s_add_u32 s47, s47, s50
    s_lshr_b64 s[50:51], s[38:39], s49
    s_and_b32 s50, s50, 15
    s_mul_i32 s48, s50, 1280
    s_waitcnt vmcnt(10)
    s_barrier
    s_add_u32 m0, s20, 30720
    s_nop 0
    buffer_load_dwordx4 v10, s[8:11], s22 offen offset:0 lds
    s_mov_b64 exec, s[14:15]
    buffer_load_dwordx4 v11, s[8:11], s22 offen offset:1024 lds
    buffer_load_dwordx4 v12, s[8:11], s22 offen offset:2048 lds
    s_mov_b64 exec, -1
    s_add_u32 s22, s22, s23
    s_add_u32 s46, s46, 1
    s_cmp_lg_u32 s46, 10
    s_cbranch_scc1 k2_kernel_g2_u28_done
    s_mov_b32 s22, s44
    s_mov_b32 s46, 0
k2_kernel_g2_u28_done:
    s_add_u32 m0, s24, 24576
    v_mad_i32_i24 v18, v16, s48, v8
    v_add_u32 v18, s47, v18
    v_mad_i32_i24 v19, v17, s48, v9
    v_add_u32 v19, s47, v19
    buffer_load_dwordx4 v18, s[4:7], 0 offen offset:0  lds
    buffer_load_dwordx4 v19, s[4:7], 0 offen offset:1024  lds
    s_add_u32 s45, s45, 1
    s_cmp_eq_u32 s45, 10
    s_cselect_b32 s45, 0, s45
    s_lshl_b32 s49, s45, 2
    s_lshr_b64 s[50:51], s[36:37], s49
    s_and_b32 s50, s50, 15
    s_sub_u32 s50, s50, 2
    s_mul_i32 s47, s50, 1280
    s_lshl_b32 s50, s45, 7
    s_add_u32 s47, s47, s50
    s_lshr_b64 s[50:51], s[38:39], s49
    s_and_b32 s50, s50, 15
    s_mul_i32 s48, s50, 1280
    s_waitcnt vmcnt(10)
    s_barrier
    s_add_u32 m0, s20, 0
    s_nop 0
    buffer_load_dwordx4 v10, s[8:11], s22 offen offset:0 lds
    s_mov_b64 exec, s[14:15]
    buffer_load_dwordx4 v11, s[8:11], s22 offen offset:1024 lds
    buffer_load_dwordx4 v12, s[8:11], s22 offen offset:2048 lds
    s_mov_b64 exec, -1
    s_add_u32 s22, s22, s23
    s_add_u32 s46, s46, 1
    s_cmp_lg_u32 s46, 10
    s_cbranch_scc1 k2_kernel_g2_u29_done
    s_mov_b32 s22, s44
    s_mov_b32 s46, 0
k2_kernel_g2_u29_done:
    s_add_u32 m0, s24, 0
    v_mad_i32_i24 v18, v16, s48, v8
    v_add_u32 v18, s47, v18
    v_mad_i32_i24 v19, v17, s48, v9
    v_add_u32 v19, s47, v19
    buffer_load_dwordx4 v18, s[4:7], 0 offen offset:0  lds
    buffer_load_dwordx4 v19, s[4:7], 0 offen offset:1024  lds
    s_add_u32 s45, s45, 1
    s_cmp_eq_u32 s45, 10
    s_cselect_b32 s45, 0, s45
    s_lshl_b32 s49, s45, 2
    s_lshr_b64 s[50:51], s[36:37], s49
    s_and_b32 s50, s50, 15
    s_sub_u32 s50, s50, 2
    s_mul_i32 s47, s50, 1280
    s_lshl_b32 s50, s45, 7
    s_add_u32 s47, s47, s50
    s_lshr_b64 s[50:51], s[38:39], s49
    s_and_b32 s50, s50, 15
    s_mul_i32 s48, s50, 1280
    s_waitcnt vmcnt(10)
    s_barrier
    s_add_u32 m0, s20, 10240
    s_nop 0
    buffer_load_dwordx4 v10, s[8:11], s22 offen offset:0 lds
    s_mov_b64 exec, s[14:15]
    buffer_load_dwordx4 v11, s[8:11], s22 offen offset:1024 lds
    buffer_load_dwordx4 v12, s[8:11], s22 offen offset:2048 lds
    s_mov_b64 exec, -1
    s_add_u32 s22, s22, s23
    s_add_u32 s46, s46, 1
    s_cmp_lg_u32 s46, 10
    s_cbranch_scc1 k2_kernel_g2_u30_done
    s_mov_b32 s22, s44
    s_mov_b32 s46, 0
k2_kernel_g2_u30_done:
    s_add_u32 m0, s24, 8192
    v_mad_i32_i24 v18, v16, s48, v8
    v_add_u32 v18, s47, v18
    v_mad_i32_i24 v19, v17, s48, v9
    v_add_u32 v19, s47, v19
    buffer_load_dwordx4 v18, s[4:7], 0 offen offset:0  lds
    buffer_load_dwordx4 v19, s[4:7], 0 offen offset:1024  lds
    s_add_u32 s45, s45, 1
    s_cmp_eq_u32 s45, 10
    s_cselect_b32 s45, 0, s45
    s_lshl_b32 s49, s45, 2
    s_lshr_b64 s[50:51], s[36:37], s49
    s_and_b32 s50, s50, 15
    s_sub_u32 s50, s50, 2
    s_mul_i32 s47, s50, 1280
    s_lshl_b32 s50, s45, 7
    s_add_u32 s47, s47, s50
    s_lshr_b64 s[50:51], s[38:39], s49
    s_and_b32 s50, s50, 15
    s_mul_i32 s48, s50, 1280
    s_waitcnt vmcnt(10)
    s_barrier
    s_waitcnt vmcnt(5)
    s_barrier
    s_waitcnt vmcnt(0)
    s_barrier
    s_waitcnt vmcnt(0)
    s_barrier
    s_setprio 2
    s_barrier
    s_add_u32 s4, s32, 0xa00000
    s_addc_u32 s5, s33, 0
    s_mov_b32 s6, 0x280000
    s_mov_b32 s7, 0x00020000
    s_mov_b32 s8, s76
    s_mov_b32 s9, s77
    s_mov_b32 s10, 0x1e0000
    s_mov_b32 s11, 0x00020000
    s_lshl_b32 s42, s54, 7
    s_mov_b32 s43, 3072
    s_mul_i32 s44, s55, 192
    s_mov_b32 s23, 196608
    s_mul_i32 s45, s55, 20
    s_mul_i32 s30, s34, 160
    s_add_u32 s45, s45, s30
    s_lshr_b32 s45, s45, 5
    s_cmp_ge_u32 s45, 10
    s_cselect_b32 s30, 10, 0
    s_sub_u32 s45, s45, s30
    s_mov_b32 s46, s45
    s_lshl_b32 s21, s45, 7
    s_mul_i32 s22, s45, s23
    s_mul_i32 s30, s26, 192
    v_add_u32 v20, s30, v0
    v_mul_u32_u24 v21, 0x15556, v20
    v_lshrrev_b32 v21, 20, v21
    v_mul_u32_u24 v22, 12, v21
    v_lshrrev_b32 v23, 2, v21
    v_sub_u32 v22, v20, v22
    v_and_b32 v23, 2, v23
    v_xor_b32 v22, v22, v23
    v_mul_lo_u32 v21, v21, s43
    v_lshl_add_u32 v12, v22, 4, v21
    v_add_u32 v12, s44, v12
    v_add_u32 v20, 64, v20
    v_mul_u32_u24 v21, 0x15556, v20
    v_lshrrev_b32 v21, 20, v21
    v_mul_u32_u24 v22, 12, v21
    v_lshrrev_b32 v23, 2, v21
    v_sub_u32 v22, v20, v22
    v_and_b32 v23, 2, v23
    v_xor_b32 v22, v22, v23
    v_mul_lo_u32 v21, v21, s43
    v_lshl_add_u32 v13, v22, 4, v21
    v_add_u32 v13, s44, v13
    v_subrev_u32 v13, 1024, v13
    v_add_u32 v20, 64, v20
    v_mul_u32_u24 v21, 0x15556, v20
    v_lshrrev_b32 v21, 20, v21
    v_mul_u32_u24 v22, 12, v21
    v_lshrrev_b32 v23, 2, v21
    v_sub_u32 v22, v20, v22
    v_and_b32 v23, 2, v23
    v_xor_b32 v22, v22, v23
    v_mul_lo_u32 v21, v21, s43
    v_lshl_add_u32 v14, v22, 4, v21
    v_add_u32 v14, s44, v14
    v_subrev_u32 v14, 2048, v14
    s_mul_i32 s24, s26, 4096
    s_mul_i32 s20, s26, 3072
    s_add_u32 s20, s20, 49152
    s_add_u32 m0, s20, 0
    s_nop 0
    buffer_load_dwordx4 v12, s[8:11], s22 offen offset:0 lds
    buffer_load_dwordx4 v13, s[8:11], s22 offen offset:1024 lds
    buffer_load_dwordx4 v14, s[8:11], s22 offen offset:2048 lds
    s_add_u32 s22, s22, s23
    s_add_u32 s46, s46, 1
    s_cmp_lg_u32 s46, 10
    s_cbranch_scc1 k2_kernel_g3_u31_done
    s_mov_b32 s22, 0
    s_mov_b32 s46, 0
k2_kernel_g3_u31_done:
    s_add_u32 m0, s20, 12288
    s_nop 0
    buffer_load_dwordx4 v12, s[8:11], s22 offen offset:0 lds
    buffer_load_dwordx4 v13, s[8:11], s22 offen offset:1024 lds
    buffer_load_dwordx4 v14, s[8:11], s22 offen offset:2048 lds
    s_add_u32 s22, s22, s23
    s_add_u32 s46, s46, 1
    s_cmp_lg_u32 s46, 10
    s_cbranch_scc1 k2_kernel_g3_u32_done
    s_mov_b32 s22, 0
    s_mov_b32 s46, 0
k2_kernel_g3_u32_done:
    s_mul_i32 s30, s26, 32
    v_lshrrev_b32 v20, 3, v0
    v_add_u32 v20, s30, v20
    v_lshrrev_b32 v21, 1, v20
    v_xor_b32 v21, v21, v0
    v_and_b32 v21, 7, v21
    v_add_u32 v20, s42, v20
    v_mul_u32_u24 v22, 1280, v20
    v_lshl_add_u32 v8, v21, 4, v22
    s_mul_i32 s30, s26, 32
    v_lshrrev_b32 v20, 3, v0
    v_add_u32 v20, s30, v20
    v_add_u32 v20, 8, v20
    v_lshrrev_b32 v21, 1, v20
    v_xor_b32 v21, v21, v0
    v_and_b32 v21, 7, v21
    v_add_u32 v20, s42, v20
    v_mul_u32_u24 v22, 1280, v20
    v_lshl_add_u32 v9, v21, 4, v22
    v_subrev_u32 v9, 1024, v9
    s_mul_i32 s30, s26, 32
    v_lshrrev_b32 v20, 3, v0
    v_add_u32 v20, s30, v20
    v_add_u32 v20, 16, v20
    v_lshrrev_b32 v21, 1, v20
    v_xor_b32 v21, v21, v0
    v_and_b32 v21, 7, v21
    v_add_u32 v20, s42, v20
    v_mul_u32_u24 v22, 1280, v20
    v_lshl_add_u32 v10, v21, 4, v22
    v_subrev_u32 v10, 2048, v10
    s_mul_i32 s30, s26, 32
    v_lshrrev_b32 v20, 3, v0
    v_add_u32 v20, s30, v20
    v_add_u32 v20, 24, v20
    v_lshrrev_b32 v21, 1, v20
    v_xor_b32 v21, v21, v0
    v_and_b32 v21, 7, v21
    v_add_u32 v20, s42, v20
    v_mul_u32_u24 v22, 1280, v20
    v_lshl_add_u32 v11, v21, 4, v22
    v_subrev_u32 v11, 3072, v11
    s_barrier
    s_cmp_lg_u32 s26, 0
    s_cbranch_scc1 k2_kernel_nopoll
    s_lshl_b32 s30, s54, 8
    s_add_u32 s30, s30, 0x1a70000
    v_mov_b32 v20, s30
    s_mov_b32 s19, 0x40000
k2_kernel_poll:
    global_load_dword v21, v20, s[32:33] sc1
    s_waitcnt vmcnt(0)
    v_readfirstlane_b32 s30, v21
    s_sub_u32 s19, s19, 1
    s_cmp_eq_u32 s19, 0
    s_cbranch_scc1 k2_kernel_polld
    s_cmp_ge_u32 s30, 16
    s_cbranch_scc1 k2_kernel_polld
    s_sleep 2
    s_branch k2_kernel_poll
k2_kernel_polld:
k2_kernel_nopoll:
    s_barrier
    s_add_u32 m0, s24, 0
    s_nop 0
    buffer_load_dwordx4 v8, s[4:7], s21 offen offset:0 sc1 lds
    buffer_load_dwordx4 v9, s[4:7], s21 offen offset:1024 sc1 lds
    buffer_load_dwordx4 v10, s[4:7], s21 offen offset:2048 sc1 lds
    buffer_load_dwordx4 v11, s[4:7], s21 offen offset:3072 sc1 lds
    s_add_u32 s21, s21, 128
    s_add_u32 s45, s45, 1
    s_cmp_lg_u32 s45, 10
    s_cbranch_scc1 k2_kernel_g3_u33_done
    s_mov_b32 s21, 0
    s_mov_b32 s45, 0
k2_kernel_g3_u33_done:
    s_waitcnt vmcnt(0)
    s_barrier
    s_add_u32 m0, s24, 16384
    s_nop 0
    buffer_load_dwordx4 v8, s[4:7], s21 offen offset:0 sc1 lds
    buffer_load_dwordx4 v9, s[4:7], s21 offen offset:1024 sc1 lds
    buffer_load_dwordx4 v10, s[4:7], s21 offen offset:2048 sc1 lds
    buffer_load_dwordx4 v11, s[4:7], s21 offen offset:3072 sc1 lds
    s_add_u32 s21, s21, 128
    s_add_u32 s45, s45, 1
    s_cmp_lg_u32 s45, 10
    s_cbranch_scc1 k2_kernel_g3_u34_done
    s_mov_b32 s21, 0
    s_mov_b32 s45, 0
k2_kernel_g3_u34_done:
    s_add_u32 m0, s24, 32768
    s_nop 0
    buffer_load_dwordx4 v8, s[4:7], s21 offen offset:0 sc1 lds
    buffer_load_dwordx4 v9, s[4:7], s21 offen offset:1024 sc1 lds
    buffer_load_dwordx4 v10, s[4:7], s21 offen offset:2048 sc1 lds
    buffer_load_dwordx4 v11, s[4:7], s21 offen offset:3072 sc1 lds
    s_add_u32 s21, s21, 128
    s_add_u32 s45, s45, 1
    s_cmp_lg_u32 s45, 10
    s_cbranch_scc1 k2_kernel_g3_u35_done
    s_mov_b32 s21, 0
    s_mov_b32 s45, 0
k2_kernel_g3_u35_done:
    s_waitcnt vmcnt(4)
    s_barrier
    s_add_u32 m0, s20, 0
    s_nop 0
    buffer_load_dwordx4 v12, s[8:11], s22 offen offset:0 lds
    buffer_load_dwordx4 v13, s[8:11], s22 offen offset:1024 lds
    buffer_load_dwordx4 v14, s[8:11], s22 offen offset:2048 lds
    s_add_u32 s22, s22, s23
    s_add_u32 s46, s46, 1
    s_cmp_lg_u32 s46, 10
    s_cbranch_scc1 k2_kernel_g3_u36_done
    s_mov_b32 s22, 0
    s_mov_b32 s46, 0
k2_kernel_g3_u36_done:
    s_add_u32 m0, s24, 0
    s_nop 0
    buffer_load_dwordx4 v8, s[4:7], s21 offen offset:0 sc1 lds
    buffer_load_dwordx4 v9, s[4:7], s21 offen offset:1024 sc1 lds
    buffer_load_dwordx4 v10, s[4:7], s21 offen offset:2048 sc1 lds
    buffer_load_dwordx4 v11, s[4:7], s21 offen offset:3072 sc1 lds
    s_add_u32 s21, s21, 128
    s_add_u32 s45, s45, 1
    s_cmp_lg_u32 s45, 10
    s_cbranch_scc1 k2_kernel_g3_u37_done
    s_mov_b32 s21, 0
    s_mov_b32 s45, 0
k2_kernel_g3_u37_done:
    s_waitcnt vmcnt(4)
    s_barrier
    s_add_u32 m0, s20, 12288
    s_nop 0
    buffer_load_dwordx4 v12, s[8:11], s22 offen offset:0 lds
    buffer_load_dwordx4 v13, s[8:11], s22 offen offset:1024 lds
    buffer_load_dwordx4 v14, s[8:11], s22 offen offset:2048 lds
    s_add_u32 s22, s22, s23
    s_add_u32 s46, s46, 1
    s_cmp_lg_u32 s46, 10
    s_cbranch_scc1 k2_kernel_g3_u38_done
    s_mov_b32 s22, 0
    s_mov_b32 s46, 0
k2_kernel_g3_u38_done:
    s_add_u32 m0, s24, 16384
    s_nop 0
    buffer_load_dwordx4 v8, s[4:7], s21 offen offset:0 sc1 lds
    buffer_load_dwordx4 v9, s[4:7], s21 offen offset:1024 sc1 lds
    buffer_load_dwordx4 v10, s[4:7], s21 offen offset:2048 sc1 lds
    buffer_load_dwordx4 v11, s[4:7], s21 offen offset:3072 sc1 lds
    s_add_u32 s21, s21, 128
    s_add_u32 s45, s45, 1
    s_cmp_lg_u32 s45, 10
    s_cbranch_scc1 k2_kernel_g3_u39_done
    s_mov_b32 s21, 0
    s_mov_b32 s45, 0
k2_kernel_g3_u39_done:
    s_waitcnt vmcnt(4)
    s_barrier
    s_add_u32 m0, s20, 0
    s_nop 0
    buffer_load_dwordx4 v12, s[8:11], s22 offen offset:0 lds
    buffer_load_dwordx4 v13, s[8:11], s22 offen offset:1024 lds
    buffer_load_dwordx4 v14, s[8:11], s22 offen offset:2048 lds
    s_add_u32 s22, s22, s23
    s_add_u32 s46, s46, 1
    s_cmp_lg_u32 s46, 10
    s_cbranch_scc1 k2_kernel_g3_u40_done
    s_mov_b32 s22, 0
    s_mov_b32 s46, 0
k2_kernel_g3_u40_done:
    s_add_u32 m0, s24, 32768
    s_nop 0
    buffer_load_dwordx4 v8, s[4:7], s21 offen offset:0 sc1 lds
    buffer_load_dwordx4 v9, s[4:7], s21 offen offset:1024 sc1 lds
    buffer_load_dwordx4 v10, s[4:7], s21 offen offset:2048 sc1 lds
    buffer_load_dwordx4 v11, s[4:7], s21 offen offset:3072 sc1 lds
    s_add_u32 s21, s21, 128
    s_add_u32 s45, s45, 1
    s_cmp_lg_u32 s45, 10
    s_cbranch_scc1 k2_kernel_g3_u41_done
    s_mov_b32 s21, 0
    s_mov_b32 s45, 0
k2_kernel_g3_u41_done:
    s_waitcnt vmcnt(4)
    s_barrier
    s_add_u32 m0, s20, 12288
    s_nop 0
    buffer_load_dwordx4 v12, s[8:11], s22 offen offset:0 lds
    buffer_load_dwordx4 v13, s[8:11], s22 offen offset:1024 lds
    buffer_load_dwordx4 v14, s[8:11], s22 offen offset:2048 lds
    s_add_u32 s22, s22, s23
    s_add_u32 s46, s46, 1
    s_cmp_lg_u32 s46, 10
    s_cbranch_scc1 k2_kernel_g3_u42_done
    s_mov_b32 s22, 0
    s_mov_b32 s46, 0
k2_kernel_g3_u42_done:
    s_add_u32 m0, s24, 0
    s_nop 0
    buffer_load_dwordx4 v8, s[4:7], s21 offen offset:0 sc1 lds
    buffer_load_dwordx4 v9, s[4:7], s21 offen offset:1024 sc1 lds
    buffer_load_dwordx4 v10, s[4:7], s21 offen offset:2048 sc1 lds
    buffer_load_dwordx4 v11, s[4:7], s21 offen offset:3072 sc1 lds
    s_add_u32 s21, s21, 128
    s_add_u32 s45, s45, 1
    s_cmp_lg_u32 s45, 10
    s_cbranch_scc1 k2_kernel_g3_u43_done
    s_mov_b32 s21, 0
    s_mov_b32 s45, 0
k2_kernel_g3_u43_done:
    s_waitcnt vmcnt(4)
    s_barrier
    s_add_u32 m0, s20, 0
    s_nop 0
    buffer_load_dwordx4 v12, s[8:11], s22 offen offset:0 lds
    buffer_load_dwordx4 v13, s[8:11], s22 offen offset:1024 lds
    buffer_load_dwordx4 v14, s[8:11], s22 offen offset:2048 lds
    s_add_u32 s22, s22, s23
    s_add_u32 s46, s46, 1
    s_cmp_lg_u32 s46, 10
    s_cbranch_scc1 k2_kernel_g3_u44_done
    s_mov_b32 s22, 0
    s_mov_b32 s46, 0
k2_kernel_g3_u44_done:
    s_add_u32 m0, s24, 16384
    s_nop 0
    buffer_load_dwordx4 v8, s[4:7], s21 offen offset:0 sc1 lds
    buffer_load_dwordx4 v9, s[4:7], s21 offen offset:1024 sc1 lds
    buffer_load_dwordx4 v10, s[4:7], s21 offen offset:2048 sc1 lds
    buffer_load_dwordx4 v11, s[4:7], s21 offen offset:3072 sc1 lds
    s_add_u32 s21, s21, 128
    s_add_u32 s45, s45, 1
    s_cmp_lg_u32 s45, 10
    s_cbranch_scc1 k2_kernel_g3_u45_done
    s_mov_b32 s21, 0
    s_mov_b32 s45, 0
k2_kernel_g3_u45_done:
    s_waitcnt vmcnt(4)
    s_barrier
    s_add_u32 m0, s20, 12288
    s_nop 0
    buffer_load_dwordx4 v12, s[8:11], s22 offen offset:0 lds
    buffer_load_dwordx4 v13, s[8:11], s22 offen offset:1024 lds
    buffer_load_dwordx4 v14, s[8:11], s22 offen offset:2048 lds
    s_add_u32 s22, s22, s23
    s_add_u32 s46, s46, 1
    s_cmp_lg_u32 s46, 10
    s_cbranch_scc1 k2_kernel_g3_u46_done
    s_mov_b32 s22, 0
    s_mov_b32 s46, 0
k2_kernel_g3_u46_done:
    s_add_u32 m0, s24, 32768
    s_nop 0
    buffer_load_dwordx4 v8, s[4:7], s21 offen offset:0 sc1 lds
    buffer_load_dwordx4 v9, s[4:7], s21 offen offset:1024 sc1 lds
    buffer_load_dwordx4 v10, s[4:7], s21 offen offset:2048 sc1 lds
    buffer_load_dwordx4 v11, s[4:7], s21 offen offset:3072 sc1 lds
    s_add_u32 s21, s21, 128
    s_add_u32 s45, s45, 1
    s_cmp_lg_u32 s45, 10
    s_cbranch_scc1 k2_kernel_g3_u47_done
    s_mov_b32 s21, 0
    s_mov_b32 s45, 0
k2_kernel_g3_u47_done:
    s_waitcnt vmcnt(4)
    s_barrier
    s_add_u32 m0, s20, 0
    s_nop 0
    buffer_load_dwordx4 v12, s[8:11], s22 offen offset:0 lds
    buffer_load_dwordx4 v13, s[8:11], s22 offen offset:1024 lds
    buffer_load_dwordx4 v14, s[8:11], s22 offen offset:2048 lds
    s_add_u32 s22, s22, s23
    s_add_u32 s46, s46, 1
    s_cmp_lg_u32 s46, 10
    s_cbranch_scc1 k2_kernel_g3_u48_done
    s_mov_b32 s22, 0
    s_mov_b32 s46, 0
k2_kernel_g3_u48_done:
    s_add_u32 m0, s24, 0
    s_nop 0
    buffer_load_dwordx4 v8, s[4:7], s21 offen offset:0 sc1 lds
    buffer_load_dwordx4 v9, s[4:7], s21 offen offset:1024 sc1 lds
    buffer_load_dwordx4 v10, s[4:7], s21 offen offset:2048 sc1 lds
    buffer_load_dwordx4 v11, s[4:7], s21 offen offset:3072 sc1 lds
    s_add_u32 s21, s21, 128
    s_add_u32 s45, s45, 1
    s_cmp_lg_u32 s45, 10
    s_cbranch_scc1 k2_kernel_g3_u49_done
    s_mov_b32 s21, 0
    s_mov_b32 s45, 0
k2_kernel_g3_u49_done:
    s_waitcnt vmcnt(4)
    s_barrier
    s_add_u32 m0, s20, 12288
    s_nop 0
    buffer_load_dwordx4 v12, s[8:11], s22 offen offset:0 lds
    buffer_load_dwordx4 v13, s[8:11], s22 offen offset:1024 lds
    buffer_load_dwordx4 v14, s[8:11], s22 offen offset:2048 lds
    s_add_u32 s22, s22, s23
    s_add_u32 s46, s46, 1
    s_cmp_lg_u32 s46, 10
    s_cbranch_scc1 k2_kernel_g3_u50_done
    s_mov_b32 s22, 0
    s_mov_b32 s46, 0
k2_kernel_g3_u50_done:
    s_waitcnt vmcnt(0)
    s_barrier
    s_waitcnt vmcnt(0)
    s_barrier
    s_add_u32 s8, s32, 0x2300000
    s_addc_u32 s9, s33, 0
    s_mov_b32 s10, 0x2d0000
    s_mov_b32 s11, 0x00020000
    s_and_b32 s3, s2, 7
    s_lshr_b32 s16, s2, 3
    s_and_b32 s52, s16, 7
    s_lshr_b32 s53, s16, 3
    s_lshr_b32 s17, s3, 1
    s_lshl_b32 s17, s17, 3
    s_add_u32 s40, s17, s52
    s_and_b32 s17, s3, 1
    s_lshl_b32 s17, s17, 2
    s_add_u32 s41, s17, s53
    s_lshl_b32 s42, s40, 6
    s_mov_b32 s23, 10240
    s_add_u32 s37, s52, s53
    s_and_b32 s39, s37, 3
    s_mul_i32 s38, s39, 3
    s_mul_i32 s30, s26, 3072
    v_lshlrev_b32 v20, 4, v0
    v_add_u32 v10, s30, v20
    s_cmp_le_u32 s26, 2
    s_cselect_b32 s30, 0, 0x7ff00000
    v_add_u32 v11, s30, v10
    s_cmp_le_u32 s26, 2
    s_cselect_b64 s[14:15], -1, 0
    s_cmp_le_u32 s26, 2
    s_cselect_b32 s30, 0, 0x7ff00000
    v_add_u32 v12, s30, v10
    s_mul_i32 s30, s26, 16
    v_lshrrev_b32 v20, 3, v0
    v_add_u32 v20, s30, v20
    v_lshrrev_b32 v21, 1, v20
    v_xor_b32 v21, v21, v0
    v_and_b32 v21, 7, v21
    v_add_u32 v20, s42, v20
    v_mov_b32 v24, v20
    v_lshlrev_b32 v25, 4, v21
    s_mul_i32 s30, s26, 16
    v_lshrrev_b32 v20, 3, v0
    v_add_u32 v20, s30, v20
    v_add_u32 v20, 8, v20
    v_lshrrev_b32 v21, 1, v20
    v_xor_b32 v21, v21, v0
    v_and_b32 v21, 7, v21
    v_add_u32 v20, s42, v20
    v_mov_b32 v26, v20
    v_lshlrev_b32 v27, 4, v21
    v_subrev_u32 v27, 1024, v27
    v_mul_u32_u24 v16, 3072, v24
    v_add_u32 v16, v16, v25
    v_add_u32 v20, 0, v25
    v_lshrrev_b32 v20, 4, v20
    v_mul_u32_u24 v23, 48, v24
    v_add_u32 v23, 1024, v23
    v_add_u32 v21, 0, v20
    v_mul_u32_u24 v22, 43, v21
    v_lshrrev_b32 v22, 7, v22
    v_mul_u32_u24 v34, 3, v22
    v_sub_u32 v21, v21, v34
    v_mul_u32_u24 v22, 98304, v22
    v_lshl_add_u32 v34, v21, 4, v22
    v_add_u32 v34, v34, v23
    v_add_u32 v21, 8, v20
    v_mul_u32_u24 v22, 43, v21
    v_lshrrev_b32 v22, 7, v22
    v_mul_u32_u24 v36, 3, v22
    v_sub_u32 v21, v21, v36
    v_mul_u32_u24 v22, 98304, v22
    v_lshl_add_u32 v36, v21, 4, v22
    v_add_u32 v36, v36, v23
    v_add_u32 v21, 16, v20
    v_mul_u32_u24 v22, 43, v21
    v_lshrrev_b32 v22, 7, v22
    v_mul_u32_u24 v38, 3, v22
    v_sub_u32 v21, v21, v38
    v_mul_u32_u24 v22, 98304, v22
    v_lshl_add_u32 v38, v21, 4, v22
    v_add_u32 v38, v38, v23
    v_mul_u32_u24 v17, 3072, v26
    v_add_u32 v17, v17, v27
    v_add_u32 v20, 1024, v27
    v_lshrrev_b32 v20, 4, v20
    v_mul_u32_u24 v23, 48, v26
    v_add_u32 v21, 0, v20
    v_mul_u32_u24 v22, 43, v21
    v_lshrrev_b32 v22, 7, v22
    v_mul_u32_u24 v35, 3, v22
    v_sub_u32 v21, v21, v35
    v_mul_u32_u24 v22, 98304, v22
    v_lshl_add_u32 v35, v21, 4, v22
    v_add_u32 v35, v35, v23
    v_add_u32 v21, 8, v20
    v_mul_u32_u24 v22, 43, v21
    v_lshrrev_b32 v22, 7, v22
    v_mul_u32_u24 v37, 3, v22
    v_sub_u32 v21, v21, v37
    v_mul_u32_u24 v22, 98304, v22
    v_lshl_add_u32 v37, v21, 4, v22
    v_add_u32 v37, v37, v23
    v_add_u32 v21, 16, v20
    v_mul_u32_u24 v22, 43, v21
    v_lshrrev_b32 v22, 7, v22
    v_mul_u32_u24 v39, 3, v22
    v_sub_u32 v21, v21, v39
    v_mul_u32_u24 v22, 98304, v22
    v_lshl_add_u32 v39, v21, 4, v22
    v_add_u32 v39, v39, v23
    s_add_u32 s4, s32, 0xf00000
    s_addc_u32 s5, s33, 0
    s_mov_b32 s6, 0x600000
    s_mov_b32 s7, 0x00020000
    s_mov_b32 s45, s37
    s_lshl_b32 s21, s45, 7
    s_mul_i32 s44, s41, 368640
    s_mov_b32 s46, s37
    s_mul_i32 s22, s46, s23
    s_add_u32 s22, s22, s44
    s_mul_i32 s24, s26, 2048
    s_mul_i32 s20, s26, 3072
    s_add_u32 s20, s20, 32768
    s_add_u32 m0, s20, 0
    s_nop 0
    buffer_load_dwordx4 v10, s[8:11], s22 offen offset:0 lds
    s_mov_b64 exec, s[14:15]
    buffer_load_dwordx4 v11, s[8:11], s22 offen offset:1024 lds
    buffer_load_dwordx4 v12, s[8:11], s22 offen offset:2048 lds
    s_mov_b64 exec, -1
    s_add_u32 s22, s22, s23
    s_add_u32 s46, s46, 1
    s_cmp_lg_u32 s46, 24
    s_cbranch_scc1 k2_kernel_g4_u51_done
    s_mov_b32 s22, s44
    s_mov_b32 s46, 0
k2_kernel_g4_u51_done:
    s_add_u32 m0, s20, 10240
    s_nop 0
    buffer_load_dwordx4 v10, s[8:11], s22 offen offset:0 lds
    s_mov_b64 exec, s[14:15]
    buffer_load_dwordx4 v11, s[8:11], s22 offen offset:1024 lds
    buffer_load_dwordx4 v12, s[8:11], s22 offen offset:2048 lds
    s_mov_b64 exec, -1
    s_add_u32 s22, s22, s23
    s_add_u32 s46, s46, 1
    s_cmp_lg_u32 s46, 24
    s_cbranch_scc1 k2_kernel_g4_u52_done
    s_mov_b32 s22, s44
    s_mov_b32 s46, 0
k2_kernel_g4_u52_done:
    s_add_u32 m0, s20, 20480
    s_nop 0
    buffer_load_dwordx4 v10, s[8:11], s22 offen offset:0 lds
    s_mov_b64 exec, s[14:15]
    buffer_load_dwordx4 v11, s[8:11], s22 offen offset:1024 lds
    buffer_load_dwordx4 v12, s[8:11], s22 offen offset:2048 lds
    s_mov_b64 exec, -1
    s_add_u32 s22, s22, s23
    s_add_u32 s46, s46, 1
    s_cmp_lg_u32 s46, 24
    s_cbranch_scc1 k2_kernel_g4_u53_done
    s_mov_b32 s22, s44
    s_mov_b32 s46, 0
k2_kernel_g4_u53_done:
    s_barrier
    s_barrier
    s_cmp_lg_u32 s26, 0
    s_cbranch_scc1 k2_kernel_nopoll2
    s_lshr_b32 s30, s40, 1
    s_add_u32 s30, s30, 16
    s_lshl_b32 s30, s30, 8
    s_add_u32 s30, s30, 0x1a70000
    v_mov_b32 v20, s30
    s_mov_b32 s36, 0x40000
k2_kernel_pg_p:
    global_load_dword v21, v20, s[32:33] sc1
    s_waitcnt vmcnt(0)
    v_readfirstlane_b32 s30, v21
    s_nop 3
    s_sub_u32 s36, s36, 1
    s_cmp_eq_u32 s36, 0
    s_cbranch_scc1 k2_kernel_pg_e
    s_cmp_ge_u32 s30, 16
    s_cbranch_scc1 k2_kernel_pg_e
    s_sleep 2
    s_branch k2_kernel_pg_p
k2_kernel_pg_e:
k2_kernel_nopoll2:
    s_barrier
    s_add_u32 m0, s24, 0
    s_nop 0
    buffer_load_dwordx4 v16, s[4:7], s21 offen offset:0 sc1 lds
    buffer_load_dwordx4 v17, s[4:7], s21 offen offset:1024 sc1 lds
    s_add_u32 s21, s21, 128
    s_add_u32 s45, s45, 1
    s_cmp_lg_u32 s45, 24
    s_cbranch_scc1 k2_kernel_g4_u54_done
    s_mov_b32 s21, 0
    s_mov_b32 s45, 0
k2_kernel_g4_u54_done:
    s_waitcnt vmcnt(0)
    s_barrier
    s_add_u32 m0, s24, 8192
    s_nop 0
    buffer_load_dwordx4 v16, s[4:7], s21 offen offset:0 sc1 lds
    buffer_load_dwordx4 v17, s[4:7], s21 offen offset:1024 sc1 lds
    s_add_u32 s21, s21, 128
    s_add_u32 s45, s45, 1
    s_cmp_lg_u32 s45, 24
    s_cbranch_scc1 k2_kernel_g4_u55_done
    s_mov_b32 s21, 0
    s_mov_b32 s45, 0
k2_kernel_g4_u55_done:
    s_add_u32 m0, s20, 30720
    s_nop 0
    buffer_load_dwordx4 v10, s[8:11], s22 offen offset:0 lds
    s_mov_b64 exec, s[14:15]
    buffer_load_dwordx4 v11, s[8:11], s22 offen offset:1024 lds
    buffer_load_dwordx4 v12, s[8:11], s22 offen offset:2048 lds
    s_mov_b64 exec, -1
    s_add_u32 s22, s22, s23
    s_add_u32 s46, s46, 1
    s_cmp_lg_u32 s46, 24
    s_cbranch_scc1 k2_kernel_g4_u56_done
    s_mov_b32 s22, s44
    s_mov_b32 s46, 0
k2_kernel_g4_u56_done:
    s_add_u32 m0, s24, 16384
    s_nop 0
    buffer_load_dwordx4 v16, s[4:7], s21 offen offset:0 sc1 lds
    buffer_load_dwordx4 v17, s[4:7], s21 offen offset:1024 sc1 lds
    s_add_u32 s21, s21, 128
    s_add_u32 s45, s45, 1
    s_cmp_lg_u32 s45, 24
    s_cbranch_scc1 k2_kernel_g4_u57_done
    s_mov_b32 s21, 0
    s_mov_b32 s45, 0
k2_kernel_g4_u57_done:
    s_add_u32 m0, s24, 24576
    s_nop 0
    buffer_load_dwordx4 v16, s[4:7], s21 offen offset:0 sc1 lds
    buffer_load_dwordx4 v17, s[4:7], s21 offen offset:1024 sc1 lds
    s_add_u32 s21, s21, 128
    s_add_u32 s45, s45, 1
    s_cmp_lg_u32 s45, 24
    s_cbranch_scc1 k2_kernel_g4_u58_done
    s_mov_b32 s21, 0
    s_mov_b32 s45, 0
k2_kernel_g4_u58_done:
    s_waitcnt vmcnt(7)
    s_barrier
    s_add_u32 m0, s20, 0
    s_nop 0
    buffer_load_dwordx4 v10, s[8:11], s22 offen offset:0 lds
    s_mov_b64 exec, s[14:15]
    buffer_load_dwordx4 v11, s[8:11], s22 offen offset:1024 lds
    buffer_load_dwordx4 v12, s[8:11], s22 offen offset:2048 lds
    s_mov_b64 exec, -1
    s_add_u32 s22, s22, s23
    s_add_u32 s46, s46, 1
    s_cmp_lg_u32 s46, 24
    s_cbranch_scc1 k2_kernel_g4_u59_done
    s_mov_b32 s22, s44
    s_mov_b32 s46, 0
k2_kernel_g4_u59_done:
    s_add_u32 m0, s24, 0
    s_nop 0
    buffer_load_dwordx4 v16, s[4:7], s21 offen offset:0 sc1 lds
    buffer_load_dwordx4 v17, s[4:7], s21 offen offset:1024 sc1 lds
    s_add_u32 s21, s21, 128
    s_add_u32 s45, s45, 1
    s_cmp_lg_u32 s45, 24
    s_cbranch_scc1 k2_kernel_g4_u60_done
    s_mov_b32 s21, 0
    s_mov_b32 s45, 0
k2_kernel_g4_u60_done:
    s_waitcnt vmcnt(7)
    s_barrier
    s_add_u32 m0, s20, 10240
    s_nop 0
    buffer_load_dwordx4 v10, s[8:11], s22 offen offset:0 lds
    s_mov_b64 exec, s[14:15]
    buffer_load_dwordx4 v11, s[8:11], s22 offen offset:1024 lds
    buffer_load_dwordx4 v12, s[8:11], s22 offen offset:2048 lds
    s_mov_b64 exec, -1
    s_add_u32 s22, s22, s23
    s_add_u32 s46, s46, 1
    s_cmp_lg_u32 s46, 24
    s_cbranch_scc1 k2_kernel_g4_u61_done
    s_mov_b32 s22, s44
    s_mov_b32 s46, 0
k2_kernel_g4_u61_done:
    s_add_u32 m0, s24, 8192
    s_nop 0
    buffer_load_dwordx4 v16, s[4:7], s21 offen offset:0 sc1 lds
    buffer_load_dwordx4 v17, s[4:7], s21 offen offset:1024 sc1 lds
    s_add_u32 s21, s21, 128
    s_add_u32 s45, s45, 1
    s_cmp_lg_u32 s45, 24
    s_cbranch_scc1 k2_kernel_g4_u62_done
    s_mov_b32 s21, 0
    s_mov_b32 s45, 0
k2_kernel_g4_u62_done:
    s_mov_b32 s19, 4
k2_kernel_g4_ll2:
    s_waitcnt vmcnt(10)
    s_barrier
    s_add_u32 m0, s20, 20480
    s_nop 0
    buffer_load_dwordx4 v10, s[8:11], s22 offen offset:0 lds
    s_mov_b64 exec, s[14:15]
    buffer_load_dwordx4 v11, s[8:11], s22 offen offset:1024 lds
    buffer_load_dwordx4 v12, s[8:11], s22 offen offset:2048 lds
    s_mov_b64 exec, -1
    s_add_u32 s22, s22, s23
    s_add_u32 s46, s46, 1
    s_cmp_lg_u32 s46, 24
    s_cbranch_scc1 k2_kernel_g4_u63_done
    s_mov_b32 s22, s44
    s_mov_b32 s46, 0
k2_kernel_g4_u63_done:
    s_add_u32 m0, s24, 16384
    s_nop 0
    buffer_load_dwordx4 v16, s[4:7], s21 offen offset:0 sc1 lds
    buffer_load_dwordx4 v17, s[4:7], s21 offen offset:1024 sc1 lds
    s_add_u32 s21, s21, 128
    s_add_u32 s45, s45, 1
    s_cmp_lg_u32 s45, 24
    s_cbranch_scc1 k2_kernel_g4_u64_done
    s_mov_b32 s21, 0
    s_mov_b32 s45, 0
k2_kernel_g4_u64_done:
    s_waitcnt vmcnt(10)
    s_barrier
    s_add_u32 m0, s20, 30720
    s_nop 0
    buffer_load_dwordx4 v10, s[8:11], s22 offen offset:0 lds
    s_mov_b64 exec, s[14:15]
    buffer_load_dwordx4 v11, s[8:11], s22 offen offset:1024 lds
    buffer_load_dwordx4 v12, s[8:11], s22 offen offset:2048 lds
    s_mov_b64 exec, -1
    s_add_u32 s22, s22, s23
    s_add_u32 s46, s46, 1
    s_cmp_lg_u32 s46, 24
    s_cbranch_scc1 k2_kernel_g4_u65_done
    s_mov_b32 s22, s44
    s_mov_b32 s46, 0
k2_kernel_g4_u65_done:
    s_add_u32 m0, s24, 24576
    s_nop 0
    buffer_load_dwordx4 v16, s[4:7], s21 offen offset:0 sc1 lds
    buffer_load_dwordx4 v17, s[4:7], s21 offen offset:1024 sc1 lds
    s_add_u32 s21, s21, 128
    s_add_u32 s45, s45, 1
    s_cmp_lg_u32 s45, 24
    s_cbranch_scc1 k2_kernel_g4_u66_done
    s_mov_b32 s21, 0
    s_mov_b32 s45, 0
k2_kernel_g4_u66_done:
    s_waitcnt vmcnt(10)
    s_barrier
    s_add_u32 m0, s20, 0
    s_nop 0
    buffer_load_dwordx4 v10, s[8:11], s22 offen offset:0 lds
    s_mov_b64 exec, s[14:15]
    buffer_load_dwordx4 v11, s[8:11], s22 offen offset:1024 lds
    buffer_load_dwordx4 v12, s[8:11], s22 offen offset:2048 lds
    s_mov_b64 exec, -1
    s_add_u32 s22, s22, s23
    s_add_u32 s46, s46, 1
    s_cmp_lg_u32 s46, 24
    s_cbranch_scc1 k2_kernel_g4_u67_done
    s_mov_b32 s22, s44
    s_mov_b32 s46, 0
k2_kernel_g4_u67_done:
    s_add_u32 m0, s24, 0
    s_nop 0
    buffer_load_dwordx4 v16, s[4:7], s21 offen offset:0 sc1 lds
    buffer_load_dwordx4 v17, s[4:7], s21 offen offset:1024 sc1 lds
    s_add_u32 s21, s21, 128
    s_add_u32 s45, s45, 1
    s_cmp_lg_u32 s45, 24
    s_cbranch_scc1 k2_kernel_g4_u68_done
    s_mov_b32 s21, 0
    s_mov_b32 s45, 0
k2_kernel_g4_u68_done:
    s_waitcnt vmcnt(10)
    s_barrier
    s_add_u32 m0, s20, 10240
    s_nop 0
    buffer_load_dwordx4 v10, s[8:11], s22 offen offset:0 lds
    s_mov_b64 exec, s[14:15]
    buffer_load_dwordx4 v11, s[8:11], s22 offen offset:1024 lds
    buffer_load_dwordx4 v12, s[8:11], s22 offen offset:2048 lds
    s_mov_b64 exec, -1
    s_add_u32 s22, s22, s23
    s_add_u32 s46, s46, 1
    s_cmp_lg_u32 s46, 24
    s_cbranch_scc1 k2_kernel_g4_u69_done
    s_mov_b32 s22, s44
    s_mov_b32 s46, 0
k2_kernel_g4_u69_done:
    s_add_u32 m0, s24, 8192
    s_nop 0
    buffer_load_dwordx4 v16, s[4:7], s21 offen offset:0 sc1 lds
    buffer_load_dwordx4 v17, s[4:7], s21 offen offset:1024 sc1 lds
    s_add_u32 s21, s21, 128
    s_add_u32 s45, s45, 1
    s_cmp_lg_u32 s45, 24
    s_cbranch_scc1 k2_kernel_g4_u70_done
    s_mov_b32 s21, 0
    s_mov_b32 s45, 0
k2_kernel_g4_u70_done:
    s_sub_u32 s19, s19, 1
    s_cmp_lg_u32 s19, 0
    s_cbranch_scc1 k2_kernel_g4_ll2
    s_waitcnt vmcnt(10)
    s_barrier
    s_add_u32 m0, s20, 20480
    s_nop 0
    buffer_load_dwordx4 v10, s[8:11], s22 offen offset:0 lds
    s_mov_b64 exec, s[14:15]
    buffer_load_dwordx4 v11, s[8:11], s22 offen offset:1024 lds
    buffer_load_dwordx4 v12, s[8:11], s22 offen offset:2048 lds
    s_mov_b64 exec, -1
    s_add_u32 s22, s22, s23
    s_add_u32 s46, s46, 1
    s_cmp_lg_u32 s46, 24
    s_cbranch_scc1 k2_kernel_g4_u71_done
    s_mov_b32 s22, s44
    s_mov_b32 s46, 0
k2_kernel_g4_u71_done:
    s_add_u32 m0, s24, 16384
    s_nop 0
    buffer_load_dwordx4 v16, s[4:7], s21 offen offset:0 sc1 lds
    buffer_load_dwordx4 v17, s[4:7], s21 offen offset:1024 sc1 lds
    s_add_u32 s21, s21, 128
    s_add_u32 s45, s45, 1
    s_cmp_lg_u32 s45, 24
    s_cbranch_scc1 k2_kernel_g4_u72_done
    s_mov_b32 s21, 0
    s_mov_b32 s45, 0
k2_kernel_g4_u72_done:
    s_waitcnt vmcnt(10)
    s_barrier
    s_add_u32 m0, s20, 30720
    s_nop 0
    buffer_load_dwordx4 v10, s[8:11], s22 offen offset:0 lds
    s_mov_b64 exec, s[14:15]
    buffer_load_dwordx4 v11, s[8:11], s22 offen offset:1024 lds
    buffer_load_dwordx4 v12, s[8:11], s22 offen offset:2048 lds
    s_mov_b64 exec, -1
    s_add_u32 s44, s44, 245760
    s_mov_b32 s46, s38
    s_mul_i32 s22, s46, s23
    s_add_u32 s22, s22, s44
    s_add_u32 m0, s24, 24576
    s_nop 0
    buffer_load_dwordx4 v16, s[4:7], s21 offen offset:0 sc1 lds
    buffer_load_dwordx4 v17, s[4:7], s21 offen offset:1024 sc1 lds
    s_lshr_b32 s30, s40, 2
    s_add_u32 s30, s30, 32
    s_lshl_b32 s30, s30, 8
    s_add_u32 s30, s30, 0x1a70000
    v_mov_b32 v20, s30
    s_mov_b32 s36, 0x40000
k2_kernel_po_p:
    global_load_dword v21, v20, s[32:33] sc1
    s_waitcnt vmcnt(0)
    v_readfirstlane_b32 s30, v21
    s_nop 3
    s_sub_u32 s36, s36, 1
    s_cmp_eq_u32 s36, 0
    s_cbranch_scc1 k2_kernel_po_e
    s_cmp_ge_u32 s30, 32
    s_cbranch_scc1 k2_kernel_po_e
    s_sleep 2
    s_branch k2_kernel_po_p
k2_kernel_po_e:
    s_add_u32 s4, s32, 0x29ffc00
    s_addc_u32 s5, s33, 0
    s_mov_b32 s6, 0x300400
    s_mov_b32 s45, s39
    s_mul_i32 s21, s45, 786432
    s_waitcnt vmcnt(10)
    s_barrier
    s_add_u32 m0, s20, 0
    s_nop 0
    buffer_load_dwordx4 v10, s[8:11], s22 offen offset:0 lds
    s_mov_b64 exec, s[14:15]
    buffer_load_dwordx4 v11, s[8:11], s22 offen offset:1024 lds
    buffer_load_dwordx4 v12, s[8:11], s22 offen offset:2048 lds
    s_mov_b64 exec, -1
    s_add_u32 s22, s22, s23
    s_add_u32 s46, s46, 1
    s_cmp_lg_u32 s46, 12
    s_cbranch_scc1 k2_kernel_g4_u73_done
    s_mov_b32 s22, s44
    s_mov_b32 s46, 0
k2_kernel_g4_u73_done:
    s_add_u32 m0, s24, 0
    s_nop 0
    buffer_load_dwordx4 v34, s[4:7], s21 offen offset:0 sc1 lds
    buffer_load_dwordx4 v35, s[4:7], s21 offen offset:1024 sc1 lds
    s_waitcnt vmcnt(10)
    s_barrier
    s_add_u32 m0, s20, 10240
    s_nop 0
    buffer_load_dwordx4 v10, s[8:11], s22 offen offset:0 lds
    s_mov_b64 exec, s[14:15]
    buffer_load_dwordx4 v11, s[8:11], s22 offen offset:1024 lds
    buffer_load_dwordx4 v12, s[8:11], s22 offen offset:2048 lds
    s_mov_b64 exec, -1
    s_add_u32 s22, s22, s23
    s_add_u32 s46, s46, 1
    s_cmp_lg_u32 s46, 12
    s_cbranch_scc1 k2_kernel_g4_u74_done
    s_mov_b32 s22, s44
    s_mov_b32 s46, 0
k2_kernel_g4_u74_done:
    s_add_u32 m0, s24, 8192
    s_nop 0
    buffer_load_dwordx4 v36, s[4:7], s21 offen offset:0 sc1 lds
    buffer_load_dwordx4 v37, s[4:7], s21 offen offset:1024 sc1 lds
    s_waitcnt vmcnt(10)
    s_barrier
    s_add_u32 m0, s20, 20480
    s_nop 0
    buffer_load_dwordx4 v10, s[8:11], s22 offen offset:0 lds
    s_mov_b64 exec, s[14:15]
    buffer_load_dwordx4 v11, s[8:11], s22 offen offset:1024 lds
    buffer_load_dwordx4 v12, s[8:11], s22 offen offset:2048 lds
    s_mov_b64 exec, -1
    s_add_u32 s22, s22, s23
    s_add_u32 s46, s46, 1
    s_cmp_lg_u32 s46, 12
    s_cbranch_scc1 k2_kernel_g4_u75_done
    s_mov_b32 s22, s44
    s_mov_b32 s46, 0
k2_kernel_g4_u75_done:
    s_add_u32 m0, s24, 16384
    s_nop 0
    buffer_load_dwordx4 v38, s[4:7], s21 offen offset:0 sc1 lds
    buffer_load_dwordx4 v39, s[4:7], s21 offen offset:1024 sc1 lds
    s_add_u32 s45, s45, 1
    s_and_b32 s45, s45, 3
    s_mul_i32 s21, s45, 786432
    s_waitcnt vmcnt(10)
    s_barrier
    s_add_u32 m0, s20, 30720
    s_nop 0
    buffer_load_dwordx4 v10, s[8:11], s22 offen offset:0 lds
    s_mov_b64 exec, s[14:15]
    buffer_load_dwordx4 v11, s[8:11], s22 offen offset:1024 lds
    buffer_load_dwordx4 v12, s[8:11], s22 offen offset:2048 lds
    s_mov_b64 exec, -1
    s_add_u32 s22, s22, s23
    s_add_u32 s46, s46, 1
    s_cmp_lg_u32 s46, 12
    s_cbranch_scc1 k2_kernel_g4_u76_done
    s_mov_b32 s22, s44
    s_mov_b32 s46, 0
k2_kernel_g4_u76_done:
    s_add_u32 m0, s24, 24576
    s_nop 0
    buffer_load_dwordx4 v34, s[4:7], s21 offen offset:0 sc1 lds
    buffer_load_dwordx4 v35, s[4:7], s21 offen offset:1024 sc1 lds
    s_waitcnt vmcnt(10)
    s_barrier
    s_add_u32 m0, s20, 0
    s_nop 0
    buffer_load_dwordx4 v10, s[8:11], s22 offen offset:0 lds
    s_mov_b64 exec, s[14:15]
    buffer_load_dwordx4 v11, s[8:11], s22 offen offset:1024 lds
    buffer_load_dwordx4 v12, s[8:11], s22 offen offset:2048 lds
    s_mov_b64 exec, -1
    s_add_u32 s22, s22, s23
    s_add_u32 s46, s46, 1
    s_cmp_lg_u32 s46, 12
    s_cbranch_scc1 k2_kernel_g4_u77_done
    s_mov_b32 s22, s44
    s_mov_b32 s46, 0
k2_kernel_g4_u77_done:
    s_add_u32 m0, s24, 0
    s_nop 0
    buffer_load_dwordx4 v36, s[4:7], s21 offen offset:0 sc1 lds
    buffer_load_dwordx4 v37, s[4:7], s21 offen offset:1024 sc1 lds
    s_waitcnt vmcnt(10)
    s_barrier
    s_add_u32 m0, s20, 10240
    s_nop 0
    buffer_load_dwordx4 v10, s[8:11], s22 offen offset:0 lds
    s_mov_b64 exec, s[14:15]
    buffer_load_dwordx4 v11, s[8:11], s22 offen offset:1024 lds
    buffer_load_dwordx4 v12, s[8:11], s22 offen offset:2048 lds
    s_mov_b64 exec, -1
    s_add_u32 s22, s22, s23
    s_add_u32 s46, s46, 1
    s_cmp_lg_u32 s46, 12
    s_cbranch_scc1 k2_kernel_g4_u78_done
    s_mov_b32 s22, s44
    s_mov_b32 s46, 0
k2_kernel_g4_u78_done:
    s_add_u32 m0, s24, 8192
    s_nop 0
    buffer_load_dwordx4 v38, s[4:7], s21 offen offset:0 sc1 lds
    buffer_load_dwordx4 v39, s[4:7], s21 offen offset:1024 sc1 lds
    s_add_u32 s45, s45, 1
    s_and_b32 s45, s45, 3
    s_mul_i32 s21, s45, 786432
    s_waitcnt vmcnt(10)
    s_barrier
    s_add_u32 m0, s20, 20480
    s_nop 0
    buffer_load_dwordx4 v10, s[8:11], s22 offen offset:0 lds
    s_mov_b64 exec, s[14:15]
    buffer_load_dwordx4 v11, s[8:11], s22 offen offset:1024 lds
    buffer_load_dwordx4 v12, s[8:11], s22 offen offset:2048 lds
    s_mov_b64 exec, -1
    s_add_u32 s22, s22, s23
    s_add_u32 s46, s46, 1
    s_cmp_lg_u32 s46, 12
    s_cbranch_scc1 k2_kernel_g4_u79_done
    s_mov_b32 s22, s44
    s_mov_b32 s46, 0
k2_kernel_g4_u79_done:
    s_add_u32 m0, s24, 16384
    s_nop 0
    buffer_load_dwordx4 v34, s[4:7], s21 offen offset:0 sc1 lds
    buffer_load_dwordx4 v35, s[4:7], s21 offen offset:1024 sc1 lds
    s_waitcnt vmcnt(10)
    s_barrier
    s_add_u32 m0, s20, 30720
    s_nop 0
    buffer_load_dwordx4 v10, s[8:11], s22 offen offset:0 lds
    s_mov_b64 exec, s[14:15]
    buffer_load_dwordx4 v11, s[8:11], s22 offen offset:1024 lds
    buffer_load_dwordx4 v12, s[8:11], s22 offen offset:2048 lds
    s_mov_b64 exec, -1
    s_add_u32 s22, s22, s23
    s_add_u32 s46, s46, 1
    s_cmp_lg_u32 s46, 12
    s_cbranch_scc1 k2_kernel_g4_u80_done
    s_mov_b32 s22, s44
    s_mov_b32 s46, 0
k2_kernel_g4_u80_done:
    s_add_u32 m0, s24, 24576
    s_nop 0
    buffer_load_dwordx4 v36, s[4:7], s21 offen offset:0 sc1 lds
    buffer_load_dwordx4 v37, s[4:7], s21 offen offset:1024 sc1 lds
    s_waitcnt vmcnt(10)
    s_barrier
    s_add_u32 m0, s20, 0
    s_nop 0
    buffer_load_dwordx4 v10, s[8:11], s22 offen offset:0 lds
    s_mov_b64 exec, s[14:15]
    buffer_load_dwordx4 v11, s[8:11], s22 offen offset:1024 lds
    buffer_load_dwordx4 v12, s[8:11], s22 offen offset:2048 lds
    s_mov_b64 exec, -1
    s_add_u32 s22, s22, s23
    s_add_u32 s46, s46, 1
    s_cmp_lg_u32 s46, 12
    s_cbranch_scc1 k2_kernel_g4_u81_done
    s_mov_b32 s22, s44
    s_mov_b32 s46, 0
k2_kernel_g4_u81_done:
    s_add_u32 m0, s24, 0
    s_nop 0
    buffer_load_dwordx4 v38, s[4:7], s21 offen offset:0 sc1 lds
    buffer_load_dwordx4 v39, s[4:7], s21 offen offset:1024 sc1 lds
    s_add_u32 s45, s45, 1
    s_and_b32 s45, s45, 3
    s_mul_i32 s21, s45, 786432
    s_waitcnt vmcnt(10)
    s_barrier
    s_add_u32 m0, s20, 10240
    s_nop 0
    buffer_load_dwordx4 v10, s[8:11], s22 offen offset:0 lds
    s_mov_b64 exec, s[14:15]
    buffer_load_dwordx4 v11, s[8:11], s22 offen offset:1024 lds
    buffer_load_dwordx4 v12, s[8:11], s22 offen offset:2048 lds
    s_mov_b64 exec, -1
    s_add_u32 s22, s22, s23
    s_add_u32 s46, s46, 1
    s_cmp_lg_u32 s46, 12
    s_cbranch_scc1 k2_kernel_g4_u82_done
    s_mov_b32 s22, s44
    s_mov_b32 s46, 0
k2_kernel_g4_u82_done:
    s_add_u32 m0, s24, 8192
    s_nop 0
    buffer_load_dwordx4 v34, s[4:7], s21 offen offset:0 sc1 lds
    buffer_load_dwordx4 v35, s[4:7], s21 offen offset:1024 sc1 lds
    s_waitcnt vmcnt(10)
    s_barrier
    s_add_u32 m0, s20, 20480
    s_nop 0
    buffer_load_dwordx4 v10, s[8:11], s22 offen offset:0 lds
    s_mov_b64 exec, s[14:15]
    buffer_load_dwordx4 v11, s[8:11], s22 offen offset:1024 lds
    buffer_load_dwordx4 v12, s[8:11], s22 offen offset:2048 lds
    s_mov_b64 exec, -1
    s_add_u32 s22, s22, s23
    s_add_u32 s46, s46, 1
    s_cmp_lg_u32 s46, 12
    s_cbranch_scc1 k2_kernel_g4_u83_done
    s_mov_b32 s22, s44
    s_mov_b32 s46, 0
k2_kernel_g4_u83_done:
    s_add_u32 m0, s24, 16384
    s_nop 0
    buffer_load_dwordx4 v36, s[4:7], s21 offen offset:0 sc1 lds
    buffer_load_dwordx4 v37, s[4:7], s21 offen offset:1024 sc1 lds
    s_waitcnt vmcnt(10)
    s_barrier
    s_add_u32 m0, s20, 30720
    s_nop 0
    buffer_load_dwordx4 v10, s[8:11], s22 offen offset:0 lds
    s_mov_b64 exec, s[14:15]
    buffer_load_dwordx4 v11, s[8:11], s22 offen offset:1024 lds
    buffer_load_dwordx4 v12, s[8:11], s22 offen offset:2048 lds
    s_mov_b64 exec, -1
    s_add_u32 s22, s22, s23
    s_add_u32 s46, s46, 1
    s_cmp_lg_u32 s46, 12
    s_cbranch_scc1 k2_kernel_g4_u84_done
    s_mov_b32 s22, s44
    s_mov_b32 s46, 0
k2_kernel_g4_u84_done:
    s_add_u32 m0, s24, 24576
    s_nop 0
    buffer_load_dwordx4 v38, s[4:7], s21 offen offset:0 sc1 lds
    buffer_load_dwordx4 v39, s[4:7], s21 offen offset:1024 sc1 lds
    s_add_u32 s45, s45, 1
    s_and_b32 s45, s45, 3
    s_mul_i32 s21, s45, 786432
    s_waitcnt vmcnt(10)
    s_barrier
    s_waitcnt vmcnt(5)
    s_barrier
    s_waitcnt vmcnt(0)
    s_barrier
    s_waitcnt vmcnt(0)
    s_barrier
    s_endpgm
k2_kernel_exit:
    s_endpgm
code_end_label:
    .fill 64, 4, 0xBF800000
.section .rodata,"a"
.p2align 6
.amdhsa_kernel k1_kernel
  .amdhsa_next_free_vgpr 216
  .amdhsa_next_free_sgpr 96
  .amdhsa_accum_offset 216
  .amdhsa_group_segment_fixed_size 0
  .amdhsa_kernarg_size 88
  .amdhsa_user_sgpr_count 2
  .amdhsa_user_sgpr_kernarg_segment_ptr 1
  .amdhsa_system_sgpr_workgroup_id_x 1
  .amdhsa_float_denorm_mode_32 3
.end_amdhsa_kernel
.p2align 6
.amdhsa_kernel k2_kernel
  .amdhsa_next_free_vgpr 128
  .amdhsa_next_free_sgpr 96
  .amdhsa_accum_offset 128
  .amdhsa_group_segment_fixed_size 0
  .amdhsa_kernarg_size 88
  .amdhsa_user_sgpr_count 2
  .amdhsa_user_sgpr_kernarg_segment_ptr 1
  .amdhsa_system_sgpr_workgroup_id_x 1
  .amdhsa_float_denorm_mode_32 3
.end_amdhsa_kernel
```
